```python
import torch

def _softmax(x, axis=-1):
    return torch.softmax(x, dim=axis)
def _gelu(x):
    return torch.nn.functional.gelu(x, approximate="tanh")
def _silu(x):
    return torch.nn.functional.silu(x)
def _sigmoid(x):
    return torch.sigmoid(x)
def _layernorm(x, axis=-1, eps=1e-5):
    m = x.mean(dim=axis, keepdim=True)
    v = x.var(dim=axis, keepdim=True, unbiased=False)
    return (x - m) / torch.sqrt(v + eps)
def _scatter_add(tgt, idx, src, axis=0):
    return tgt.clone().index_add_(axis, idx, src)
def _segment_sum(src, seg, n):
    out = torch.zeros((n,) + src.shape[1:], dtype=src.dtype)
    return out.index_add_(0, seg, src)
def _pad(x, pw):
    flat = tuple(v for pair in reversed(pw) for v in pair)
    return torch.nn.functional.pad(x, flat)

kernel_name = 'sequential_preLN__mha_block__glu_gated_bilinear__prompt'

def setup_inputs():

    _w = (lambda a: (lambda t: t.to(torch.bfloat16) if t.is_floating_point() else t)(torch.as_tensor(a)))
    def _A_setup():
        B, S, D, H = 1, 2048, 640, 32
        return {
            "x": _w((lambda *s: torch.randn(*s, dtype=torch.bfloat16) * 0.05)(B, S, D)),
            "wqkv": _w((lambda *s: torch.randn(*s, dtype=torch.bfloat16) * 0.05)(D, 3 * D)),
            "wo": _w((lambda *s: torch.randn(*s, dtype=torch.bfloat16) * 0.05)(D, D)),
        }
    _A_in = _A_setup()

    def _B_setup():
        B, S, D, F = 1, 2048, 640, 1536
        return {
            "x": _w((lambda *s: torch.randn(*s, dtype=torch.bfloat16) * 0.05)(B, S, D)),
            "w_gate": _w((lambda *s: torch.randn(*s, dtype=torch.bfloat16) * 0.8)(D, F) * (D ** -0.5)),
            "w_up": _w((lambda *s: torch.randn(*s, dtype=torch.bfloat16) * 0.8)(D, F) * (D ** -0.5)),
            "w_down": _w((lambda *s: torch.randn(*s, dtype=torch.bfloat16) * 0.8)(F, D) * (F ** -0.5)),
        }
    _B_in = _B_setup()

    return {
        "A_x": _A_in["x"],
        "A_wqkv": _A_in["wqkv"],
        "A_wo": _A_in["wo"],
        "B_x": _B_in["x"],
        "B_w_gate": _B_in["w_gate"],
        "B_w_up": _B_in["w_up"],
        "B_w_down": _B_in["w_down"],
    }

def reference(A_x, A_wqkv, A_wo, B_x, B_w_gate, B_w_up, B_w_down):
    def _A_ref(x, wqkv, wo):
        B, S, D = x.shape
        H = 32
        Dh = D // H
        qkv = (lambda x, *d: x.permute(*d))((x @ wqkv).reshape(B, S, 3, H, Dh), 2, 0, 3, 1, 4)
        q, k, v = qkv[0], qkv[1], qkv[2]
        scores = torch.einsum("bhqd,bhkd->bhqk", q, k) * (Dh ** -0.5)
        p = _softmax(scores, axis=-1)
        o = torch.einsum("bhqk,bhkd->bhqd", p, v)
        return (lambda x, *d: x.permute(*d))(o, 0, 2, 1, 3).reshape(B, S, D) @ wo

    def _B_ref(x, w_gate, w_up, w_down):
        g = torch.einsum("bsd,df->bsf", x, w_gate)
        u = torch.einsum("bsd,df->bsf", x, w_up)
        h = g * u
        return torch.einsum("bsf,fd->bsd", h, w_down)

    x = A_x
    h = x + _A_ref(_layernorm(x, axis=-1), A_wqkv, A_wo)
    h2 = h + _B_ref(_layernorm(h, axis=-1), B_w_gate, B_w_up, B_w_down)
    return h2
```

```asm
; @launch kernel=mk_attn_ffn_kernel grid=(256,1,1) block=(256,1,1) lds=163840
.amdgcn_target "amdgcn-amd-amdhsa--gfx950"
.text
.globl mk_attn_ffn_kernel
.p2align 8
.type mk_attn_ffn_kernel,@function
mk_attn_ffn_kernel:
  s_load_dwordx4 s[4:7], s[0:1], 0
  s_load_dwordx2 s[48:49], s[0:1], 64
  s_load_dwordx2 s[50:51], s[0:1], 16
  s_load_dwordx4 s[52:55], s[0:1], 32
  s_load_dwordx2 s[56:57], s[0:1], 48
  s_memrealtime s[100:101]
  s_load_dwordx2 s[24:25], s[0:1], 72
  s_cmp_ge_u32 s2, 256
  s_cbranch_scc1 L_mkdone_1
  v_lshrrev_b32 v9, 6, v0
  v_and_b32 v1, 63, v0
  s_and_b32 s26, s2, 7
  v_readfirstlane_b32 s28, v9
  s_lshr_b32 s27, s2, 3
  s_xor_b32 s33, s28, 3
  s_lshl_b32 s33, s33, 5
  s_add_u32 s33, s33, s27
  s_lshl_b32 s34, s33, 13
  s_cmp_ge_u32 s34, L_mk_end-mk_attn_ffn_kernel
  s_cbranch_scc1 L_npf_3
  s_getpc_b64 s[94:95]
L_pc_2:
  s_sub_u32 s94, s94, L_pc_2-mk_attn_ffn_kernel
  s_subb_u32 s95, s95, 0
  v_lshl_add_u32 v2, v1, 7, s34
  v_min_u32 v2, L_mk_end-mk_attn_ffn_kernel-4, v2
  global_load_dword v2, v2, s[94:95]
L_npf_3:
  s_lshr_b32 s92, s27, 1
  s_and_b32 s93, s27, 1
  v_lshrrev_b32 v131, 5, v1
  v_lshlrev_b32 v131, 5, v131
  v_bfe_u32 v132, v1, 3, 1
  v_add_u32 v131, v131, v132
  v_and_b32 v132, 16, v1
  v_add_u32 v131, v131, v132
  s_lshr_b32 s42, s28, 1
  s_and_b32 s43, s28, 1
  s_lshl_b32 s33, s42, 6
  s_lshl_b32 s34, s43, 3
  s_add_u32 s33, s33, s34
  v_add_u32 v131, s33, v131
  v_mul_u32_u24 v131, 1280, v131
  v_and_b32 v132, 7, v1
  v_lshl_add_u32 v4, v132, 4, v131
  v_add_u32 v5, 1520, v4
  v_add_u32 v6, 3040, v4
  v_add_u32 v7, 4560, v4
  v_lshrrev_b32 v131, 4, v1
  v_lshlrev_b32 v132, 2, v131
  v_and_b32 v133, 15, v1
  v_xor_b32 v132, v132, v133
  s_cmp_eq_u32 s93, 0
  s_cselect_b32 s34, 10, 4
  s_cselect_b32 s35, 15, 13
  s_lshl_b32 s33, s28, 4
  v_add_u32 v131, s33, v131
  v_mul_u32_u24 v131, 3840, v131
  v_cmp_le_u32 vcc, s34, v132
  v_add_u32 v133, 1120, v131
  v_min_u32 v132, s35, v132
  v_cndmask_b32 v131, v131, v133, vcc
  v_lshl_add_u32 v8, v132, 4, v131
  v_add_u32 v9, 14336, v8
  v_add_u32 v10, 28672, v8
  v_add_u32 v11, 43008, v8
  s_mul_i32 s62, s92, 3
  s_mul_i32 s33, s93, 0
  s_add_u32 s62, s62, s33
  s_mul_i32 s33, s26, 1
  s_add_u32 s62, s62, s33
  s_mul_i32 s33, s62, 205
  s_lshr_b32 s33, s33, 11
  s_mul_i32 s33, s33, 10
  s_sub_u32 s62, s62, s33
  s_mul_i32 s63, s92, 163840
  s_mul_i32 s29, s26, 160
  s_mul_i32 s33, s93, 1376
  s_add_u32 s29, s29, s33
  s_mul_i32 s60, s28, 4160
  s_lshl_b32 s61, s28, 12
  s_add_u32 s61, s61, 16640
  v_mov_b32 v139, 0
  s_waitcnt lgkmcnt(0)
  s_mov_b32 s12, s4
  s_mov_b32 s13, s5
  s_mov_b32 s14, 2621440
  s_mov_b32 s15, 0x20000
  s_mov_b32 s16, s6
  s_mov_b32 s17, s7
  s_mov_b32 s18, 2457600
  s_mov_b32 s19, 0x20000
  s_or_b32 s33, s2, s28
  s_cbranch_scc1 L_ntag_4
  s_lshl_b32 s100, s100, 5
  s_or_b32 s100, s100, 16
  v_mov_b32 v131, s100
  s_mov_b64 exec, 1
  global_store_dword v139, v131, s[48:49] sc0 sc1
  s_mov_b64 exec, -1
L_ntag_4:
  s_add_u32 m0, s60, 0
  s_lshl_b32 s37, s62, 7
  s_add_u32 s37, s37, s63
  s_mul_i32 s38, s62, 245760
  s_add_u32 s38, s38, s29
  s_add_u32 s62, s62, 1
  s_cmp_eq_u32 s62, 10
  s_cselect_b32 s62, 0, s62
  buffer_load_dwordx4 v4, s[12:15], s37 offen offset:0 lds
  buffer_load_dwordx4 v5, s[12:15], s37 offen offset:1040 lds
  buffer_load_dwordx4 v6, s[12:15], s37 offen offset:2080 lds
  buffer_load_dwordx4 v7, s[12:15], s37 offen offset:3120 lds
  s_add_u32 m0, s61, 0
  s_nop 0
  buffer_load_dwordx4 v8, s[16:19], s38 offen offset:0 lds
  buffer_load_dwordx4 v9, s[16:19], s38 offen offset:1024 lds
  buffer_load_dwordx4 v10, s[16:19], s38 offen offset:2048 lds
  buffer_load_dwordx4 v11, s[16:19], s38 offen offset:3072 lds
  s_mov_b32 s8, s24
  s_mov_b32 s9, s25
  s_mov_b32 s10, 33554432
  s_mov_b32 s11, 0x20000
  s_lshl_b32 s101, s27, 2
  s_add_u32 s101, s101, s28
  s_lshl_b32 s58, s101, 3
  s_add_u32 s58, s58, s26
  s_add_u32 s59, s58, 480
  s_sub_u32 s33, s101, 60
  s_mul_i32 s34, s33, 205
  s_lshr_b32 s34, s34, 10
  s_mul_i32 s34, s34, 70
  s_lshl_b32 s33, s33, 1
  s_add_u32 s34, s34, s33
  s_mul_i32 s33, s26, 10
  s_add_u32 s34, s34, s33
  s_add_u32 s34, s34, 960
  s_add_u32 s35, s34, 1
  s_cmp_ge_u32 s101, 60
  s_cselect_b32 s58, s34, s58
  s_cselect_b32 s59, s35, s59
  v_lshrrev_b32 v131, 4, v1
  v_and_b32 v132, 15, v1
  s_cmp_ge_u32 s58, 960
  s_cbranch_scc1 L_lod_5
  s_cmp_ge_u32 s58, 480
  s_cselect_b32 s20, s54, s52
  s_cselect_b32 s21, s55, s53
  s_cselect_b32 s36, 32, 0
  s_cselect_b32 s33, 480, 0
  s_sub_u32 s33, s58, s33
  s_mul_i32 s34, s33, 2731
  s_lshr_b32 s34, s34, 16
  s_mul_i32 s35, s34, 24
  s_sub_u32 s33, s33, s35
  s_mov_b32 s22, 1966080
  s_mov_b32 s94, 3072
  s_mov_b32 s31, 64
  s_mov_b32 s30, 3
  s_add_u32 s36, s36, 24117248
  v_lshrrev_b32 v133, 1, v132
  v_mul_u32_u24 v204, 20480, v133
  v_and_b32 v133, 1, v132
  v_lshl_add_u32 v204, v133, 7, v204
  s_mul_i32 s35, s33, 163840
  s_add_u32 s36, s36, s35
  s_lshl_b32 s35, s34, 10
  s_add_u32 s36, s36, s35
  s_branch L_perm_7
L_lod_5:
  s_cmp_ge_u32 s58, 1440
  s_cselect_b32 s20, s50, s56
  s_cselect_b32 s21, s51, s57
  s_cselect_b32 s33, 480, 0
  s_cselect_b32 s36, 20, 48
  s_cselect_b32 s95, 0, 5242880
  s_sub_u32 s33, s58, s33
  s_sub_u32 s33, s33, 960
  s_mul_i32 s22, s36, 40960
  s_mul_i32 s34, s33, 6554
  s_lshr_b32 s34, s34, 16
  s_mul_i32 s35, s34, 10
  s_sub_u32 s33, s33, s35
  s_mov_b32 s94, 1280
  s_mov_b32 s31, 32
  s_mov_b32 s30, 2
  s_lshl_b32 s35, s33, 4
  v_add_u32 v133, s35, v132
  v_mul_u32_u24 v134, 205, v133
  v_lshrrev_b32 v134, 10, v134
  v_mad_i32_i24 v133, v134, -5, v133
  v_lshlrev_b32 v204, 10, v133
  v_and_b32 v133, 3, v134
  v_lshl_add_u32 v204, v133, 6, v204
  v_lshrrev_b32 v134, 2, v134
  s_mul_i32 s36, s36, 5120
  v_mad_u32_u24 v204, v134, s36, v204
  s_mul_i32 s36, s34, 5120
  s_add_u32 s36, s36, s95
  s_add_u32 s36, s36, 23068672
  s_cmp_lt_u32 s58, 1440
  s_cbranch_scc1 L_wd_6
L_perm_7:
  s_lshl_b32 s34, s34, 2
  v_add_u32 v133, s34, v131
  v_mul_u32_u24 v134, 205, v133
  v_lshrrev_b32 v134, 10, v134
  v_mad_i32_i24 v133, v134, -5, v133
  v_mul_u32_u24 v240, 40, v134
  v_lshrrev_b32 v134, 1, v133
  v_mad_u32_u24 v240, v134, 20, v240
  v_and_b32 v134, 1, v133
  v_lshl_add_u32 v240, v134, s30, v240
  v_lshrrev_b32 v134, 2, v133
  v_mul_u32_u24 v133, 24, v134
  v_sub_u32 v240, v240, v133
  s_lshl_b32 s34, 1, s30
  s_add_u32 s35, s34, 8
  s_sub_u32 s34, 12, s34
  v_mad_u32_u24 v241, v134, s35, v240
  v_add_u32 v241, s34, v241
  s_branch L_ld_8
L_wd_6:
  s_lshl_b32 s34, s34, 5
  v_lshl_add_u32 v240, v131, 3, s34
  v_add_u32 v241, 4, v240
L_ld_8:
  s_mov_b32 s23, 0x20000
  s_lshl_b32 s33, s33, 7
  v_lshl_add_u32 v132, v132, 3, s33
  v_mad_u32_u24 v240, v240, s94, v132
  v_mad_u32_u24 v241, v241, s94, v132
  v_lshl_add_u32 v204, v131, 4, v204
  v_add_u32 v204, s36, v204
  s_lshl_b32 s95, s94, 1
  s_add_u32 s96, s95, s94
  v_lshrrev_b32 v131, 4, v1
  v_and_b32 v132, 15, v1
  s_cmp_ge_u32 s59, 960
  s_cbranch_scc1 L_lod_9
  s_cmp_ge_u32 s59, 480
  s_cselect_b32 s44, s54, s52
  s_cselect_b32 s45, s55, s53
  s_cselect_b32 s36, 32, 0
  s_cselect_b32 s33, 480, 0
  s_sub_u32 s33, s59, s33
  s_mul_i32 s34, s33, 2731
  s_lshr_b32 s34, s34, 16
  s_mul_i32 s35, s34, 24
  s_sub_u32 s33, s33, s35
  s_mov_b32 s46, 1966080
  s_mov_b32 s97, 3072
  s_mov_b32 s31, 64
  s_mov_b32 s30, 3
  s_add_u32 s36, s36, 24117248
  v_lshrrev_b32 v133, 1, v132
  v_mul_u32_u24 v205, 20480, v133
  v_and_b32 v133, 1, v132
  v_lshl_add_u32 v205, v133, 7, v205
  s_mul_i32 s35, s33, 163840
  s_add_u32 s36, s36, s35
  s_lshl_b32 s35, s34, 10
  s_add_u32 s36, s36, s35
  s_branch L_perm_11
L_lod_9:
  s_cmp_ge_u32 s59, 1440
  s_cselect_b32 s44, s50, s56
  s_cselect_b32 s45, s51, s57
  s_cselect_b32 s33, 480, 0
  s_cselect_b32 s36, 20, 48
  s_cselect_b32 s98, 0, 5242880
  s_sub_u32 s33, s59, s33
  s_sub_u32 s33, s33, 960
  s_mul_i32 s46, s36, 40960
  s_mul_i32 s34, s33, 6554
  s_lshr_b32 s34, s34, 16
  s_mul_i32 s35, s34, 10
  s_sub_u32 s33, s33, s35
  s_mov_b32 s97, 1280
  s_mov_b32 s31, 32
  s_mov_b32 s30, 2
  s_lshl_b32 s35, s33, 4
  v_add_u32 v133, s35, v132
  v_mul_u32_u24 v134, 205, v133
  v_lshrrev_b32 v134, 10, v134
  v_mad_i32_i24 v133, v134, -5, v133
  v_lshlrev_b32 v205, 10, v133
  v_and_b32 v133, 3, v134
  v_lshl_add_u32 v205, v133, 6, v205
  v_lshrrev_b32 v134, 2, v134
  s_mul_i32 s36, s36, 5120
  v_mad_u32_u24 v205, v134, s36, v205
  s_mul_i32 s36, s34, 5120
  s_add_u32 s36, s36, s98
  s_add_u32 s36, s36, 23068672
  s_cmp_lt_u32 s59, 1440
  s_cbranch_scc1 L_wd_10
L_perm_11:
  s_lshl_b32 s34, s34, 2
  v_add_u32 v133, s34, v131
  v_mul_u32_u24 v134, 205, v133
  v_lshrrev_b32 v134, 10, v134
  v_mad_i32_i24 v133, v134, -5, v133
  v_mul_u32_u24 v242, 40, v134
  v_lshrrev_b32 v134, 1, v133
  v_mad_u32_u24 v242, v134, 20, v242
  v_and_b32 v134, 1, v133
  v_lshl_add_u32 v242, v134, s30, v242
  v_lshrrev_b32 v134, 2, v133
  v_mul_u32_u24 v133, 24, v134
  v_sub_u32 v242, v242, v133
  s_lshl_b32 s34, 1, s30
  s_add_u32 s35, s34, 8
  s_sub_u32 s34, 12, s34
  v_mad_u32_u24 v243, v134, s35, v242
  v_add_u32 v243, s34, v243
  s_branch L_ld_12
L_wd_10:
  s_lshl_b32 s34, s34, 5
  v_lshl_add_u32 v242, v131, 3, s34
  v_add_u32 v243, 4, v242
L_ld_12:
  s_mov_b32 s47, 0x20000
  s_lshl_b32 s33, s33, 7
  v_lshl_add_u32 v132, v132, 3, s33
  v_mad_u32_u24 v242, v242, s97, v132
  v_mad_u32_u24 v243, v243, s97, v132
  v_lshl_add_u32 v205, v131, 4, v205
  v_add_u32 v205, s36, v205
  s_lshl_b32 s98, s97, 1
  s_add_u32 s99, s98, s97
  s_cmp_ge_u32 s101, 60
  s_cselect_b64 vcc, 0, -1
  v_add_u32 v131, 64, v204
  s_cmp_ge_u32 s58, 1640
  s_cselect_b32 s22, 0, s22
  s_cselect_b32 s46, 0, s46
  s_cselect_b32 s33, 33554432, 0
  v_cndmask_b32 v205, v205, v131, vcc
  v_or_b32 v204, s33, v204
  v_or_b32 v205, s33, v205
  s_mul_i32 s34, s26, 1114112
  v_min_u32 v131, 63, v1
  s_mul_i32 s33, s101, 7680
  s_add_u32 s33, s33, s34
  v_lshl_add_u32 v128, v131, 7, s33
  s_add_u32 s33, s28, 2
  s_mul_i32 s33, s33, 163840
  s_add_u32 s33, s33, s34
  s_lshl_b32 s35, s27, 10
  s_add_u32 s33, s33, s35
  s_sub_u32 s33, s33, 7680
  v_lshl_add_u32 v132, v131, 7, s33
  v_cmp_lt_u32 vcc, 59, v1
  s_lshl_b32 s33, s26, 9
  s_add_u32 s33, s33, 32511488
  v_cndmask_b32 v128, v128, v132, vcc
  v_lshl_add_u32 v132, v131, 7, s33
  v_cmp_lt_u32 vcc, 59, v131
  v_cndmask_b32 v128, v128, v132, vcc
  s_add_u32 m0, s60, 33024
  s_lshl_b32 s37, s62, 7
  s_add_u32 s37, s37, s63
  s_mul_i32 s38, s62, 245760
  s_add_u32 s38, s38, s29
  s_add_u32 s62, s62, 1
  s_cmp_eq_u32 s62, 10
  s_cselect_b32 s62, 0, s62
  buffer_load_dwordx4 v4, s[12:15], s37 offen offset:0 lds
  buffer_load_dwordx4 v5, s[12:15], s37 offen offset:1040 lds
  buffer_load_dwordx4 v6, s[12:15], s37 offen offset:2080 lds
  buffer_load_dwordx4 v7, s[12:15], s37 offen offset:3120 lds
  s_mov_b32 s39, 66048
  s_mov_b32 s40, 0
  v_and_b32 v129, 31, v1
  v_lshrrev_b32 v130, 5, v1
  s_lshl_b32 s34, s26, 7
  s_add_u32 s34, s34, 32505856
  v_lshl_add_u32 v137, v129, 2, s34
  v_bfe_u32 v131, v129, 1, 3
  v_mul_u32_u24 v131, 1040, v131
  v_and_b32 v132, 1, v129
  v_lshl_add_u32 v131, v132, 7, v131
  v_lshrrev_b32 v132, 4, v129
  v_lshl_add_u32 v131, v132, 8, v131
  v_lshl_add_u32 v131, v130, 4, v131
  s_mul_i32 s33, s42, 8320
  s_lshl_b32 s34, s43, 9
  s_add_u32 s35, s33, s34
  v_add_u32 v12, s35, v131
  s_xor_b32 s34, s34, 512
  s_add_u32 s35, s33, s34
  v_add_u32 v13, s35, v131
  v_bfe_u32 v131, v1, 2, 2
  v_lshl_add_u32 v132, v130, 3, v131
  v_lshlrev_b32 v132, 8, v132
  v_bfe_u32 v133, v1, 4, 1
  v_lshl_add_u32 v132, v133, 5, v132
  v_and_b32 v133, 3, v1
  v_lshl_add_u32 v132, v133, 3, v132
  v_add_u32 v132, 16640, v132
  s_lshl_b32 s33, s43, 1
  s_add_u32 s33, s33, s42
  v_xor_b32 v133, s33, v131
  v_lshl_add_u32 v14, v133, 6, v132
  v_xor_b32 v133, 1, v133
  v_lshl_add_u32 v15, v133, 6, v132
  v_mov_b32 v16, v12
  v_mov_b32 v18, v14
  v_mov_b32 v17, v13
  v_mov_b32 v19, v15
  v_mov_b32 v206, 0
  v_mov_b32 v207, 0
  v_mov_b32 v208, 0
  v_mov_b32 v209, 0
  v_mov_b32 v210, 0
  v_mov_b32 v211, 0
  v_mov_b32 v212, 0
  v_mov_b32 v213, 0
  v_mov_b32 v214, 0
  v_mov_b32 v215, 0
  v_lshrrev_b32 v131, 2, v1
  v_xor_b32 v131, v131, v1
  v_bfe_i32 v131, v131, 2, 1
  v_mov_b32 v20, 0x3f803f80
  v_bfi_b32 v20, v131, 0, v20
  v_mov_b32 v21, v20
  v_mov_b32 v22, v20
  v_mov_b32 v23, v20
  s_mov_b32 s3, 0xffff0000
  v_mov_b32 v64, 0
  v_mov_b32 v65, 0
  v_mov_b32 v66, 0
  v_mov_b32 v67, 0
  v_mov_b32 v68, 0
  v_mov_b32 v69, 0
  v_mov_b32 v70, 0
  v_mov_b32 v71, 0
  v_mov_b32 v72, 0
  v_mov_b32 v73, 0
  v_mov_b32 v74, 0
  v_mov_b32 v75, 0
  v_mov_b32 v76, 0
  v_mov_b32 v77, 0
  v_mov_b32 v78, 0
  v_mov_b32 v79, 0
  v_mov_b32 v80, 0
  v_mov_b32 v81, 0
  v_mov_b32 v82, 0
  v_mov_b32 v83, 0
  v_mov_b32 v84, 0
  v_mov_b32 v85, 0
  v_mov_b32 v86, 0
  v_mov_b32 v87, 0
  v_mov_b32 v88, 0
  v_mov_b32 v89, 0
  v_mov_b32 v90, 0
  v_mov_b32 v91, 0
  v_mov_b32 v92, 0
  v_mov_b32 v93, 0
  v_mov_b32 v94, 0
  v_mov_b32 v95, 0
  v_mov_b32 v96, 0
  v_mov_b32 v97, 0
  v_mov_b32 v98, 0
  v_mov_b32 v99, 0
  v_mov_b32 v100, 0
  v_mov_b32 v101, 0
  v_mov_b32 v102, 0
  v_mov_b32 v103, 0
  v_mov_b32 v104, 0
  v_mov_b32 v105, 0
  v_mov_b32 v106, 0
  v_mov_b32 v107, 0
  v_mov_b32 v108, 0
  v_mov_b32 v109, 0
  v_mov_b32 v110, 0
  v_mov_b32 v111, 0
  v_mov_b32 v112, 0
  v_mov_b32 v113, 0
  v_mov_b32 v114, 0
  v_mov_b32 v115, 0
  v_mov_b32 v116, 0
  v_mov_b32 v117, 0
  v_mov_b32 v118, 0
  v_mov_b32 v119, 0
  v_mov_b32 v120, 0
  v_mov_b32 v121, 0
  v_mov_b32 v122, 0
  v_mov_b32 v123, 0
  v_mov_b32 v124, 0
  v_mov_b32 v125, 0
  v_mov_b32 v126, 0
  v_mov_b32 v127, 0
  s_getreg_b32 s32, hwreg(HW_REG_XCC_ID)
  s_and_b32 s32, s32, 15
  s_lshl_b32 s33, s92, 2
  s_add_u32 s58, s33, s28
  s_xor_b32 s59, s58, 1
  s_mul_i32 s34, s26, 1114112
  s_mul_i32 s58, s58, 2560
  s_mul_i32 s59, s59, 2560
  s_add_u32 s58, s58, s34
  s_add_u32 s59, s59, s34
  s_mov_b32 s41, 0
  s_lshl_b32 s36, s93, 1
  s_add_u32 s36, s36, s43
  s_lshl_b32 s36, s36, 1
  s_add_u32 s36, s36, s42
  s_cmp_ge_u32 s36, 6
  s_cbranch_scc1 L_pv_14
  s_cmp_eq_u32 s36, 4
  s_cbranch_scc1 L_pqv_15
  s_cmp_eq_u32 s36, 5
  s_cbranch_scc1 L_pvq_16
  s_lshl_b32 s33, s36, 3
  s_mov_b32 s35, 162560
  s_mov_b32 s34, 161280
  v_lshlrev_b32 v133, 3, v129
  v_add3_u32 v131, s33, v130, 0
  v_mul_u32_u24 v132, 205, v131
  v_lshrrev_b32 v132, 10, v132
  v_lshl_add_u32 v24, v131, 8, v133
  v_mul_u32_u24 v131, s35, v132
  v_lshrrev_b32 v132, 1, v132
  v_subrev_u32 v131, 327680, v131
  v_mul_u32_u24 v132, s34, v132
  v_max_i32 v131, v131, v132
  v_add_u32 v24, v131, v24
  v_add3_u32 v131, s33, v130, 2
  v_mul_u32_u24 v132, 205, v131
  v_lshrrev_b32 v132, 10, v132
  v_lshl_add_u32 v25, v131, 8, v133
  v_mul_u32_u24 v131, s35, v132
  v_lshrrev_b32 v132, 1, v132
  v_subrev_u32 v131, 327680, v131
  v_mul_u32_u24 v132, s34, v132
  v_max_i32 v131, v131, v132
  v_add_u32 v25, v131, v25
  v_add3_u32 v131, s33, v130, 4
  v_mul_u32_u24 v132, 205, v131
  v_lshrrev_b32 v132, 10, v132
  v_lshl_add_u32 v26, v131, 8, v133
  v_mul_u32_u24 v131, s35, v132
  v_lshrrev_b32 v132, 1, v132
  v_subrev_u32 v131, 327680, v131
  v_mul_u32_u24 v132, s34, v132
  v_max_i32 v131, v131, v132
  v_add_u32 v26, v131, v26
  v_add3_u32 v131, s33, v130, 6
  v_mul_u32_u24 v132, 205, v131
  v_lshrrev_b32 v132, 10, v132
  v_lshl_add_u32 v27, v131, 8, v133
  v_mul_u32_u24 v131, s35, v132
  v_lshrrev_b32 v132, 1, v132
  v_subrev_u32 v131, 327680, v131
  v_mul_u32_u24 v132, s34, v132
  v_max_i32 v131, v131, v132
  v_add_u32 v27, v131, v27
  s_xor_b32 s36, s36, 1
  s_lshl_b32 s33, s36, 3
  s_mov_b32 s35, 162560
  s_mov_b32 s34, 161280
  v_lshlrev_b32 v133, 3, v129
  v_add3_u32 v131, s33, v130, 0
  v_mul_u32_u24 v132, 205, v131
  v_lshrrev_b32 v132, 10, v132
  v_lshl_add_u32 v28, v131, 8, v133
  v_mul_u32_u24 v131, s35, v132
  v_lshrrev_b32 v132, 1, v132
  v_subrev_u32 v131, 327680, v131
  v_mul_u32_u24 v132, s34, v132
  v_max_i32 v131, v131, v132
  v_add_u32 v28, v131, v28
  v_add3_u32 v131, s33, v130, 2
  v_mul_u32_u24 v132, 205, v131
  v_lshrrev_b32 v132, 10, v132
  v_lshl_add_u32 v29, v131, 8, v133
  v_mul_u32_u24 v131, s35, v132
  v_lshrrev_b32 v132, 1, v132
  v_subrev_u32 v131, 327680, v131
  v_mul_u32_u24 v132, s34, v132
  v_max_i32 v131, v131, v132
  v_add_u32 v29, v131, v29
  v_add3_u32 v131, s33, v130, 4
  v_mul_u32_u24 v132, 205, v131
  v_lshrrev_b32 v132, 10, v132
  v_lshl_add_u32 v30, v131, 8, v133
  v_mul_u32_u24 v131, s35, v132
  v_lshrrev_b32 v132, 1, v132
  v_subrev_u32 v131, 327680, v131
  v_mul_u32_u24 v132, s34, v132
  v_max_i32 v131, v131, v132
  v_add_u32 v30, v131, v30
  v_add3_u32 v131, s33, v130, 6
  v_mul_u32_u24 v132, 205, v131
  v_lshrrev_b32 v132, 10, v132
  v_lshl_add_u32 v31, v131, 8, v133
  v_mul_u32_u24 v131, s35, v132
  v_lshrrev_b32 v132, 1, v132
  v_subrev_u32 v131, 327680, v131
  v_mul_u32_u24 v132, s34, v132
  v_max_i32 v131, v131, v132
  v_add_u32 v31, v131, v31
  s_add_u32 m0, s61, 33024
  s_nop 0
  buffer_load_dwordx4 v8, s[16:19], s38 offen offset:0 lds
  buffer_load_dwordx4 v9, s[16:19], s38 offen offset:1024 lds
  buffer_load_dwordx4 v10, s[16:19], s38 offen offset:2048 lds
  buffer_load_dwordx4 v11, s[16:19], s38 offen offset:3072 lds
  s_lshl_b32 s37, s62, 7
  s_add_u32 s37, s37, s63
  s_mul_i32 s38, s62, 245760
  s_add_u32 s38, s38, s29
  s_add_u32 s62, s62, 1
  s_cmp_eq_u32 s62, 10
  s_cselect_b32 s62, 0, s62
  global_load_dword v135, v139, s[48:49] sc1
  s_cmp_lg_u32 s28, 2
  s_cbranch_scc1 L_ntw_22
  s_load_dwordx2 s[6:7], s[0:1], 56
  v_lshlrev_b32 v138, 21, v1
  v_and_b32 v140, 0x200000, v138
  buffer_load_dword v254, v138, s[8:11], 0 offen sc1
  global_load_dword v254, v139, s[50:51]
  global_load_dword v254, v139, s[52:53]
  global_load_dword v254, v139, s[54:55]
  global_load_dword v254, v139, s[56:57]
  s_waitcnt lgkmcnt(0)
  global_load_dword v254, v140, s[6:7] sc1
L_ntw_22:
  s_cmp_eq_u32 s28, 2
  s_waitcnt vmcnt(15)
  s_cbranch_scc1 L_qfw_23
  s_waitcnt vmcnt(9)
L_qfw_23:
  s_barrier
  ds_read_b128 v[32:35], v16 offset:0
  ds_read_b64_tr_b16 v[48:49], v18 offset:0
  ds_read_b64_tr_b16 v[50:51], v18 offset:1024
  ds_read_b128 v[36:39], v17 offset:0
  ds_read_b64_tr_b16 v[52:53], v19 offset:0
  ds_read_b64_tr_b16 v[54:55], v19 offset:1024
.p2align 6
L_qloop_17:
  s_waitcnt lgkmcnt(0)
  s_add_u32 m0, s60, s39
  v_mfma_f32_32x32x16_bf16 v[64:79], v[48:51], v[32:35], v[64:79]
  ds_read_b128 v[40:43], v16 offset:32
  ds_read_b64_tr_b16 v[56:57], v18 offset:4096
  ds_read_b64_tr_b16 v[58:59], v18 offset:5120
  v_lshlrev_b32 v216, 16, v32
  v_and_b32 v217, s3, v32
  v_lshlrev_b32 v218, 16, v33
  v_mfma_f32_32x32x16_bf16 v[80:95], v[52:55], v[32:35], v[80:95]
  ds_read_b128 v[44:47], v17 offset:32
  ds_read_b64_tr_b16 v[60:61], v19 offset:4096
  ds_read_b64_tr_b16 v[62:63], v19 offset:5120
  buffer_load_dwordx4 v4, s[12:15], s37 offen offset:0 lds
  buffer_load_dwordx4 v5, s[12:15], s37 offen offset:1040 lds
  v_and_b32 v219, s3, v33
  v_fmac_f32 v206, v216, v216
  v_mfma_f32_16x16x32_bf16 v[212:215], v[20:23], v[48:51], v[212:215]
  v_fmac_f32 v207, v217, v217
  v_lshlrev_b32 v220, 16, v34
  v_mfma_f32_32x32x16_bf16 v[96:111], v[48:51], v[36:39], v[96:111]
  buffer_load_dwordx4 v6, s[12:15], s37 offen offset:2080 lds
  v_and_b32 v221, s3, v34
  v_fmac_f32 v206, v218, v218
  v_fmac_f32 v207, v219, v219
  v_lshlrev_b32 v222, 16, v35
  v_and_b32 v223, s3, v35
  v_mfma_f32_32x32x16_bf16 v[112:127], v[52:55], v[36:39], v[112:127]
  v_fmac_f32 v206, v220, v220
  v_fmac_f32 v207, v221, v221
  v_fmac_f32 v206, v222, v222
  v_fmac_f32 v207, v223, v223
  buffer_load_dwordx4 v7, s[12:15], s37 offen offset:3120 lds
  s_add_u32 m0, s61, s39
  v_mfma_f32_16x16x32_bf16 v[208:211], v[20:23], v[32:35], v[208:211]
  s_waitcnt lgkmcnt(0)
  v_mfma_f32_32x32x16_bf16 v[64:79], v[56:59], v[40:43], v[64:79]
  ds_read_b128 v[32:35], v16 offset:64
  ds_read_b64_tr_b16 v[48:49], v18 offset:8192
  ds_read_b64_tr_b16 v[50:51], v18 offset:9216
  v_lshlrev_b32 v216, 16, v40
  v_and_b32 v217, s3, v40
  v_lshlrev_b32 v218, 16, v41
  v_mfma_f32_32x32x16_bf16 v[80:95], v[60:63], v[40:43], v[80:95]
  ds_read_b128 v[36:39], v17 offset:64
  ds_read_b64_tr_b16 v[52:53], v19 offset:8192
  ds_read_b64_tr_b16 v[54:55], v19 offset:9216
  buffer_load_dwordx4 v8, s[16:19], s38 offen offset:0 lds
  buffer_load_dwordx4 v9, s[16:19], s38 offen offset:1024 lds
  v_and_b32 v219, s3, v41
  v_fmac_f32 v206, v216, v216
  v_mfma_f32_16x16x32_bf16 v[212:215], v[20:23], v[56:59], v[212:215]
  v_fmac_f32 v207, v217, v217
  v_lshlrev_b32 v220, 16, v42
  v_mfma_f32_32x32x16_bf16 v[96:111], v[56:59], v[44:47], v[96:111]
  buffer_load_dwordx4 v10, s[16:19], s38 offen offset:2048 lds
  v_and_b32 v221, s3, v42
  v_fmac_f32 v206, v218, v218
  v_fmac_f32 v207, v219, v219
  v_lshlrev_b32 v222, 16, v43
  v_and_b32 v223, s3, v43
  v_mfma_f32_32x32x16_bf16 v[112:127], v[60:63], v[44:47], v[112:127]
  v_fmac_f32 v206, v220, v220
  v_fmac_f32 v207, v221, v221
  v_fmac_f32 v206, v222, v222
  v_fmac_f32 v207, v223, v223
  buffer_load_dwordx4 v11, s[16:19], s38 offen offset:3072 lds
  s_mov_b32 s39, s40
  v_mfma_f32_16x16x32_bf16 v[208:211], v[20:23], v[40:43], v[208:211]
  s_waitcnt lgkmcnt(0)
  v_mfma_f32_32x32x16_bf16 v[64:79], v[48:51], v[32:35], v[64:79]
  ds_read_b128 v[40:43], v16 offset:96
  ds_read_b64_tr_b16 v[56:57], v18 offset:12288
  ds_read_b64_tr_b16 v[58:59], v18 offset:13312
  v_lshlrev_b32 v216, 16, v32
  v_and_b32 v217, s3, v32
  v_lshlrev_b32 v218, 16, v33
  v_mfma_f32_32x32x16_bf16 v[80:95], v[52:55], v[32:35], v[80:95]
  ds_read_b128 v[44:47], v17 offset:96
  ds_read_b64_tr_b16 v[60:61], v19 offset:12288
  ds_read_b64_tr_b16 v[62:63], v19 offset:13312
  s_add_u32 s40, s40, 33024
  s_cmp_eq_u32 s40, 99072
  s_cselect_b32 s40, 0, s40
  v_and_b32 v219, s3, v33
  v_fmac_f32 v206, v216, v216
  v_mfma_f32_16x16x32_bf16 v[212:215], v[20:23], v[48:51], v[212:215]
  v_fmac_f32 v207, v217, v217
  v_lshlrev_b32 v220, 16, v34
  v_mfma_f32_32x32x16_bf16 v[96:111], v[48:51], v[36:39], v[96:111]
  s_add_u32 s41, s41, 1
  v_and_b32 v221, s3, v34
  v_fmac_f32 v206, v218, v218
  v_fmac_f32 v207, v219, v219
  v_lshlrev_b32 v222, 16, v35
  v_and_b32 v223, s3, v35
  v_mfma_f32_32x32x16_bf16 v[112:127], v[52:55], v[36:39], v[112:127]
  v_fmac_f32 v206, v220, v220
  v_fmac_f32 v207, v221, v221
  v_fmac_f32 v206, v222, v222
  v_fmac_f32 v207, v223, v223
  v_add_u32 v16, s40, v12
  v_add_u32 v17, s40, v13
  v_add_u32 v18, s40, v14
  v_add_u32 v19, s40, v15
  v_mfma_f32_16x16x32_bf16 v[208:211], v[20:23], v[32:35], v[208:211]
  s_waitcnt lgkmcnt(0)
  v_mfma_f32_32x32x16_bf16 v[64:79], v[56:59], v[40:43], v[64:79]
  s_waitcnt vmcnt(8)
  s_barrier
  ds_read_b128 v[32:35], v16 offset:0
  ds_read_b64_tr_b16 v[48:49], v18 offset:0
  ds_read_b64_tr_b16 v[50:51], v18 offset:1024
  v_mfma_f32_32x32x16_bf16 v[80:95], v[60:63], v[40:43], v[80:95]
  ds_read_b128 v[36:39], v17 offset:0
  ds_read_b64_tr_b16 v[52:53], v19 offset:0
  ds_read_b64_tr_b16 v[54:55], v19 offset:1024
  v_lshlrev_b32 v216, 16, v40
  v_and_b32 v217, s3, v40
  v_lshlrev_b32 v218, 16, v41
  v_and_b32 v219, s3, v41
  v_mfma_f32_16x16x32_bf16 v[212:215], v[20:23], v[56:59], v[212:215]
  v_fmac_f32 v206, v216, v216
  v_fmac_f32 v207, v217, v217
  v_mfma_f32_32x32x16_bf16 v[96:111], v[56:59], v[44:47], v[96:111]
  v_lshlrev_b32 v220, 16, v42
  v_and_b32 v221, s3, v42
  v_fmac_f32 v206, v218, v218
  v_fmac_f32 v207, v219, v219
  v_lshlrev_b32 v222, 16, v43
  v_and_b32 v223, s3, v43
  v_mfma_f32_32x32x16_bf16 v[112:127], v[60:63], v[44:47], v[112:127]
  v_fmac_f32 v206, v220, v220
  v_fmac_f32 v207, v221, v221
  v_fmac_f32 v206, v222, v222
  v_fmac_f32 v207, v223, v223
  v_mfma_f32_16x16x32_bf16 v[208:211], v[20:23], v[40:43], v[208:211]
  s_lshl_b32 s37, s62, 7
  s_add_u32 s37, s37, s63
  s_mul_i32 s38, s62, 245760
  s_add_u32 s38, s38, s29
  s_add_u32 s62, s62, 1
  s_cmp_eq_u32 s62, 10
  s_cselect_b32 s62, 0, s62
  s_cmp_eq_u32 s41, 2
  s_cbranch_scc1 L_qhook_19
  s_cmp_lt_u32 s41, 8
  s_cbranch_scc1 L_qloop_17
  s_sub_u32 s33, 127, s101
  s_lshl_b32 s34, s33, 13
  s_cmp_ge_u32 s34, L_mk_end-L_att_begin
  s_cbranch_scc1 L_npf_26
  s_getpc_b64 s[50:51]
L_pc_25:
  s_add_u32 s50, s50, L_att_begin-L_pc_25
  s_addc_u32 s51, s51, 0
  v_lshl_add_u32 v255, v1, 7, s34
  v_min_u32 v255, L_mk_end-L_att_begin-4, v255
  global_load_dword v255, v255, s[50:51]
L_npf_26:
  buffer_load_dword v135, v137, s[8:11], 0 offen sc1
  buffer_load_dword v254, v128, s[8:11], 0 offen sc1
L_qloop_18:
  s_waitcnt lgkmcnt(0)
  v_mfma_f32_32x32x16_bf16 v[64:79], v[48:51], v[32:35], v[64:79]
  ds_read_b128 v[40:43], v16 offset:32
  ds_read_b64_tr_b16 v[56:57], v18 offset:4096
  ds_read_b64_tr_b16 v[58:59], v18 offset:5120
  v_lshlrev_b32 v216, 16, v32
  v_and_b32 v217, s3, v32
  v_lshlrev_b32 v218, 16, v33
  v_mfma_f32_32x32x16_bf16 v[80:95], v[52:55], v[32:35], v[80:95]
  ds_read_b128 v[44:47], v17 offset:32
  ds_read_b64_tr_b16 v[60:61], v19 offset:4096
  ds_read_b64_tr_b16 v[62:63], v19 offset:5120
  v_and_b32 v219, s3, v33
  v_fmac_f32 v206, v216, v216
  v_mfma_f32_16x16x32_bf16 v[212:215], v[20:23], v[48:51], v[212:215]
  v_fmac_f32 v207, v217, v217
  v_lshlrev_b32 v220, 16, v34
  v_mfma_f32_32x32x16_bf16 v[96:111], v[48:51], v[36:39], v[96:111]
  v_and_b32 v221, s3, v34
  v_fmac_f32 v206, v218, v218
  v_fmac_f32 v207, v219, v219
  v_lshlrev_b32 v222, 16, v35
  v_and_b32 v223, s3, v35
  v_mfma_f32_32x32x16_bf16 v[112:127], v[52:55], v[36:39], v[112:127]
  v_fmac_f32 v206, v220, v220
  v_fmac_f32 v207, v221, v221
  v_fmac_f32 v206, v222, v222
  v_fmac_f32 v207, v223, v223
  v_mfma_f32_16x16x32_bf16 v[208:211], v[20:23], v[32:35], v[208:211]
  s_waitcnt lgkmcnt(0)
  v_mfma_f32_32x32x16_bf16 v[64:79], v[56:59], v[40:43], v[64:79]
  ds_read_b128 v[32:35], v16 offset:64
  ds_read_b64_tr_b16 v[48:49], v18 offset:8192
  ds_read_b64_tr_b16 v[50:51], v18 offset:9216
  v_lshlrev_b32 v216, 16, v40
  v_and_b32 v217, s3, v40
  v_lshlrev_b32 v218, 16, v41
  v_mfma_f32_32x32x16_bf16 v[80:95], v[60:63], v[40:43], v[80:95]
  ds_read_b128 v[36:39], v17 offset:64
  ds_read_b64_tr_b16 v[52:53], v19 offset:8192
  ds_read_b64_tr_b16 v[54:55], v19 offset:9216
  v_and_b32 v219, s3, v41
  v_fmac_f32 v206, v216, v216
  v_mfma_f32_16x16x32_bf16 v[212:215], v[20:23], v[56:59], v[212:215]
  v_fmac_f32 v207, v217, v217
  v_lshlrev_b32 v220, 16, v42
  v_mfma_f32_32x32x16_bf16 v[96:111], v[56:59], v[44:47], v[96:111]
  v_and_b32 v221, s3, v42
  v_fmac_f32 v206, v218, v218
  v_fmac_f32 v207, v219, v219
  v_lshlrev_b32 v222, 16, v43
  v_and_b32 v223, s3, v43
  v_mfma_f32_32x32x16_bf16 v[112:127], v[60:63], v[44:47], v[112:127]
  v_fmac_f32 v206, v220, v220
  v_fmac_f32 v207, v221, v221
  v_fmac_f32 v206, v222, v222
  v_fmac_f32 v207, v223, v223
  v_mfma_f32_16x16x32_bf16 v[208:211], v[20:23], v[40:43], v[208:211]
  s_waitcnt lgkmcnt(0)
  v_mfma_f32_32x32x16_bf16 v[64:79], v[48:51], v[32:35], v[64:79]
  ds_read_b128 v[40:43], v16 offset:96
  ds_read_b64_tr_b16 v[56:57], v18 offset:12288
  ds_read_b64_tr_b16 v[58:59], v18 offset:13312
  v_lshlrev_b32 v216, 16, v32
  v_and_b32 v217, s3, v32
  v_lshlrev_b32 v218, 16, v33
  v_mfma_f32_32x32x16_bf16 v[80:95], v[52:55], v[32:35], v[80:95]
  ds_read_b128 v[44:47], v17 offset:96
  ds_read_b64_tr_b16 v[60:61], v19 offset:12288
  ds_read_b64_tr_b16 v[62:63], v19 offset:13312
  s_add_u32 s40, s40, 33024
  s_cmp_eq_u32 s40, 99072
  s_cselect_b32 s40, 0, s40
  v_and_b32 v219, s3, v33
  v_fmac_f32 v206, v216, v216
  v_mfma_f32_16x16x32_bf16 v[212:215], v[20:23], v[48:51], v[212:215]
  v_fmac_f32 v207, v217, v217
  v_lshlrev_b32 v220, 16, v34
  v_mfma_f32_32x32x16_bf16 v[96:111], v[48:51], v[36:39], v[96:111]
  s_add_u32 s41, s41, 1
  v_and_b32 v221, s3, v34
  v_fmac_f32 v206, v218, v218
  v_fmac_f32 v207, v219, v219
  v_lshlrev_b32 v222, 16, v35
  v_and_b32 v223, s3, v35
  v_mfma_f32_32x32x16_bf16 v[112:127], v[52:55], v[36:39], v[112:127]
  v_fmac_f32 v206, v220, v220
  v_fmac_f32 v207, v221, v221
  v_fmac_f32 v206, v222, v222
  v_fmac_f32 v207, v223, v223
  v_add_u32 v16, s40, v12
  v_add_u32 v17, s40, v13
  v_add_u32 v18, s40, v14
  v_add_u32 v19, s40, v15
  v_mfma_f32_16x16x32_bf16 v[208:211], v[20:23], v[32:35], v[208:211]
  s_waitcnt lgkmcnt(0)
  v_mfma_f32_32x32x16_bf16 v[64:79], v[56:59], v[40:43], v[64:79]
  s_waitcnt vmcnt(2)
  s_barrier
  ds_read_b128 v[32:35], v16 offset:0
  ds_read_b64_tr_b16 v[48:49], v18 offset:0
  ds_read_b64_tr_b16 v[50:51], v18 offset:1024
  v_mfma_f32_32x32x16_bf16 v[80:95], v[60:63], v[40:43], v[80:95]
  ds_read_b128 v[36:39], v17 offset:0
  ds_read_b64_tr_b16 v[52:53], v19 offset:0
  ds_read_b64_tr_b16 v[54:55], v19 offset:1024
  v_lshlrev_b32 v216, 16, v40
  v_and_b32 v217, s3, v40
  v_lshlrev_b32 v218, 16, v41
  v_and_b32 v219, s3, v41
  v_mfma_f32_16x16x32_bf16 v[212:215], v[20:23], v[56:59], v[212:215]
  v_fmac_f32 v206, v216, v216
  v_fmac_f32 v207, v217, v217
  v_mfma_f32_32x32x16_bf16 v[96:111], v[56:59], v[44:47], v[96:111]
  v_lshlrev_b32 v220, 16, v42
  v_and_b32 v221, s3, v42
  v_fmac_f32 v206, v218, v218
  v_fmac_f32 v207, v219, v219
  v_lshlrev_b32 v222, 16, v43
  v_and_b32 v223, s3, v43
  v_mfma_f32_32x32x16_bf16 v[112:127], v[60:63], v[44:47], v[112:127]
  v_fmac_f32 v206, v220, v220
  v_fmac_f32 v207, v221, v221
  v_fmac_f32 v206, v222, v222
  v_fmac_f32 v207, v223, v223
  v_mfma_f32_16x16x32_bf16 v[208:211], v[20:23], v[40:43], v[208:211]
  s_cmp_lt_u32 s41, 10
  s_cbranch_scc1 L_qloop_18
  s_waitcnt vmcnt(1)
  s_mov_b32 s31, 200000
L_idp_31:
  v_xor_b32 v131, s32, v135
  v_cmp_lt_u32 vcc, 15, v131
  s_cbranch_vccz L_idk_32
  buffer_load_dword v135, v137, s[8:11], 0 offen sc1
  s_sub_u32 s31, s31, 1
  s_waitcnt vmcnt(0)
  s_cbranch_scc0 L_idp_31
L_idk_32:
  v_cmp_ne_u32 vcc, 0, v131
  v_add_f32 v206, v206, v207
  v_mov_b32 v131, v206
  s_cmp_lg_u64 vcc, 0
  s_cselect_b32 s30, 0, 1
  v_permlane32_swap_b32 v131, v206
  s_nop 1
  v_add_f32 v206, v206, v131
  v_mul_f32 v208, 0x3acccccd, v208
  v_mul_f32 v206, 0x3acccccd, v206
  v_fma_f32 v206, -v208, v208, v206
  v_max_f32 v206, 0, v206
  v_add_f32 v206, 0x3727c5ac, v206
  v_rsq_f32 v206, v206
  v_sub_f32 v208, 0, v208
  s_lshl_b32 s35, s28, 7
  s_add_u32 s35, s35, 132096
  v_lshl_add_u32 v131, v129, 2, s35
  s_lshl_b32 s33, s43, 8
  s_lshl_b32 s34, s42, 7
  s_add_u32 s33, s33, s34
  s_add_u32 s33, s33, 133120
  v_lshl_add_u32 v132, v129, 2, s33
  ds_write_b32 v131, v206
  ds_write_b32 v131, v208 offset:512
  ds_write_b32 v132, v212
  v_xor_b32 v4, 128, v131
  v_xor_b32 v5, 128, v132
  v_lshl_add_u32 v6, v130, 4, s33
  v_xor_b32 v7, 128, v6
  v_lshl_add_u32 v8, v130, 4, s35
  v_xor_b32 v9, 128, v8
  s_waitcnt lgkmcnt(0)
  s_barrier
  ds_read_b32 v134, v131
  ds_read_b32 v136, v131 offset:512
  ds_read_b32 v138, v4
  ds_read_b32 v206, v4 offset:512
  ds_read_b128 v[32:35], v6 offset:0
  ds_read_b128 v[36:39], v6 offset:32
  ds_read_b128 v[40:43], v6 offset:64
  ds_read_b128 v[44:47], v6 offset:96
  ds_read_b128 v[48:51], v7 offset:0
  ds_read_b128 v[52:55], v7 offset:32
  ds_read_b128 v[56:59], v7 offset:64
  ds_read_b128 v[60:63], v7 offset:96
  s_waitcnt lgkmcnt(0)
  v_mul_f32 v134, 0x3f1166db, v134
  v_mul_f32 v138, 0x3f1166db, v138
  v_pk_fma_f32 v[64:65], v[32:33], v[136:137], v[64:65] op_sel_hi:[1,0,1]
  v_pk_fma_f32 v[66:67], v[34:35], v[136:137], v[66:67] op_sel_hi:[1,0,1]
  v_pk_fma_f32 v[68:69], v[36:37], v[136:137], v[68:69] op_sel_hi:[1,0,1]
  v_pk_fma_f32 v[70:71], v[38:39], v[136:137], v[70:71] op_sel_hi:[1,0,1]
  v_pk_fma_f32 v[72:73], v[40:41], v[136:137], v[72:73] op_sel_hi:[1,0,1]
  v_pk_fma_f32 v[74:75], v[42:43], v[136:137], v[74:75] op_sel_hi:[1,0,1]
  v_pk_fma_f32 v[76:77], v[44:45], v[136:137], v[76:77] op_sel_hi:[1,0,1]
  v_pk_fma_f32 v[78:79], v[46:47], v[136:137], v[78:79] op_sel_hi:[1,0,1]
  v_pk_mul_f32 v[64:65], v[64:65], v[134:135] op_sel_hi:[1,0]
  v_pk_mul_f32 v[66:67], v[66:67], v[134:135] op_sel_hi:[1,0]
  v_pk_mul_f32 v[68:69], v[68:69], v[134:135] op_sel_hi:[1,0]
  v_pk_mul_f32 v[70:71], v[70:71], v[134:135] op_sel_hi:[1,0]
  v_pk_mul_f32 v[72:73], v[72:73], v[134:135] op_sel_hi:[1,0]
  v_pk_mul_f32 v[74:75], v[74:75], v[134:135] op_sel_hi:[1,0]
  v_pk_mul_f32 v[76:77], v[76:77], v[134:135] op_sel_hi:[1,0]
  v_pk_mul_f32 v[78:79], v[78:79], v[134:135] op_sel_hi:[1,0]
  v_cvt_pk_bf16_f32 v64, v64, v65
  v_cvt_pk_bf16_f32 v65, v66, v67
  v_cvt_pk_bf16_f32 v66, v68, v69
  v_cvt_pk_bf16_f32 v67, v70, v71
  v_cvt_pk_bf16_f32 v68, v72, v73
  v_cvt_pk_bf16_f32 v69, v74, v75
  v_cvt_pk_bf16_f32 v70, v76, v77
  v_cvt_pk_bf16_f32 v71, v78, v79
  s_cmp_eq_u32 s30, 0
  s_cbranch_scc1 L_wt_33
  buffer_store_dwordx2 v[64:65], v24, s[8:11], s58 offen
  buffer_store_dwordx2 v[66:67], v25, s[8:11], s58 offen
  buffer_store_dwordx2 v[68:69], v26, s[8:11], s58 offen
  buffer_store_dwordx2 v[70:71], v27, s[8:11], s58 offen
L_wj_34:
  v_pk_fma_f32 v[80:81], v[48:49], v[136:137], v[80:81] op_sel_hi:[1,0,1]
  v_pk_fma_f32 v[82:83], v[50:51], v[136:137], v[82:83] op_sel_hi:[1,0,1]
  v_pk_fma_f32 v[84:85], v[52:53], v[136:137], v[84:85] op_sel_hi:[1,0,1]
  v_pk_fma_f32 v[86:87], v[54:55], v[136:137], v[86:87] op_sel_hi:[1,0,1]
  v_pk_fma_f32 v[88:89], v[56:57], v[136:137], v[88:89] op_sel_hi:[1,0,1]
  v_pk_fma_f32 v[90:91], v[58:59], v[136:137], v[90:91] op_sel_hi:[1,0,1]
  v_pk_fma_f32 v[92:93], v[60:61], v[136:137], v[92:93] op_sel_hi:[1,0,1]
  v_pk_fma_f32 v[94:95], v[62:63], v[136:137], v[94:95] op_sel_hi:[1,0,1]
  v_pk_mul_f32 v[80:81], v[80:81], v[134:135] op_sel_hi:[1,0]
  v_pk_mul_f32 v[82:83], v[82:83], v[134:135] op_sel_hi:[1,0]
  v_pk_mul_f32 v[84:85], v[84:85], v[134:135] op_sel_hi:[1,0]
  v_pk_mul_f32 v[86:87], v[86:87], v[134:135] op_sel_hi:[1,0]
  v_pk_mul_f32 v[88:89], v[88:89], v[134:135] op_sel_hi:[1,0]
  v_pk_mul_f32 v[90:91], v[90:91], v[134:135] op_sel_hi:[1,0]
  v_pk_mul_f32 v[92:93], v[92:93], v[134:135] op_sel_hi:[1,0]
  v_pk_mul_f32 v[94:95], v[94:95], v[134:135] op_sel_hi:[1,0]
  v_cvt_pk_bf16_f32 v80, v80, v81
  v_cvt_pk_bf16_f32 v81, v82, v83
  v_cvt_pk_bf16_f32 v82, v84, v85
  v_cvt_pk_bf16_f32 v83, v86, v87
  v_cvt_pk_bf16_f32 v84, v88, v89
  v_cvt_pk_bf16_f32 v85, v90, v91
  v_cvt_pk_bf16_f32 v86, v92, v93
  v_cvt_pk_bf16_f32 v87, v94, v95
  s_cmp_eq_u32 s30, 0
  s_cbranch_scc1 L_wt_35
  buffer_store_dwordx2 v[80:81], v28, s[8:11], s58 offen
  buffer_store_dwordx2 v[82:83], v29, s[8:11], s58 offen
  buffer_store_dwordx2 v[84:85], v30, s[8:11], s58 offen
  buffer_store_dwordx2 v[86:87], v31, s[8:11], s58 offen
L_wj_36:
  v_pk_fma_f32 v[96:97], v[32:33], v[206:207], v[96:97] op_sel_hi:[1,0,1]
  v_pk_fma_f32 v[98:99], v[34:35], v[206:207], v[98:99] op_sel_hi:[1,0,1]
  v_pk_fma_f32 v[100:101], v[36:37], v[206:207], v[100:101] op_sel_hi:[1,0,1]
  v_pk_fma_f32 v[102:103], v[38:39], v[206:207], v[102:103] op_sel_hi:[1,0,1]
  v_pk_fma_f32 v[104:105], v[40:41], v[206:207], v[104:105] op_sel_hi:[1,0,1]
  v_pk_fma_f32 v[106:107], v[42:43], v[206:207], v[106:107] op_sel_hi:[1,0,1]
  v_pk_fma_f32 v[108:109], v[44:45], v[206:207], v[108:109] op_sel_hi:[1,0,1]
  v_pk_fma_f32 v[110:111], v[46:47], v[206:207], v[110:111] op_sel_hi:[1,0,1]
  v_pk_mul_f32 v[96:97], v[96:97], v[138:139] op_sel_hi:[1,0]
  v_pk_mul_f32 v[98:99], v[98:99], v[138:139] op_sel_hi:[1,0]
  v_pk_mul_f32 v[100:101], v[100:101], v[138:139] op_sel_hi:[1,0]
  v_pk_mul_f32 v[102:103], v[102:103], v[138:139] op_sel_hi:[1,0]
  v_pk_mul_f32 v[104:105], v[104:105], v[138:139] op_sel_hi:[1,0]
  v_pk_mul_f32 v[106:107], v[106:107], v[138:139] op_sel_hi:[1,0]
  v_pk_mul_f32 v[108:109], v[108:109], v[138:139] op_sel_hi:[1,0]
  v_pk_mul_f32 v[110:111], v[110:111], v[138:139] op_sel_hi:[1,0]
  v_cvt_pk_bf16_f32 v96, v96, v97
  v_cvt_pk_bf16_f32 v97, v98, v99
  v_cvt_pk_bf16_f32 v98, v100, v101
  v_cvt_pk_bf16_f32 v99, v102, v103
  v_cvt_pk_bf16_f32 v100, v104, v105
  v_cvt_pk_bf16_f32 v101, v106, v107
  v_cvt_pk_bf16_f32 v102, v108, v109
  v_cvt_pk_bf16_f32 v103, v110, v111
  s_cmp_eq_u32 s30, 0
  s_cbranch_scc1 L_wt_37
  buffer_store_dwordx2 v[96:97], v24, s[8:11], s59 offen
  buffer_store_dwordx2 v[98:99], v25, s[8:11], s59 offen
  buffer_store_dwordx2 v[100:101], v26, s[8:11], s59 offen
  buffer_store_dwordx2 v[102:103], v27, s[8:11], s59 offen
L_wj_38:
  v_pk_fma_f32 v[112:113], v[48:49], v[206:207], v[112:113] op_sel_hi:[1,0,1]
  v_pk_fma_f32 v[114:115], v[50:51], v[206:207], v[114:115] op_sel_hi:[1,0,1]
  v_pk_fma_f32 v[116:117], v[52:53], v[206:207], v[116:117] op_sel_hi:[1,0,1]
  v_pk_fma_f32 v[118:119], v[54:55], v[206:207], v[118:119] op_sel_hi:[1,0,1]
  v_pk_fma_f32 v[120:121], v[56:57], v[206:207], v[120:121] op_sel_hi:[1,0,1]
  v_pk_fma_f32 v[122:123], v[58:59], v[206:207], v[122:123] op_sel_hi:[1,0,1]
  v_pk_fma_f32 v[124:125], v[60:61], v[206:207], v[124:125] op_sel_hi:[1,0,1]
  v_pk_fma_f32 v[126:127], v[62:63], v[206:207], v[126:127] op_sel_hi:[1,0,1]
  v_pk_mul_f32 v[112:113], v[112:113], v[138:139] op_sel_hi:[1,0]
  v_pk_mul_f32 v[114:115], v[114:115], v[138:139] op_sel_hi:[1,0]
  v_pk_mul_f32 v[116:117], v[116:117], v[138:139] op_sel_hi:[1,0]
  v_pk_mul_f32 v[118:119], v[118:119], v[138:139] op_sel_hi:[1,0]
  v_pk_mul_f32 v[120:121], v[120:121], v[138:139] op_sel_hi:[1,0]
  v_pk_mul_f32 v[122:123], v[122:123], v[138:139] op_sel_hi:[1,0]
  v_pk_mul_f32 v[124:125], v[124:125], v[138:139] op_sel_hi:[1,0]
  v_pk_mul_f32 v[126:127], v[126:127], v[138:139] op_sel_hi:[1,0]
  v_cvt_pk_bf16_f32 v112, v112, v113
  v_cvt_pk_bf16_f32 v113, v114, v115
  v_cvt_pk_bf16_f32 v114, v116, v117
  v_cvt_pk_bf16_f32 v115, v118, v119
  v_cvt_pk_bf16_f32 v116, v120, v121
  v_cvt_pk_bf16_f32 v117, v122, v123
  v_cvt_pk_bf16_f32 v118, v124, v125
  v_cvt_pk_bf16_f32 v119, v126, v127
  s_cmp_eq_u32 s30, 0
  s_cbranch_scc1 L_wt_39
  buffer_store_dwordx2 v[112:113], v28, s[8:11], s59 offen
  buffer_store_dwordx2 v[114:115], v29, s[8:11], s59 offen
  buffer_store_dwordx2 v[116:117], v30, s[8:11], s59 offen
  buffer_store_dwordx2 v[118:119], v31, s[8:11], s59 offen
L_wj_40:
  s_branch L_qjoin_13
L_pqv_15:
  s_lshl_b32 s33, s36, 3
  s_mov_b32 s35, 162560
  s_mov_b32 s34, 161280
  v_lshlrev_b32 v133, 3, v129
  v_add3_u32 v131, s33, v130, 0
  v_mul_u32_u24 v132, 205, v131
  v_lshrrev_b32 v132, 10, v132
  v_lshl_add_u32 v24, v131, 8, v133
  v_mul_u32_u24 v131, s35, v132
  v_lshrrev_b32 v132, 1, v132
  v_subrev_u32 v131, 327680, v131
  v_mul_u32_u24 v132, s34, v132
  v_max_i32 v131, v131, v132
  v_add_u32 v24, v131, v24
  v_add3_u32 v131, s33, v130, 2
  v_mul_u32_u24 v132, 205, v131
  v_lshrrev_b32 v132, 10, v132
  v_lshl_add_u32 v25, v131, 8, v133
  v_mul_u32_u24 v131, s35, v132
  v_lshrrev_b32 v132, 1, v132
  v_subrev_u32 v131, 327680, v131
  v_mul_u32_u24 v132, s34, v132
  v_max_i32 v131, v131, v132
  v_add_u32 v25, v131, v25
  v_add3_u32 v131, s33, v130, 4
  v_mul_u32_u24 v132, 205, v131
  v_lshrrev_b32 v132, 10, v132
  v_lshl_add_u32 v26, v131, 8, v133
  v_mul_u32_u24 v131, s35, v132
  v_lshrrev_b32 v132, 1, v132
  v_subrev_u32 v131, 327680, v131
  v_mul_u32_u24 v132, s34, v132
  v_max_i32 v131, v131, v132
  v_add_u32 v26, v131, v26
  v_add3_u32 v131, s33, v130, 6
  v_mul_u32_u24 v132, 205, v131
  v_lshrrev_b32 v132, 10, v132
  v_lshl_add_u32 v27, v131, 8, v133
  v_mul_u32_u24 v131, s35, v132
  v_lshrrev_b32 v132, 1, v132
  v_subrev_u32 v131, 327680, v131
  v_mul_u32_u24 v132, s34, v132
  v_max_i32 v131, v131, v132
  v_add_u32 v27, v131, v27
  s_xor_b32 s36, s36, 1
  s_lshl_b32 s33, s36, 5
  s_sub_u32 s33, s33, 160
  s_mov_b32 s35, 163520
  v_mul_u32_u24 v133, 320, v130
  v_add_u32 v133, 328960, v133
  v_add_u32 v131, s33, v129
  v_mul_u32_u24 v132, 205, v131
  v_lshrrev_b32 v132, 12, v132
  v_lshl_add_u32 v28, v131, 4, v133
  v_mad_u32_u24 v28, v132, s35, v28
  v_lshrrev_b32 v132, 2, v132
  v_lshl_or_b32 v28, v132, 25, v28
  s_add_u32 m0, s61, 33024
  s_nop 0
  buffer_load_dwordx4 v8, s[16:19], s38 offen offset:0 lds
  buffer_load_dwordx4 v9, s[16:19], s38 offen offset:1024 lds
  buffer_load_dwordx4 v10, s[16:19], s38 offen offset:2048 lds
  buffer_load_dwordx4 v11, s[16:19], s38 offen offset:3072 lds
  s_lshl_b32 s37, s62, 7
  s_add_u32 s37, s37, s63
  s_mul_i32 s38, s62, 245760
  s_add_u32 s38, s38, s29
  s_add_u32 s62, s62, 1
  s_cmp_eq_u32 s62, 10
  s_cselect_b32 s62, 0, s62
  global_load_dword v135, v139, s[48:49] sc1
  s_cmp_lg_u32 s28, 2
  s_cbranch_scc1 L_ntw_46
  s_load_dwordx2 s[6:7], s[0:1], 56
  v_lshlrev_b32 v138, 21, v1
  v_and_b32 v140, 0x200000, v138
  buffer_load_dword v254, v138, s[8:11], 0 offen sc1
  global_load_dword v254, v139, s[50:51]
  global_load_dword v254, v139, s[52:53]
  global_load_dword v254, v139, s[54:55]
  global_load_dword v254, v139, s[56:57]
  s_waitcnt lgkmcnt(0)
  global_load_dword v254, v140, s[6:7] sc1
L_ntw_46:
  s_cmp_eq_u32 s28, 2
  s_waitcnt vmcnt(15)
  s_cbranch_scc1 L_qfw_47
  s_waitcnt vmcnt(9)
L_qfw_47:
  s_barrier
  ds_read_b128 v[32:35], v16 offset:0
  ds_read_b64_tr_b16 v[48:49], v18 offset:0
  ds_read_b64_tr_b16 v[50:51], v18 offset:1024
  ds_read_b128 v[36:39], v17 offset:0
  ds_read_b64_tr_b16 v[52:53], v19 offset:0
  ds_read_b64_tr_b16 v[54:55], v19 offset:1024
.p2align 6
L_qloop_41:
  s_waitcnt lgkmcnt(0)
  s_add_u32 m0, s60, s39
  v_mfma_f32_32x32x16_bf16 v[64:79], v[48:51], v[32:35], v[64:79]
  ds_read_b128 v[40:43], v16 offset:32
  ds_read_b64_tr_b16 v[56:57], v18 offset:4096
  ds_read_b64_tr_b16 v[58:59], v18 offset:5120
  v_lshlrev_b32 v216, 16, v32
  v_and_b32 v217, s3, v32
  v_lshlrev_b32 v218, 16, v33
  v_mfma_f32_32x32x16_bf16 v[80:95], v[32:35], v[52:55], v[80:95]
  ds_read_b128 v[44:47], v17 offset:32
  ds_read_b64_tr_b16 v[60:61], v19 offset:4096
  ds_read_b64_tr_b16 v[62:63], v19 offset:5120
  buffer_load_dwordx4 v4, s[12:15], s37 offen offset:0 lds
  buffer_load_dwordx4 v5, s[12:15], s37 offen offset:1040 lds
  v_and_b32 v219, s3, v33
  v_fmac_f32 v206, v216, v216
  v_mfma_f32_16x16x32_bf16 v[212:215], v[20:23], v[48:51], v[212:215]
  v_fmac_f32 v207, v217, v217
  v_lshlrev_b32 v220, 16, v34
  v_mfma_f32_32x32x16_bf16 v[96:111], v[48:51], v[36:39], v[96:111]
  buffer_load_dwordx4 v6, s[12:15], s37 offen offset:2080 lds
  v_and_b32 v221, s3, v34
  v_fmac_f32 v206, v218, v218
  v_fmac_f32 v207, v219, v219
  v_lshlrev_b32 v222, 16, v35
  v_and_b32 v223, s3, v35
  v_mfma_f32_32x32x16_bf16 v[112:127], v[36:39], v[52:55], v[112:127]
  v_fmac_f32 v206, v220, v220
  v_fmac_f32 v207, v221, v221
  v_fmac_f32 v206, v222, v222
  v_fmac_f32 v207, v223, v223
  buffer_load_dwordx4 v7, s[12:15], s37 offen offset:3120 lds
  s_add_u32 m0, s61, s39
  v_mfma_f32_16x16x32_bf16 v[208:211], v[20:23], v[32:35], v[208:211]
  s_waitcnt lgkmcnt(0)
  v_mfma_f32_32x32x16_bf16 v[64:79], v[56:59], v[40:43], v[64:79]
  ds_read_b128 v[32:35], v16 offset:64
  ds_read_b64_tr_b16 v[48:49], v18 offset:8192
  ds_read_b64_tr_b16 v[50:51], v18 offset:9216
  v_lshlrev_b32 v216, 16, v40
  v_and_b32 v217, s3, v40
  v_lshlrev_b32 v218, 16, v41
  v_mfma_f32_32x32x16_bf16 v[80:95], v[40:43], v[60:63], v[80:95]
  ds_read_b128 v[36:39], v17 offset:64
  ds_read_b64_tr_b16 v[52:53], v19 offset:8192
  ds_read_b64_tr_b16 v[54:55], v19 offset:9216
  buffer_load_dwordx4 v8, s[16:19], s38 offen offset:0 lds
  buffer_load_dwordx4 v9, s[16:19], s38 offen offset:1024 lds
  v_and_b32 v219, s3, v41
  v_fmac_f32 v206, v216, v216
  v_mfma_f32_16x16x32_bf16 v[212:215], v[20:23], v[56:59], v[212:215]
  v_fmac_f32 v207, v217, v217
  v_lshlrev_b32 v220, 16, v42
  v_mfma_f32_32x32x16_bf16 v[96:111], v[56:59], v[44:47], v[96:111]
  buffer_load_dwordx4 v10, s[16:19], s38 offen offset:2048 lds
  v_and_b32 v221, s3, v42
  v_fmac_f32 v206, v218, v218
  v_fmac_f32 v207, v219, v219
  v_lshlrev_b32 v222, 16, v43
  v_and_b32 v223, s3, v43
  v_mfma_f32_32x32x16_bf16 v[112:127], v[44:47], v[60:63], v[112:127]
  v_fmac_f32 v206, v220, v220
  v_fmac_f32 v207, v221, v221
  v_fmac_f32 v206, v222, v222
  v_fmac_f32 v207, v223, v223
  buffer_load_dwordx4 v11, s[16:19], s38 offen offset:3072 lds
  s_mov_b32 s39, s40
  v_mfma_f32_16x16x32_bf16 v[208:211], v[20:23], v[40:43], v[208:211]
  s_waitcnt lgkmcnt(0)
  v_mfma_f32_32x32x16_bf16 v[64:79], v[48:51], v[32:35], v[64:79]
  ds_read_b128 v[40:43], v16 offset:96
  ds_read_b64_tr_b16 v[56:57], v18 offset:12288
  ds_read_b64_tr_b16 v[58:59], v18 offset:13312
  v_lshlrev_b32 v216, 16, v32
  v_and_b32 v217, s3, v32
  v_lshlrev_b32 v218, 16, v33
  v_mfma_f32_32x32x16_bf16 v[80:95], v[32:35], v[52:55], v[80:95]
  ds_read_b128 v[44:47], v17 offset:96
  ds_read_b64_tr_b16 v[60:61], v19 offset:12288
  ds_read_b64_tr_b16 v[62:63], v19 offset:13312
  s_add_u32 s40, s40, 33024
  s_cmp_eq_u32 s40, 99072
  s_cselect_b32 s40, 0, s40
  v_and_b32 v219, s3, v33
  v_fmac_f32 v206, v216, v216
  v_mfma_f32_16x16x32_bf16 v[212:215], v[20:23], v[48:51], v[212:215]
  v_fmac_f32 v207, v217, v217
  v_lshlrev_b32 v220, 16, v34
  v_mfma_f32_32x32x16_bf16 v[96:111], v[48:51], v[36:39], v[96:111]
  s_add_u32 s41, s41, 1
  v_and_b32 v221, s3, v34
  v_fmac_f32 v206, v218, v218
  v_fmac_f32 v207, v219, v219
  v_lshlrev_b32 v222, 16, v35
  v_and_b32 v223, s3, v35
  v_mfma_f32_32x32x16_bf16 v[112:127], v[36:39], v[52:55], v[112:127]
  v_fmac_f32 v206, v220, v220
  v_fmac_f32 v207, v221, v221
  v_fmac_f32 v206, v222, v222
  v_fmac_f32 v207, v223, v223
  v_add_u32 v16, s40, v12
  v_add_u32 v17, s40, v13
  v_add_u32 v18, s40, v14
  v_add_u32 v19, s40, v15
  v_mfma_f32_16x16x32_bf16 v[208:211], v[20:23], v[32:35], v[208:211]
  s_waitcnt lgkmcnt(0)
  v_mfma_f32_32x32x16_bf16 v[64:79], v[56:59], v[40:43], v[64:79]
  s_waitcnt vmcnt(8)
  s_barrier
  ds_read_b128 v[32:35], v16 offset:0
  ds_read_b64_tr_b16 v[48:49], v18 offset:0
  ds_read_b64_tr_b16 v[50:51], v18 offset:1024
  v_mfma_f32_32x32x16_bf16 v[80:95], v[40:43], v[60:63], v[80:95]
  ds_read_b128 v[36:39], v17 offset:0
  ds_read_b64_tr_b16 v[52:53], v19 offset:0
  ds_read_b64_tr_b16 v[54:55], v19 offset:1024
  v_lshlrev_b32 v216, 16, v40
  v_and_b32 v217, s3, v40
  v_lshlrev_b32 v218, 16, v41
  v_and_b32 v219, s3, v41
  v_mfma_f32_16x16x32_bf16 v[212:215], v[20:23], v[56:59], v[212:215]
  v_fmac_f32 v206, v216, v216
  v_fmac_f32 v207, v217, v217
  v_mfma_f32_32x32x16_bf16 v[96:111], v[56:59], v[44:47], v[96:111]
  v_lshlrev_b32 v220, 16, v42
  v_and_b32 v221, s3, v42
  v_fmac_f32 v206, v218, v218
  v_fmac_f32 v207, v219, v219
  v_lshlrev_b32 v222, 16, v43
  v_and_b32 v223, s3, v43
  v_mfma_f32_32x32x16_bf16 v[112:127], v[44:47], v[60:63], v[112:127]
  v_fmac_f32 v206, v220, v220
  v_fmac_f32 v207, v221, v221
  v_fmac_f32 v206, v222, v222
  v_fmac_f32 v207, v223, v223
  v_mfma_f32_16x16x32_bf16 v[208:211], v[20:23], v[40:43], v[208:211]
  s_lshl_b32 s37, s62, 7
  s_add_u32 s37, s37, s63
  s_mul_i32 s38, s62, 245760
  s_add_u32 s38, s38, s29
  s_add_u32 s62, s62, 1
  s_cmp_eq_u32 s62, 10
  s_cselect_b32 s62, 0, s62
  s_cmp_eq_u32 s41, 2
  s_cbranch_scc1 L_qhook_43
  s_cmp_lt_u32 s41, 8
  s_cbranch_scc1 L_qloop_41
  s_sub_u32 s33, 127, s101
  s_lshl_b32 s34, s33, 13
  s_cmp_ge_u32 s34, L_mk_end-L_att_begin
  s_cbranch_scc1 L_npf_50
  s_getpc_b64 s[50:51]
L_pc_49:
  s_add_u32 s50, s50, L_att_begin-L_pc_49
  s_addc_u32 s51, s51, 0
  v_lshl_add_u32 v255, v1, 7, s34
  v_min_u32 v255, L_mk_end-L_att_begin-4, v255
  global_load_dword v255, v255, s[50:51]
L_npf_50:
  buffer_load_dword v135, v137, s[8:11], 0 offen sc1
  buffer_load_dword v254, v128, s[8:11], 0 offen sc1
L_qloop_42:
  s_waitcnt lgkmcnt(0)
  v_mfma_f32_32x32x16_bf16 v[64:79], v[48:51], v[32:35], v[64:79]
  ds_read_b128 v[40:43], v16 offset:32
  ds_read_b64_tr_b16 v[56:57], v18 offset:4096
  ds_read_b64_tr_b16 v[58:59], v18 offset:5120
  v_lshlrev_b32 v216, 16, v32
  v_and_b32 v217, s3, v32
  v_lshlrev_b32 v218, 16, v33
  v_mfma_f32_32x32x16_bf16 v[80:95], v[32:35], v[52:55], v[80:95]
  ds_read_b128 v[44:47], v17 offset:32
  ds_read_b64_tr_b16 v[60:61], v19 offset:4096
  ds_read_b64_tr_b16 v[62:63], v19 offset:5120
  v_and_b32 v219, s3, v33
  v_fmac_f32 v206, v216, v216
  v_mfma_f32_16x16x32_bf16 v[212:215], v[20:23], v[48:51], v[212:215]
  v_fmac_f32 v207, v217, v217
  v_lshlrev_b32 v220, 16, v34
  v_mfma_f32_32x32x16_bf16 v[96:111], v[48:51], v[36:39], v[96:111]
  v_and_b32 v221, s3, v34
  v_fmac_f32 v206, v218, v218
  v_fmac_f32 v207, v219, v219
  v_lshlrev_b32 v222, 16, v35
  v_and_b32 v223, s3, v35
  v_mfma_f32_32x32x16_bf16 v[112:127], v[36:39], v[52:55], v[112:127]
  v_fmac_f32 v206, v220, v220
  v_fmac_f32 v207, v221, v221
  v_fmac_f32 v206, v222, v222
  v_fmac_f32 v207, v223, v223
  v_mfma_f32_16x16x32_bf16 v[208:211], v[20:23], v[32:35], v[208:211]
  s_waitcnt lgkmcnt(0)
  v_mfma_f32_32x32x16_bf16 v[64:79], v[56:59], v[40:43], v[64:79]
  ds_read_b128 v[32:35], v16 offset:64
  ds_read_b64_tr_b16 v[48:49], v18 offset:8192
  ds_read_b64_tr_b16 v[50:51], v18 offset:9216
  v_lshlrev_b32 v216, 16, v40
  v_and_b32 v217, s3, v40
  v_lshlrev_b32 v218, 16, v41
  v_mfma_f32_32x32x16_bf16 v[80:95], v[40:43], v[60:63], v[80:95]
  ds_read_b128 v[36:39], v17 offset:64
  ds_read_b64_tr_b16 v[52:53], v19 offset:8192
  ds_read_b64_tr_b16 v[54:55], v19 offset:9216
  v_and_b32 v219, s3, v41
  v_fmac_f32 v206, v216, v216
  v_mfma_f32_16x16x32_bf16 v[212:215], v[20:23], v[56:59], v[212:215]
  v_fmac_f32 v207, v217, v217
  v_lshlrev_b32 v220, 16, v42
  v_mfma_f32_32x32x16_bf16 v[96:111], v[56:59], v[44:47], v[96:111]
  v_and_b32 v221, s3, v42
  v_fmac_f32 v206, v218, v218
  v_fmac_f32 v207, v219, v219
  v_lshlrev_b32 v222, 16, v43
  v_and_b32 v223, s3, v43
  v_mfma_f32_32x32x16_bf16 v[112:127], v[44:47], v[60:63], v[112:127]
  v_fmac_f32 v206, v220, v220
  v_fmac_f32 v207, v221, v221
  v_fmac_f32 v206, v222, v222
  v_fmac_f32 v207, v223, v223
  v_mfma_f32_16x16x32_bf16 v[208:211], v[20:23], v[40:43], v[208:211]
  s_waitcnt lgkmcnt(0)
  v_mfma_f32_32x32x16_bf16 v[64:79], v[48:51], v[32:35], v[64:79]
  ds_read_b128 v[40:43], v16 offset:96
  ds_read_b64_tr_b16 v[56:57], v18 offset:12288
  ds_read_b64_tr_b16 v[58:59], v18 offset:13312
  v_lshlrev_b32 v216, 16, v32
  v_and_b32 v217, s3, v32
  v_lshlrev_b32 v218, 16, v33
  v_mfma_f32_32x32x16_bf16 v[80:95], v[32:35], v[52:55], v[80:95]
  ds_read_b128 v[44:47], v17 offset:96
  ds_read_b64_tr_b16 v[60:61], v19 offset:12288
  ds_read_b64_tr_b16 v[62:63], v19 offset:13312
  s_add_u32 s40, s40, 33024
  s_cmp_eq_u32 s40, 99072
  s_cselect_b32 s40, 0, s40
  v_and_b32 v219, s3, v33
  v_fmac_f32 v206, v216, v216
  v_mfma_f32_16x16x32_bf16 v[212:215], v[20:23], v[48:51], v[212:215]
  v_fmac_f32 v207, v217, v217
  v_lshlrev_b32 v220, 16, v34
  v_mfma_f32_32x32x16_bf16 v[96:111], v[48:51], v[36:39], v[96:111]
  s_add_u32 s41, s41, 1
  v_and_b32 v221, s3, v34
  v_fmac_f32 v206, v218, v218
  v_fmac_f32 v207, v219, v219
  v_lshlrev_b32 v222, 16, v35
  v_and_b32 v223, s3, v35
  v_mfma_f32_32x32x16_bf16 v[112:127], v[36:39], v[52:55], v[112:127]
  v_fmac_f32 v206, v220, v220
  v_fmac_f32 v207, v221, v221
  v_fmac_f32 v206, v222, v222
  v_fmac_f32 v207, v223, v223
  v_add_u32 v16, s40, v12
  v_add_u32 v17, s40, v13
  v_add_u32 v18, s40, v14
  v_add_u32 v19, s40, v15
  v_mfma_f32_16x16x32_bf16 v[208:211], v[20:23], v[32:35], v[208:211]
  s_waitcnt lgkmcnt(0)
  v_mfma_f32_32x32x16_bf16 v[64:79], v[56:59], v[40:43], v[64:79]
  s_waitcnt vmcnt(2)
  s_barrier
  ds_read_b128 v[32:35], v16 offset:0
  ds_read_b64_tr_b16 v[48:49], v18 offset:0
  ds_read_b64_tr_b16 v[50:51], v18 offset:1024
  v_mfma_f32_32x32x16_bf16 v[80:95], v[40:43], v[60:63], v[80:95]
  ds_read_b128 v[36:39], v17 offset:0
  ds_read_b64_tr_b16 v[52:53], v19 offset:0
  ds_read_b64_tr_b16 v[54:55], v19 offset:1024
  v_lshlrev_b32 v216, 16, v40
  v_and_b32 v217, s3, v40
  v_lshlrev_b32 v218, 16, v41
  v_and_b32 v219, s3, v41
  v_mfma_f32_16x16x32_bf16 v[212:215], v[20:23], v[56:59], v[212:215]
  v_fmac_f32 v206, v216, v216
  v_fmac_f32 v207, v217, v217
  v_mfma_f32_32x32x16_bf16 v[96:111], v[56:59], v[44:47], v[96:111]
  v_lshlrev_b32 v220, 16, v42
  v_and_b32 v221, s3, v42
  v_fmac_f32 v206, v218, v218
  v_fmac_f32 v207, v219, v219
  v_lshlrev_b32 v222, 16, v43
  v_and_b32 v223, s3, v43
  v_mfma_f32_32x32x16_bf16 v[112:127], v[44:47], v[60:63], v[112:127]
  v_fmac_f32 v206, v220, v220
  v_fmac_f32 v207, v221, v221
  v_fmac_f32 v206, v222, v222
  v_fmac_f32 v207, v223, v223
  v_mfma_f32_16x16x32_bf16 v[208:211], v[20:23], v[40:43], v[208:211]
  s_cmp_lt_u32 s41, 10
  s_cbranch_scc1 L_qloop_42
  s_waitcnt vmcnt(1)
  s_mov_b32 s31, 200000
L_idp_55:
  v_xor_b32 v131, s32, v135
  v_cmp_lt_u32 vcc, 15, v131
  s_cbranch_vccz L_idk_56
  buffer_load_dword v135, v137, s[8:11], 0 offen sc1
  s_sub_u32 s31, s31, 1
  s_waitcnt vmcnt(0)
  s_cbranch_scc0 L_idp_55
L_idk_56:
  v_cmp_ne_u32 vcc, 0, v131
  v_add_f32 v206, v206, v207
  v_mov_b32 v131, v206
  s_cmp_lg_u64 vcc, 0
  s_cselect_b32 s30, 0, 1
  v_permlane32_swap_b32 v131, v206
  s_nop 1
  v_add_f32 v206, v206, v131
  v_mul_f32 v208, 0x3acccccd, v208
  v_mul_f32 v206, 0x3acccccd, v206
  v_fma_f32 v206, -v208, v208, v206
  v_max_f32 v206, 0, v206
  v_add_f32 v206, 0x3727c5ac, v206
  v_rsq_f32 v206, v206
  v_sub_f32 v208, 0, v208
  s_lshl_b32 s35, s28, 7
  s_add_u32 s35, s35, 132096
  v_lshl_add_u32 v131, v129, 2, s35
  s_lshl_b32 s33, s43, 8
  s_lshl_b32 s34, s42, 7
  s_add_u32 s33, s33, s34
  s_add_u32 s33, s33, 133120
  v_lshl_add_u32 v132, v129, 2, s33
  ds_write_b32 v131, v206
  ds_write_b32 v131, v208 offset:512
  ds_write_b32 v132, v212
  v_xor_b32 v4, 128, v131
  v_xor_b32 v5, 128, v132
  v_lshl_add_u32 v6, v130, 4, s33
  v_xor_b32 v7, 128, v6
  v_lshl_add_u32 v8, v130, 4, s35
  v_xor_b32 v9, 128, v8
  s_waitcnt lgkmcnt(0)
  s_barrier
  ds_read_b32 v134, v131
  ds_read_b32 v136, v131 offset:512
  ds_read_b32 v138, v4
  ds_read_b32 v206, v4 offset:512
  ds_read_b128 v[32:35], v6 offset:0
  ds_read_b128 v[36:39], v6 offset:32
  ds_read_b128 v[40:43], v6 offset:64
  ds_read_b128 v[44:47], v6 offset:96
  ds_read_b32 v218, v5
  ds_read_b128 v[172:175], v8 offset:512
  ds_read_b128 v[176:179], v8 offset:544
  ds_read_b128 v[180:183], v8 offset:576
  ds_read_b128 v[184:187], v8 offset:608
  ds_read_b128 v[140:143], v8 offset:0
  ds_read_b128 v[144:147], v8 offset:32
  ds_read_b128 v[148:151], v8 offset:64
  ds_read_b128 v[152:155], v8 offset:96
  ds_read_b128 v[188:191], v9 offset:512
  ds_read_b128 v[192:195], v9 offset:544
  ds_read_b128 v[196:199], v9 offset:576
  ds_read_b128 v[200:203], v9 offset:608
  ds_read_b128 v[156:159], v9 offset:0
  ds_read_b128 v[160:163], v9 offset:32
  ds_read_b128 v[164:167], v9 offset:64
  ds_read_b128 v[168:171], v9 offset:96
  s_waitcnt lgkmcnt(0)
  v_mul_f32 v134, 0x3f1166db, v134
  v_mul_f32 v138, 0x3f1166db, v138
  v_pk_fma_f32 v[64:65], v[32:33], v[136:137], v[64:65] op_sel_hi:[1,0,1]
  v_pk_fma_f32 v[66:67], v[34:35], v[136:137], v[66:67] op_sel_hi:[1,0,1]
  v_pk_fma_f32 v[68:69], v[36:37], v[136:137], v[68:69] op_sel_hi:[1,0,1]
  v_pk_fma_f32 v[70:71], v[38:39], v[136:137], v[70:71] op_sel_hi:[1,0,1]
  v_pk_fma_f32 v[72:73], v[40:41], v[136:137], v[72:73] op_sel_hi:[1,0,1]
  v_pk_fma_f32 v[74:75], v[42:43], v[136:137], v[74:75] op_sel_hi:[1,0,1]
  v_pk_fma_f32 v[76:77], v[44:45], v[136:137], v[76:77] op_sel_hi:[1,0,1]
  v_pk_fma_f32 v[78:79], v[46:47], v[136:137], v[78:79] op_sel_hi:[1,0,1]
  v_pk_mul_f32 v[64:65], v[64:65], v[134:135] op_sel_hi:[1,0]
  v_pk_mul_f32 v[66:67], v[66:67], v[134:135] op_sel_hi:[1,0]
  v_pk_mul_f32 v[68:69], v[68:69], v[134:135] op_sel_hi:[1,0]
  v_pk_mul_f32 v[70:71], v[70:71], v[134:135] op_sel_hi:[1,0]
  v_pk_mul_f32 v[72:73], v[72:73], v[134:135] op_sel_hi:[1,0]
  v_pk_mul_f32 v[74:75], v[74:75], v[134:135] op_sel_hi:[1,0]
  v_pk_mul_f32 v[76:77], v[76:77], v[134:135] op_sel_hi:[1,0]
  v_pk_mul_f32 v[78:79], v[78:79], v[134:135] op_sel_hi:[1,0]
  v_cvt_pk_bf16_f32 v64, v64, v65
  v_cvt_pk_bf16_f32 v65, v66, v67
  v_cvt_pk_bf16_f32 v66, v68, v69
  v_cvt_pk_bf16_f32 v67, v70, v71
  v_cvt_pk_bf16_f32 v68, v72, v73
  v_cvt_pk_bf16_f32 v69, v74, v75
  v_cvt_pk_bf16_f32 v70, v76, v77
  v_cvt_pk_bf16_f32 v71, v78, v79
  s_cmp_eq_u32 s30, 0
  s_cbranch_scc1 L_wt_57
  buffer_store_dwordx2 v[64:65], v24, s[8:11], s58 offen
  buffer_store_dwordx2 v[66:67], v25, s[8:11], s58 offen
  buffer_store_dwordx2 v[68:69], v26, s[8:11], s58 offen
  buffer_store_dwordx2 v[70:71], v27, s[8:11], s58 offen
L_wj_58:
  v_pk_fma_f32 v[80:81], v[172:173], v[218:219], v[80:81] op_sel_hi:[1,0,1]
  v_pk_fma_f32 v[82:83], v[174:175], v[218:219], v[82:83] op_sel_hi:[1,0,1]
  v_pk_fma_f32 v[84:85], v[176:177], v[218:219], v[84:85] op_sel_hi:[1,0,1]
  v_pk_fma_f32 v[86:87], v[178:179], v[218:219], v[86:87] op_sel_hi:[1,0,1]
  v_pk_fma_f32 v[88:89], v[180:181], v[218:219], v[88:89] op_sel_hi:[1,0,1]
  v_pk_fma_f32 v[90:91], v[182:183], v[218:219], v[90:91] op_sel_hi:[1,0,1]
  v_pk_fma_f32 v[92:93], v[184:185], v[218:219], v[92:93] op_sel_hi:[1,0,1]
  v_pk_fma_f32 v[94:95], v[186:187], v[218:219], v[94:95] op_sel_hi:[1,0,1]
  v_pk_mul_f32 v[80:81], v[80:81], v[140:141]
  v_pk_mul_f32 v[82:83], v[82:83], v[142:143]
  v_pk_mul_f32 v[84:85], v[84:85], v[144:145]
  v_pk_mul_f32 v[86:87], v[86:87], v[146:147]
  v_pk_mul_f32 v[88:89], v[88:89], v[148:149]
  v_pk_mul_f32 v[90:91], v[90:91], v[150:151]
  v_pk_mul_f32 v[92:93], v[92:93], v[152:153]
  v_pk_mul_f32 v[94:95], v[94:95], v[154:155]
  v_cvt_pk_bf16_f32 v80, v80, v81
  v_cvt_pk_bf16_f32 v81, v82, v83
  v_cvt_pk_bf16_f32 v82, v84, v85
  v_cvt_pk_bf16_f32 v83, v86, v87
  v_cvt_pk_bf16_f32 v84, v88, v89
  v_cvt_pk_bf16_f32 v85, v90, v91
  v_cvt_pk_bf16_f32 v86, v92, v93
  v_cvt_pk_bf16_f32 v87, v94, v95
  s_cmp_eq_u32 s30, 0
  s_cbranch_scc1 L_wt_59
  buffer_store_dwordx4 v[80:83], v28, s[8:11], s58 offen offset:0
  buffer_store_dwordx4 v[84:87], v28, s[8:11], s58 offen offset:640
L_wj_60:
  v_pk_fma_f32 v[96:97], v[32:33], v[206:207], v[96:97] op_sel_hi:[1,0,1]
  v_pk_fma_f32 v[98:99], v[34:35], v[206:207], v[98:99] op_sel_hi:[1,0,1]
  v_pk_fma_f32 v[100:101], v[36:37], v[206:207], v[100:101] op_sel_hi:[1,0,1]
  v_pk_fma_f32 v[102:103], v[38:39], v[206:207], v[102:103] op_sel_hi:[1,0,1]
  v_pk_fma_f32 v[104:105], v[40:41], v[206:207], v[104:105] op_sel_hi:[1,0,1]
  v_pk_fma_f32 v[106:107], v[42:43], v[206:207], v[106:107] op_sel_hi:[1,0,1]
  v_pk_fma_f32 v[108:109], v[44:45], v[206:207], v[108:109] op_sel_hi:[1,0,1]
  v_pk_fma_f32 v[110:111], v[46:47], v[206:207], v[110:111] op_sel_hi:[1,0,1]
  v_pk_mul_f32 v[96:97], v[96:97], v[138:139] op_sel_hi:[1,0]
  v_pk_mul_f32 v[98:99], v[98:99], v[138:139] op_sel_hi:[1,0]
  v_pk_mul_f32 v[100:101], v[100:101], v[138:139] op_sel_hi:[1,0]
  v_pk_mul_f32 v[102:103], v[102:103], v[138:139] op_sel_hi:[1,0]
  v_pk_mul_f32 v[104:105], v[104:105], v[138:139] op_sel_hi:[1,0]
  v_pk_mul_f32 v[106:107], v[106:107], v[138:139] op_sel_hi:[1,0]
  v_pk_mul_f32 v[108:109], v[108:109], v[138:139] op_sel_hi:[1,0]
  v_pk_mul_f32 v[110:111], v[110:111], v[138:139] op_sel_hi:[1,0]
  v_cvt_pk_bf16_f32 v96, v96, v97
  v_cvt_pk_bf16_f32 v97, v98, v99
  v_cvt_pk_bf16_f32 v98, v100, v101
  v_cvt_pk_bf16_f32 v99, v102, v103
  v_cvt_pk_bf16_f32 v100, v104, v105
  v_cvt_pk_bf16_f32 v101, v106, v107
  v_cvt_pk_bf16_f32 v102, v108, v109
  v_cvt_pk_bf16_f32 v103, v110, v111
  s_cmp_eq_u32 s30, 0
  s_cbranch_scc1 L_wt_61
  buffer_store_dwordx2 v[96:97], v24, s[8:11], s59 offen
  buffer_store_dwordx2 v[98:99], v25, s[8:11], s59 offen
  buffer_store_dwordx2 v[100:101], v26, s[8:11], s59 offen
  buffer_store_dwordx2 v[102:103], v27, s[8:11], s59 offen
L_wj_62:
  v_pk_fma_f32 v[112:113], v[188:189], v[218:219], v[112:113] op_sel_hi:[1,0,1]
  v_pk_fma_f32 v[114:115], v[190:191], v[218:219], v[114:115] op_sel_hi:[1,0,1]
  v_pk_fma_f32 v[116:117], v[192:193], v[218:219], v[116:117] op_sel_hi:[1,0,1]
  v_pk_fma_f32 v[118:119], v[194:195], v[218:219], v[118:119] op_sel_hi:[1,0,1]
  v_pk_fma_f32 v[120:121], v[196:197], v[218:219], v[120:121] op_sel_hi:[1,0,1]
  v_pk_fma_f32 v[122:123], v[198:199], v[218:219], v[122:123] op_sel_hi:[1,0,1]
  v_pk_fma_f32 v[124:125], v[200:201], v[218:219], v[124:125] op_sel_hi:[1,0,1]
  v_pk_fma_f32 v[126:127], v[202:203], v[218:219], v[126:127] op_sel_hi:[1,0,1]
  v_pk_mul_f32 v[112:113], v[112:113], v[156:157]
  v_pk_mul_f32 v[114:115], v[114:115], v[158:159]
  v_pk_mul_f32 v[116:117], v[116:117], v[160:161]
  v_pk_mul_f32 v[118:119], v[118:119], v[162:163]
  v_pk_mul_f32 v[120:121], v[120:121], v[164:165]
  v_pk_mul_f32 v[122:123], v[122:123], v[166:167]
  v_pk_mul_f32 v[124:125], v[124:125], v[168:169]
  v_pk_mul_f32 v[126:127], v[126:127], v[170:171]
  v_cvt_pk_bf16_f32 v112, v112, v113
  v_cvt_pk_bf16_f32 v113, v114, v115
  v_cvt_pk_bf16_f32 v114, v116, v117
  v_cvt_pk_bf16_f32 v115, v118, v119
  v_cvt_pk_bf16_f32 v116, v120, v121
  v_cvt_pk_bf16_f32 v117, v122, v123
  v_cvt_pk_bf16_f32 v118, v124, v125
  v_cvt_pk_bf16_f32 v119, v126, v127
  s_cmp_eq_u32 s30, 0
  s_cbranch_scc1 L_wt_63
  buffer_store_dwordx4 v[112:115], v28, s[8:11], s59 offen offset:0
  buffer_store_dwordx4 v[116:119], v28, s[8:11], s59 offen offset:640
L_wj_64:
  s_branch L_qjoin_13
L_pvq_16:
  s_lshl_b32 s33, s36, 5
  s_sub_u32 s33, s33, 160
  s_mov_b32 s35, 163520
  v_mul_u32_u24 v133, 320, v130
  v_add_u32 v133, 328960, v133
  v_add_u32 v131, s33, v129
  v_mul_u32_u24 v132, 205, v131
  v_lshrrev_b32 v132, 12, v132
  v_lshl_add_u32 v24, v131, 4, v133
  v_mad_u32_u24 v24, v132, s35, v24
  v_lshrrev_b32 v132, 2, v132
  v_lshl_or_b32 v24, v132, 25, v24
  s_xor_b32 s36, s36, 1
  s_lshl_b32 s33, s36, 3
  s_mov_b32 s35, 162560
  s_mov_b32 s34, 161280
  v_lshlrev_b32 v133, 3, v129
  v_add3_u32 v131, s33, v130, 0
  v_mul_u32_u24 v132, 205, v131
  v_lshrrev_b32 v132, 10, v132
  v_lshl_add_u32 v28, v131, 8, v133
  v_mul_u32_u24 v131, s35, v132
  v_lshrrev_b32 v132, 1, v132
  v_subrev_u32 v131, 327680, v131
  v_mul_u32_u24 v132, s34, v132
  v_max_i32 v131, v131, v132
  v_add_u32 v28, v131, v28
  v_add3_u32 v131, s33, v130, 2
  v_mul_u32_u24 v132, 205, v131
  v_lshrrev_b32 v132, 10, v132
  v_lshl_add_u32 v29, v131, 8, v133
  v_mul_u32_u24 v131, s35, v132
  v_lshrrev_b32 v132, 1, v132
  v_subrev_u32 v131, 327680, v131
  v_mul_u32_u24 v132, s34, v132
  v_max_i32 v131, v131, v132
  v_add_u32 v29, v131, v29
  v_add3_u32 v131, s33, v130, 4
  v_mul_u32_u24 v132, 205, v131
  v_lshrrev_b32 v132, 10, v132
  v_lshl_add_u32 v30, v131, 8, v133
  v_mul_u32_u24 v131, s35, v132
  v_lshrrev_b32 v132, 1, v132
  v_subrev_u32 v131, 327680, v131
  v_mul_u32_u24 v132, s34, v132
  v_max_i32 v131, v131, v132
  v_add_u32 v30, v131, v30
  v_add3_u32 v131, s33, v130, 6
  v_mul_u32_u24 v132, 205, v131
  v_lshrrev_b32 v132, 10, v132
  v_lshl_add_u32 v31, v131, 8, v133
  v_mul_u32_u24 v131, s35, v132
  v_lshrrev_b32 v132, 1, v132
  v_subrev_u32 v131, 327680, v131
  v_mul_u32_u24 v132, s34, v132
  v_max_i32 v131, v131, v132
  v_add_u32 v31, v131, v31
  s_add_u32 m0, s61, 33024
  s_nop 0
  buffer_load_dwordx4 v8, s[16:19], s38 offen offset:0 lds
  buffer_load_dwordx4 v9, s[16:19], s38 offen offset:1024 lds
  buffer_load_dwordx4 v10, s[16:19], s38 offen offset:2048 lds
  buffer_load_dwordx4 v11, s[16:19], s38 offen offset:3072 lds
  s_lshl_b32 s37, s62, 7
  s_add_u32 s37, s37, s63
  s_mul_i32 s38, s62, 245760
  s_add_u32 s38, s38, s29
  s_add_u32 s62, s62, 1
  s_cmp_eq_u32 s62, 10
  s_cselect_b32 s62, 0, s62
  global_load_dword v135, v139, s[48:49] sc1
  s_cmp_lg_u32 s28, 2
  s_cbranch_scc1 L_ntw_70
  s_load_dwordx2 s[6:7], s[0:1], 56
  v_lshlrev_b32 v138, 21, v1
  v_and_b32 v140, 0x200000, v138
  buffer_load_dword v254, v138, s[8:11], 0 offen sc1
  global_load_dword v254, v139, s[50:51]
  global_load_dword v254, v139, s[52:53]
  global_load_dword v254, v139, s[54:55]
  global_load_dword v254, v139, s[56:57]
  s_waitcnt lgkmcnt(0)
  global_load_dword v254, v140, s[6:7] sc1
L_ntw_70:
  s_cmp_eq_u32 s28, 2
  s_waitcnt vmcnt(15)
  s_cbranch_scc1 L_qfw_71
  s_waitcnt vmcnt(9)
L_qfw_71:
  s_barrier
  ds_read_b128 v[32:35], v16 offset:0
  ds_read_b64_tr_b16 v[48:49], v18 offset:0
  ds_read_b64_tr_b16 v[50:51], v18 offset:1024
  ds_read_b128 v[36:39], v17 offset:0
  ds_read_b64_tr_b16 v[52:53], v19 offset:0
  ds_read_b64_tr_b16 v[54:55], v19 offset:1024
.p2align 6
L_qloop_65:
  s_waitcnt lgkmcnt(0)
  s_add_u32 m0, s60, s39
  v_mfma_f32_32x32x16_bf16 v[64:79], v[32:35], v[48:51], v[64:79]
  ds_read_b128 v[40:43], v16 offset:32
  ds_read_b64_tr_b16 v[56:57], v18 offset:4096
  ds_read_b64_tr_b16 v[58:59], v18 offset:5120
  v_lshlrev_b32 v216, 16, v32
  v_and_b32 v217, s3, v32
  v_lshlrev_b32 v218, 16, v33
  v_mfma_f32_32x32x16_bf16 v[80:95], v[52:55], v[32:35], v[80:95]
  ds_read_b128 v[44:47], v17 offset:32
  ds_read_b64_tr_b16 v[60:61], v19 offset:4096
  ds_read_b64_tr_b16 v[62:63], v19 offset:5120
  buffer_load_dwordx4 v4, s[12:15], s37 offen offset:0 lds
  buffer_load_dwordx4 v5, s[12:15], s37 offen offset:1040 lds
  v_and_b32 v219, s3, v33
  v_fmac_f32 v206, v216, v216
  v_mfma_f32_16x16x32_bf16 v[212:215], v[20:23], v[48:51], v[212:215]
  v_fmac_f32 v207, v217, v217
  v_lshlrev_b32 v220, 16, v34
  v_mfma_f32_32x32x16_bf16 v[96:111], v[36:39], v[48:51], v[96:111]
  buffer_load_dwordx4 v6, s[12:15], s37 offen offset:2080 lds
  v_and_b32 v221, s3, v34
  v_fmac_f32 v206, v218, v218
  v_fmac_f32 v207, v219, v219
  v_lshlrev_b32 v222, 16, v35
  v_and_b32 v223, s3, v35
  v_mfma_f32_32x32x16_bf16 v[112:127], v[52:55], v[36:39], v[112:127]
  v_fmac_f32 v206, v220, v220
  v_fmac_f32 v207, v221, v221
  v_fmac_f32 v206, v222, v222
  v_fmac_f32 v207, v223, v223
  buffer_load_dwordx4 v7, s[12:15], s37 offen offset:3120 lds
  s_add_u32 m0, s61, s39
  v_mfma_f32_16x16x32_bf16 v[208:211], v[20:23], v[32:35], v[208:211]
  s_waitcnt lgkmcnt(0)
  v_mfma_f32_32x32x16_bf16 v[64:79], v[40:43], v[56:59], v[64:79]
  ds_read_b128 v[32:35], v16 offset:64
  ds_read_b64_tr_b16 v[48:49], v18 offset:8192
  ds_read_b64_tr_b16 v[50:51], v18 offset:9216
  v_lshlrev_b32 v216, 16, v40
  v_and_b32 v217, s3, v40
  v_lshlrev_b32 v218, 16, v41
  v_mfma_f32_32x32x16_bf16 v[80:95], v[60:63], v[40:43], v[80:95]
  ds_read_b128 v[36:39], v17 offset:64
  ds_read_b64_tr_b16 v[52:53], v19 offset:8192
  ds_read_b64_tr_b16 v[54:55], v19 offset:9216
  buffer_load_dwordx4 v8, s[16:19], s38 offen offset:0 lds
  buffer_load_dwordx4 v9, s[16:19], s38 offen offset:1024 lds
  v_and_b32 v219, s3, v41
  v_fmac_f32 v206, v216, v216
  v_mfma_f32_16x16x32_bf16 v[212:215], v[20:23], v[56:59], v[212:215]
  v_fmac_f32 v207, v217, v217
  v_lshlrev_b32 v220, 16, v42
  v_mfma_f32_32x32x16_bf16 v[96:111], v[44:47], v[56:59], v[96:111]
  buffer_load_dwordx4 v10, s[16:19], s38 offen offset:2048 lds
  v_and_b32 v221, s3, v42
  v_fmac_f32 v206, v218, v218
  v_fmac_f32 v207, v219, v219
  v_lshlrev_b32 v222, 16, v43
  v_and_b32 v223, s3, v43
  v_mfma_f32_32x32x16_bf16 v[112:127], v[60:63], v[44:47], v[112:127]
  v_fmac_f32 v206, v220, v220
  v_fmac_f32 v207, v221, v221
  v_fmac_f32 v206, v222, v222
  v_fmac_f32 v207, v223, v223
  buffer_load_dwordx4 v11, s[16:19], s38 offen offset:3072 lds
  s_mov_b32 s39, s40
  v_mfma_f32_16x16x32_bf16 v[208:211], v[20:23], v[40:43], v[208:211]
  s_waitcnt lgkmcnt(0)
  v_mfma_f32_32x32x16_bf16 v[64:79], v[32:35], v[48:51], v[64:79]
  ds_read_b128 v[40:43], v16 offset:96
  ds_read_b64_tr_b16 v[56:57], v18 offset:12288
  ds_read_b64_tr_b16 v[58:59], v18 offset:13312
  v_lshlrev_b32 v216, 16, v32
  v_and_b32 v217, s3, v32
  v_lshlrev_b32 v218, 16, v33
  v_mfma_f32_32x32x16_bf16 v[80:95], v[52:55], v[32:35], v[80:95]
  ds_read_b128 v[44:47], v17 offset:96
  ds_read_b64_tr_b16 v[60:61], v19 offset:12288
  ds_read_b64_tr_b16 v[62:63], v19 offset:13312
  s_add_u32 s40, s40, 33024
  s_cmp_eq_u32 s40, 99072
  s_cselect_b32 s40, 0, s40
  v_and_b32 v219, s3, v33
  v_fmac_f32 v206, v216, v216
  v_mfma_f32_16x16x32_bf16 v[212:215], v[20:23], v[48:51], v[212:215]
  v_fmac_f32 v207, v217, v217
  v_lshlrev_b32 v220, 16, v34
  v_mfma_f32_32x32x16_bf16 v[96:111], v[36:39], v[48:51], v[96:111]
  s_add_u32 s41, s41, 1
  v_and_b32 v221, s3, v34
  v_fmac_f32 v206, v218, v218
  v_fmac_f32 v207, v219, v219
  v_lshlrev_b32 v222, 16, v35
  v_and_b32 v223, s3, v35
  v_mfma_f32_32x32x16_bf16 v[112:127], v[52:55], v[36:39], v[112:127]
  v_fmac_f32 v206, v220, v220
  v_fmac_f32 v207, v221, v221
  v_fmac_f32 v206, v222, v222
  v_fmac_f32 v207, v223, v223
  v_add_u32 v16, s40, v12
  v_add_u32 v17, s40, v13
  v_add_u32 v18, s40, v14
  v_add_u32 v19, s40, v15
  v_mfma_f32_16x16x32_bf16 v[208:211], v[20:23], v[32:35], v[208:211]
  s_waitcnt lgkmcnt(0)
  v_mfma_f32_32x32x16_bf16 v[64:79], v[40:43], v[56:59], v[64:79]
  s_waitcnt vmcnt(8)
  s_barrier
  ds_read_b128 v[32:35], v16 offset:0
  ds_read_b64_tr_b16 v[48:49], v18 offset:0
  ds_read_b64_tr_b16 v[50:51], v18 offset:1024
  v_mfma_f32_32x32x16_bf16 v[80:95], v[60:63], v[40:43], v[80:95]
  ds_read_b128 v[36:39], v17 offset:0
  ds_read_b64_tr_b16 v[52:53], v19 offset:0
  ds_read_b64_tr_b16 v[54:55], v19 offset:1024
  v_lshlrev_b32 v216, 16, v40
  v_and_b32 v217, s3, v40
  v_lshlrev_b32 v218, 16, v41
  v_and_b32 v219, s3, v41
  v_mfma_f32_16x16x32_bf16 v[212:215], v[20:23], v[56:59], v[212:215]
  v_fmac_f32 v206, v216, v216
  v_fmac_f32 v207, v217, v217
  v_mfma_f32_32x32x16_bf16 v[96:111], v[44:47], v[56:59], v[96:111]
  v_lshlrev_b32 v220, 16, v42
  v_and_b32 v221, s3, v42
  v_fmac_f32 v206, v218, v218
  v_fmac_f32 v207, v219, v219
  v_lshlrev_b32 v222, 16, v43
  v_and_b32 v223, s3, v43
  v_mfma_f32_32x32x16_bf16 v[112:127], v[60:63], v[44:47], v[112:127]
  v_fmac_f32 v206, v220, v220
  v_fmac_f32 v207, v221, v221
  v_fmac_f32 v206, v222, v222
  v_fmac_f32 v207, v223, v223
  v_mfma_f32_16x16x32_bf16 v[208:211], v[20:23], v[40:43], v[208:211]
  s_lshl_b32 s37, s62, 7
  s_add_u32 s37, s37, s63
  s_mul_i32 s38, s62, 245760
  s_add_u32 s38, s38, s29
  s_add_u32 s62, s62, 1
  s_cmp_eq_u32 s62, 10
  s_cselect_b32 s62, 0, s62
  s_cmp_eq_u32 s41, 2
  s_cbranch_scc1 L_qhook_67
  s_cmp_lt_u32 s41, 8
  s_cbranch_scc1 L_qloop_65
  s_sub_u32 s33, 127, s101
  s_lshl_b32 s34, s33, 13
  s_cmp_ge_u32 s34, L_mk_end-L_att_begin
  s_cbranch_scc1 L_npf_74
  s_getpc_b64 s[50:51]
L_pc_73:
  s_add_u32 s50, s50, L_att_begin-L_pc_73
  s_addc_u32 s51, s51, 0
  v_lshl_add_u32 v255, v1, 7, s34
  v_min_u32 v255, L_mk_end-L_att_begin-4, v255
  global_load_dword v255, v255, s[50:51]
L_npf_74:
  buffer_load_dword v135, v137, s[8:11], 0 offen sc1
  buffer_load_dword v254, v128, s[8:11], 0 offen sc1
L_qloop_66:
  s_waitcnt lgkmcnt(0)
  v_mfma_f32_32x32x16_bf16 v[64:79], v[32:35], v[48:51], v[64:79]
  ds_read_b128 v[40:43], v16 offset:32
  ds_read_b64_tr_b16 v[56:57], v18 offset:4096
  ds_read_b64_tr_b16 v[58:59], v18 offset:5120
  v_lshlrev_b32 v216, 16, v32
  v_and_b32 v217, s3, v32
  v_lshlrev_b32 v218, 16, v33
  v_mfma_f32_32x32x16_bf16 v[80:95], v[52:55], v[32:35], v[80:95]
  ds_read_b128 v[44:47], v17 offset:32
  ds_read_b64_tr_b16 v[60:61], v19 offset:4096
  ds_read_b64_tr_b16 v[62:63], v19 offset:5120
  v_and_b32 v219, s3, v33
  v_fmac_f32 v206, v216, v216
  v_mfma_f32_16x16x32_bf16 v[212:215], v[20:23], v[48:51], v[212:215]
  v_fmac_f32 v207, v217, v217
  v_lshlrev_b32 v220, 16, v34
  v_mfma_f32_32x32x16_bf16 v[96:111], v[36:39], v[48:51], v[96:111]
  v_and_b32 v221, s3, v34
  v_fmac_f32 v206, v218, v218
  v_fmac_f32 v207, v219, v219
  v_lshlrev_b32 v222, 16, v35
  v_and_b32 v223, s3, v35
  v_mfma_f32_32x32x16_bf16 v[112:127], v[52:55], v[36:39], v[112:127]
  v_fmac_f32 v206, v220, v220
  v_fmac_f32 v207, v221, v221
  v_fmac_f32 v206, v222, v222
  v_fmac_f32 v207, v223, v223
  v_mfma_f32_16x16x32_bf16 v[208:211], v[20:23], v[32:35], v[208:211]
  s_waitcnt lgkmcnt(0)
  v_mfma_f32_32x32x16_bf16 v[64:79], v[40:43], v[56:59], v[64:79]
  ds_read_b128 v[32:35], v16 offset:64
  ds_read_b64_tr_b16 v[48:49], v18 offset:8192
  ds_read_b64_tr_b16 v[50:51], v18 offset:9216
  v_lshlrev_b32 v216, 16, v40
  v_and_b32 v217, s3, v40
  v_lshlrev_b32 v218, 16, v41
  v_mfma_f32_32x32x16_bf16 v[80:95], v[60:63], v[40:43], v[80:95]
  ds_read_b128 v[36:39], v17 offset:64
  ds_read_b64_tr_b16 v[52:53], v19 offset:8192
  ds_read_b64_tr_b16 v[54:55], v19 offset:9216
  v_and_b32 v219, s3, v41
  v_fmac_f32 v206, v216, v216
  v_mfma_f32_16x16x32_bf16 v[212:215], v[20:23], v[56:59], v[212:215]
  v_fmac_f32 v207, v217, v217
  v_lshlrev_b32 v220, 16, v42
  v_mfma_f32_32x32x16_bf16 v[96:111], v[44:47], v[56:59], v[96:111]
  v_and_b32 v221, s3, v42
  v_fmac_f32 v206, v218, v218
  v_fmac_f32 v207, v219, v219
  v_lshlrev_b32 v222, 16, v43
  v_and_b32 v223, s3, v43
  v_mfma_f32_32x32x16_bf16 v[112:127], v[60:63], v[44:47], v[112:127]
  v_fmac_f32 v206, v220, v220
  v_fmac_f32 v207, v221, v221
  v_fmac_f32 v206, v222, v222
  v_fmac_f32 v207, v223, v223
  v_mfma_f32_16x16x32_bf16 v[208:211], v[20:23], v[40:43], v[208:211]
  s_waitcnt lgkmcnt(0)
  v_mfma_f32_32x32x16_bf16 v[64:79], v[32:35], v[48:51], v[64:79]
  ds_read_b128 v[40:43], v16 offset:96
  ds_read_b64_tr_b16 v[56:57], v18 offset:12288
  ds_read_b64_tr_b16 v[58:59], v18 offset:13312
  v_lshlrev_b32 v216, 16, v32
  v_and_b32 v217, s3, v32
  v_lshlrev_b32 v218, 16, v33
  v_mfma_f32_32x32x16_bf16 v[80:95], v[52:55], v[32:35], v[80:95]
  ds_read_b128 v[44:47], v17 offset:96
  ds_read_b64_tr_b16 v[60:61], v19 offset:12288
  ds_read_b64_tr_b16 v[62:63], v19 offset:13312
  s_add_u32 s40, s40, 33024
  s_cmp_eq_u32 s40, 99072
  s_cselect_b32 s40, 0, s40
  v_and_b32 v219, s3, v33
  v_fmac_f32 v206, v216, v216
  v_mfma_f32_16x16x32_bf16 v[212:215], v[20:23], v[48:51], v[212:215]
  v_fmac_f32 v207, v217, v217
  v_lshlrev_b32 v220, 16, v34
  v_mfma_f32_32x32x16_bf16 v[96:111], v[36:39], v[48:51], v[96:111]
  s_add_u32 s41, s41, 1
  v_and_b32 v221, s3, v34
  v_fmac_f32 v206, v218, v218
  v_fmac_f32 v207, v219, v219
  v_lshlrev_b32 v222, 16, v35
  v_and_b32 v223, s3, v35
  v_mfma_f32_32x32x16_bf16 v[112:127], v[52:55], v[36:39], v[112:127]
  v_fmac_f32 v206, v220, v220
  v_fmac_f32 v207, v221, v221
  v_fmac_f32 v206, v222, v222
  v_fmac_f32 v207, v223, v223
  v_add_u32 v16, s40, v12
  v_add_u32 v17, s40, v13
  v_add_u32 v18, s40, v14
  v_add_u32 v19, s40, v15
  v_mfma_f32_16x16x32_bf16 v[208:211], v[20:23], v[32:35], v[208:211]
  s_waitcnt lgkmcnt(0)
  v_mfma_f32_32x32x16_bf16 v[64:79], v[40:43], v[56:59], v[64:79]
  s_waitcnt vmcnt(2)
  s_barrier
  ds_read_b128 v[32:35], v16 offset:0
  ds_read_b64_tr_b16 v[48:49], v18 offset:0
  ds_read_b64_tr_b16 v[50:51], v18 offset:1024
  v_mfma_f32_32x32x16_bf16 v[80:95], v[60:63], v[40:43], v[80:95]
  ds_read_b128 v[36:39], v17 offset:0
  ds_read_b64_tr_b16 v[52:53], v19 offset:0
  ds_read_b64_tr_b16 v[54:55], v19 offset:1024
  v_lshlrev_b32 v216, 16, v40
  v_and_b32 v217, s3, v40
  v_lshlrev_b32 v218, 16, v41
  v_and_b32 v219, s3, v41
  v_mfma_f32_16x16x32_bf16 v[212:215], v[20:23], v[56:59], v[212:215]
  v_fmac_f32 v206, v216, v216
  v_fmac_f32 v207, v217, v217
  v_mfma_f32_32x32x16_bf16 v[96:111], v[44:47], v[56:59], v[96:111]
  v_lshlrev_b32 v220, 16, v42
  v_and_b32 v221, s3, v42
  v_fmac_f32 v206, v218, v218
  v_fmac_f32 v207, v219, v219
  v_lshlrev_b32 v222, 16, v43
  v_and_b32 v223, s3, v43
  v_mfma_f32_32x32x16_bf16 v[112:127], v[60:63], v[44:47], v[112:127]
  v_fmac_f32 v206, v220, v220
  v_fmac_f32 v207, v221, v221
  v_fmac_f32 v206, v222, v222
  v_fmac_f32 v207, v223, v223
  v_mfma_f32_16x16x32_bf16 v[208:211], v[20:23], v[40:43], v[208:211]
  s_cmp_lt_u32 s41, 10
  s_cbranch_scc1 L_qloop_66
  s_waitcnt vmcnt(1)
  s_mov_b32 s31, 200000
L_idp_79:
  v_xor_b32 v131, s32, v135
  v_cmp_lt_u32 vcc, 15, v131
  s_cbranch_vccz L_idk_80
  buffer_load_dword v135, v137, s[8:11], 0 offen sc1
  s_sub_u32 s31, s31, 1
  s_waitcnt vmcnt(0)
  s_cbranch_scc0 L_idp_79
L_idk_80:
  v_cmp_ne_u32 vcc, 0, v131
  v_add_f32 v206, v206, v207
  v_mov_b32 v131, v206
  s_cmp_lg_u64 vcc, 0
  s_cselect_b32 s30, 0, 1
  v_permlane32_swap_b32 v131, v206
  s_nop 1
  v_add_f32 v206, v206, v131
  v_mul_f32 v208, 0x3acccccd, v208
  v_mul_f32 v206, 0x3acccccd, v206
  v_fma_f32 v206, -v208, v208, v206
  v_max_f32 v206, 0, v206
  v_add_f32 v206, 0x3727c5ac, v206
  v_rsq_f32 v206, v206
  v_sub_f32 v208, 0, v208
  s_lshl_b32 s35, s28, 7
  s_add_u32 s35, s35, 132096
  v_lshl_add_u32 v131, v129, 2, s35
  s_lshl_b32 s33, s43, 8
  s_lshl_b32 s34, s42, 7
  s_add_u32 s33, s33, s34
  s_add_u32 s33, s33, 133120
  v_lshl_add_u32 v132, v129, 2, s33
  ds_write_b32 v131, v206
  ds_write_b32 v131, v208 offset:512
  ds_write_b32 v132, v212
  v_xor_b32 v4, 128, v131
  v_xor_b32 v5, 128, v132
  v_lshl_add_u32 v6, v130, 4, s33
  v_xor_b32 v7, 128, v6
  v_lshl_add_u32 v8, v130, 4, s35
  v_xor_b32 v9, 128, v8
  s_waitcnt lgkmcnt(0)
  s_barrier
  ds_read_b32 v134, v131
  ds_read_b32 v136, v131 offset:512
  ds_read_b32 v138, v4
  ds_read_b32 v206, v4 offset:512
  ds_read_b32 v216, v132
  ds_read_b128 v[48:51], v7 offset:0
  ds_read_b128 v[52:55], v7 offset:32
  ds_read_b128 v[56:59], v7 offset:64
  ds_read_b128 v[60:63], v7 offset:96
  ds_read_b128 v[172:175], v8 offset:512
  ds_read_b128 v[176:179], v8 offset:544
  ds_read_b128 v[180:183], v8 offset:576
  ds_read_b128 v[184:187], v8 offset:608
  ds_read_b128 v[140:143], v8 offset:0
  ds_read_b128 v[144:147], v8 offset:32
  ds_read_b128 v[148:151], v8 offset:64
  ds_read_b128 v[152:155], v8 offset:96
  ds_read_b128 v[188:191], v9 offset:512
  ds_read_b128 v[192:195], v9 offset:544
  ds_read_b128 v[196:199], v9 offset:576
  ds_read_b128 v[200:203], v9 offset:608
  ds_read_b128 v[156:159], v9 offset:0
  ds_read_b128 v[160:163], v9 offset:32
  ds_read_b128 v[164:167], v9 offset:64
  ds_read_b128 v[168:171], v9 offset:96
  s_waitcnt lgkmcnt(0)
  v_mul_f32 v134, 0x3f1166db, v134
  v_mul_f32 v138, 0x3f1166db, v138
  v_pk_fma_f32 v[64:65], v[172:173], v[216:217], v[64:65] op_sel_hi:[1,0,1]
  v_pk_fma_f32 v[66:67], v[174:175], v[216:217], v[66:67] op_sel_hi:[1,0,1]
  v_pk_fma_f32 v[68:69], v[176:177], v[216:217], v[68:69] op_sel_hi:[1,0,1]
  v_pk_fma_f32 v[70:71], v[178:179], v[216:217], v[70:71] op_sel_hi:[1,0,1]
  v_pk_fma_f32 v[72:73], v[180:181], v[216:217], v[72:73] op_sel_hi:[1,0,1]
  v_pk_fma_f32 v[74:75], v[182:183], v[216:217], v[74:75] op_sel_hi:[1,0,1]
  v_pk_fma_f32 v[76:77], v[184:185], v[216:217], v[76:77] op_sel_hi:[1,0,1]
  v_pk_fma_f32 v[78:79], v[186:187], v[216:217], v[78:79] op_sel_hi:[1,0,1]
  v_pk_mul_f32 v[64:65], v[64:65], v[140:141]
  v_pk_mul_f32 v[66:67], v[66:67], v[142:143]
  v_pk_mul_f32 v[68:69], v[68:69], v[144:145]
  v_pk_mul_f32 v[70:71], v[70:71], v[146:147]
  v_pk_mul_f32 v[72:73], v[72:73], v[148:149]
  v_pk_mul_f32 v[74:75], v[74:75], v[150:151]
  v_pk_mul_f32 v[76:77], v[76:77], v[152:153]
  v_pk_mul_f32 v[78:79], v[78:79], v[154:155]
  v_cvt_pk_bf16_f32 v64, v64, v65
  v_cvt_pk_bf16_f32 v65, v66, v67
  v_cvt_pk_bf16_f32 v66, v68, v69
  v_cvt_pk_bf16_f32 v67, v70, v71
  v_cvt_pk_bf16_f32 v68, v72, v73
  v_cvt_pk_bf16_f32 v69, v74, v75
  v_cvt_pk_bf16_f32 v70, v76, v77
  v_cvt_pk_bf16_f32 v71, v78, v79
  s_cmp_eq_u32 s30, 0
  s_cbranch_scc1 L_wt_81
  buffer_store_dwordx4 v[64:67], v24, s[8:11], s58 offen offset:0
  buffer_store_dwordx4 v[68:71], v24, s[8:11], s58 offen offset:640
L_wj_82:
  v_pk_fma_f32 v[80:81], v[48:49], v[136:137], v[80:81] op_sel_hi:[1,0,1]
  v_pk_fma_f32 v[82:83], v[50:51], v[136:137], v[82:83] op_sel_hi:[1,0,1]
  v_pk_fma_f32 v[84:85], v[52:53], v[136:137], v[84:85] op_sel_hi:[1,0,1]
  v_pk_fma_f32 v[86:87], v[54:55], v[136:137], v[86:87] op_sel_hi:[1,0,1]
  v_pk_fma_f32 v[88:89], v[56:57], v[136:137], v[88:89] op_sel_hi:[1,0,1]
  v_pk_fma_f32 v[90:91], v[58:59], v[136:137], v[90:91] op_sel_hi:[1,0,1]
  v_pk_fma_f32 v[92:93], v[60:61], v[136:137], v[92:93] op_sel_hi:[1,0,1]
  v_pk_fma_f32 v[94:95], v[62:63], v[136:137], v[94:95] op_sel_hi:[1,0,1]
  v_pk_mul_f32 v[80:81], v[80:81], v[134:135] op_sel_hi:[1,0]
  v_pk_mul_f32 v[82:83], v[82:83], v[134:135] op_sel_hi:[1,0]
  v_pk_mul_f32 v[84:85], v[84:85], v[134:135] op_sel_hi:[1,0]
  v_pk_mul_f32 v[86:87], v[86:87], v[134:135] op_sel_hi:[1,0]
  v_pk_mul_f32 v[88:89], v[88:89], v[134:135] op_sel_hi:[1,0]
  v_pk_mul_f32 v[90:91], v[90:91], v[134:135] op_sel_hi:[1,0]
  v_pk_mul_f32 v[92:93], v[92:93], v[134:135] op_sel_hi:[1,0]
  v_pk_mul_f32 v[94:95], v[94:95], v[134:135] op_sel_hi:[1,0]
  v_cvt_pk_bf16_f32 v80, v80, v81
  v_cvt_pk_bf16_f32 v81, v82, v83
  v_cvt_pk_bf16_f32 v82, v84, v85
  v_cvt_pk_bf16_f32 v83, v86, v87
  v_cvt_pk_bf16_f32 v84, v88, v89
  v_cvt_pk_bf16_f32 v85, v90, v91
  v_cvt_pk_bf16_f32 v86, v92, v93
  v_cvt_pk_bf16_f32 v87, v94, v95
  s_cmp_eq_u32 s30, 0
  s_cbranch_scc1 L_wt_83
  buffer_store_dwordx2 v[80:81], v28, s[8:11], s58 offen
  buffer_store_dwordx2 v[82:83], v29, s[8:11], s58 offen
  buffer_store_dwordx2 v[84:85], v30, s[8:11], s58 offen
  buffer_store_dwordx2 v[86:87], v31, s[8:11], s58 offen
L_wj_84:
  v_pk_fma_f32 v[96:97], v[188:189], v[216:217], v[96:97] op_sel_hi:[1,0,1]
  v_pk_fma_f32 v[98:99], v[190:191], v[216:217], v[98:99] op_sel_hi:[1,0,1]
  v_pk_fma_f32 v[100:101], v[192:193], v[216:217], v[100:101] op_sel_hi:[1,0,1]
  v_pk_fma_f32 v[102:103], v[194:195], v[216:217], v[102:103] op_sel_hi:[1,0,1]
  v_pk_fma_f32 v[104:105], v[196:197], v[216:217], v[104:105] op_sel_hi:[1,0,1]
  v_pk_fma_f32 v[106:107], v[198:199], v[216:217], v[106:107] op_sel_hi:[1,0,1]
  v_pk_fma_f32 v[108:109], v[200:201], v[216:217], v[108:109] op_sel_hi:[1,0,1]
  v_pk_fma_f32 v[110:111], v[202:203], v[216:217], v[110:111] op_sel_hi:[1,0,1]
  v_pk_mul_f32 v[96:97], v[96:97], v[156:157]
  v_pk_mul_f32 v[98:99], v[98:99], v[158:159]
  v_pk_mul_f32 v[100:101], v[100:101], v[160:161]
  v_pk_mul_f32 v[102:103], v[102:103], v[162:163]
  v_pk_mul_f32 v[104:105], v[104:105], v[164:165]
  v_pk_mul_f32 v[106:107], v[106:107], v[166:167]
  v_pk_mul_f32 v[108:109], v[108:109], v[168:169]
  v_pk_mul_f32 v[110:111], v[110:111], v[170:171]
  v_cvt_pk_bf16_f32 v96, v96, v97
  v_cvt_pk_bf16_f32 v97, v98, v99
  v_cvt_pk_bf16_f32 v98, v100, v101
  v_cvt_pk_bf16_f32 v99, v102, v103
  v_cvt_pk_bf16_f32 v100, v104, v105
  v_cvt_pk_bf16_f32 v101, v106, v107
  v_cvt_pk_bf16_f32 v102, v108, v109
  v_cvt_pk_bf16_f32 v103, v110, v111
  s_cmp_eq_u32 s30, 0
  s_cbranch_scc1 L_wt_85
  buffer_store_dwordx4 v[96:99], v24, s[8:11], s59 offen offset:0
  buffer_store_dwordx4 v[100:103], v24, s[8:11], s59 offen offset:640
L_wj_86:
  v_pk_fma_f32 v[112:113], v[48:49], v[206:207], v[112:113] op_sel_hi:[1,0,1]
  v_pk_fma_f32 v[114:115], v[50:51], v[206:207], v[114:115] op_sel_hi:[1,0,1]
  v_pk_fma_f32 v[116:117], v[52:53], v[206:207], v[116:117] op_sel_hi:[1,0,1]
  v_pk_fma_f32 v[118:119], v[54:55], v[206:207], v[118:119] op_sel_hi:[1,0,1]
  v_pk_fma_f32 v[120:121], v[56:57], v[206:207], v[120:121] op_sel_hi:[1,0,1]
  v_pk_fma_f32 v[122:123], v[58:59], v[206:207], v[122:123] op_sel_hi:[1,0,1]
  v_pk_fma_f32 v[124:125], v[60:61], v[206:207], v[124:125] op_sel_hi:[1,0,1]
  v_pk_fma_f32 v[126:127], v[62:63], v[206:207], v[126:127] op_sel_hi:[1,0,1]
  v_pk_mul_f32 v[112:113], v[112:113], v[138:139] op_sel_hi:[1,0]
  v_pk_mul_f32 v[114:115], v[114:115], v[138:139] op_sel_hi:[1,0]
  v_pk_mul_f32 v[116:117], v[116:117], v[138:139] op_sel_hi:[1,0]
  v_pk_mul_f32 v[118:119], v[118:119], v[138:139] op_sel_hi:[1,0]
  v_pk_mul_f32 v[120:121], v[120:121], v[138:139] op_sel_hi:[1,0]
  v_pk_mul_f32 v[122:123], v[122:123], v[138:139] op_sel_hi:[1,0]
  v_pk_mul_f32 v[124:125], v[124:125], v[138:139] op_sel_hi:[1,0]
  v_pk_mul_f32 v[126:127], v[126:127], v[138:139] op_sel_hi:[1,0]
  v_cvt_pk_bf16_f32 v112, v112, v113
  v_cvt_pk_bf16_f32 v113, v114, v115
  v_cvt_pk_bf16_f32 v114, v116, v117
  v_cvt_pk_bf16_f32 v115, v118, v119
  v_cvt_pk_bf16_f32 v116, v120, v121
  v_cvt_pk_bf16_f32 v117, v122, v123
  v_cvt_pk_bf16_f32 v118, v124, v125
  v_cvt_pk_bf16_f32 v119, v126, v127
  s_cmp_eq_u32 s30, 0
  s_cbranch_scc1 L_wt_87
  buffer_store_dwordx2 v[112:113], v28, s[8:11], s59 offen
  buffer_store_dwordx2 v[114:115], v29, s[8:11], s59 offen
  buffer_store_dwordx2 v[116:117], v30, s[8:11], s59 offen
  buffer_store_dwordx2 v[118:119], v31, s[8:11], s59 offen
L_wj_88:
  s_branch L_qjoin_13
L_pv_14:
  s_lshl_b32 s33, s36, 5
  s_sub_u32 s33, s33, 160
  s_mov_b32 s35, 163520
  v_mul_u32_u24 v133, 320, v130
  v_add_u32 v133, 328960, v133
  v_add_u32 v131, s33, v129
  v_mul_u32_u24 v132, 205, v131
  v_lshrrev_b32 v132, 12, v132
  v_lshl_add_u32 v24, v131, 4, v133
  v_mad_u32_u24 v24, v132, s35, v24
  v_lshrrev_b32 v132, 2, v132
  v_lshl_or_b32 v24, v132, 25, v24
  s_xor_b32 s36, s36, 1
  s_lshl_b32 s33, s36, 5
  s_sub_u32 s33, s33, 160
  s_mov_b32 s35, 163520
  v_mul_u32_u24 v133, 320, v130
  v_add_u32 v133, 328960, v133
  v_add_u32 v131, s33, v129
  v_mul_u32_u24 v132, 205, v131
  v_lshrrev_b32 v132, 12, v132
  v_lshl_add_u32 v28, v131, 4, v133
  v_mad_u32_u24 v28, v132, s35, v28
  v_lshrrev_b32 v132, 2, v132
  v_lshl_or_b32 v28, v132, 25, v28
  s_add_u32 m0, s61, 33024
  s_nop 0
  buffer_load_dwordx4 v8, s[16:19], s38 offen offset:0 lds
  buffer_load_dwordx4 v9, s[16:19], s38 offen offset:1024 lds
  buffer_load_dwordx4 v10, s[16:19], s38 offen offset:2048 lds
  buffer_load_dwordx4 v11, s[16:19], s38 offen offset:3072 lds
  s_lshl_b32 s37, s62, 7
  s_add_u32 s37, s37, s63
  s_mul_i32 s38, s62, 245760
  s_add_u32 s38, s38, s29
  s_add_u32 s62, s62, 1
  s_cmp_eq_u32 s62, 10
  s_cselect_b32 s62, 0, s62
  global_load_dword v135, v139, s[48:49] sc1
  s_cmp_lg_u32 s28, 2
  s_cbranch_scc1 L_ntw_94
  s_load_dwordx2 s[6:7], s[0:1], 56
  v_lshlrev_b32 v138, 21, v1
  v_and_b32 v140, 0x200000, v138
  buffer_load_dword v254, v138, s[8:11], 0 offen sc1
  global_load_dword v254, v139, s[50:51]
  global_load_dword v254, v139, s[52:53]
  global_load_dword v254, v139, s[54:55]
  global_load_dword v254, v139, s[56:57]
  s_waitcnt lgkmcnt(0)
  global_load_dword v254, v140, s[6:7] sc1
L_ntw_94:
  s_cmp_eq_u32 s28, 2
  s_waitcnt vmcnt(15)
  s_cbranch_scc1 L_qfw_95
  s_waitcnt vmcnt(9)
L_qfw_95:
  s_barrier
  ds_read_b128 v[32:35], v16 offset:0
  ds_read_b64_tr_b16 v[48:49], v18 offset:0
  ds_read_b64_tr_b16 v[50:51], v18 offset:1024
  ds_read_b128 v[36:39], v17 offset:0
  ds_read_b64_tr_b16 v[52:53], v19 offset:0
  ds_read_b64_tr_b16 v[54:55], v19 offset:1024
.p2align 6
L_qloop_89:
  s_waitcnt lgkmcnt(0)
  s_add_u32 m0, s60, s39
  v_mfma_f32_32x32x16_bf16 v[64:79], v[32:35], v[48:51], v[64:79]
  ds_read_b128 v[40:43], v16 offset:32
  ds_read_b64_tr_b16 v[56:57], v18 offset:4096
  ds_read_b64_tr_b16 v[58:59], v18 offset:5120
  v_lshlrev_b32 v216, 16, v32
  v_and_b32 v217, s3, v32
  v_lshlrev_b32 v218, 16, v33
  v_mfma_f32_32x32x16_bf16 v[80:95], v[32:35], v[52:55], v[80:95]
  ds_read_b128 v[44:47], v17 offset:32
  ds_read_b64_tr_b16 v[60:61], v19 offset:4096
  ds_read_b64_tr_b16 v[62:63], v19 offset:5120
  buffer_load_dwordx4 v4, s[12:15], s37 offen offset:0 lds
  buffer_load_dwordx4 v5, s[12:15], s37 offen offset:1040 lds
  v_and_b32 v219, s3, v33
  v_fmac_f32 v206, v216, v216
  v_mfma_f32_16x16x32_bf16 v[212:215], v[20:23], v[48:51], v[212:215]
  v_fmac_f32 v207, v217, v217
  v_lshlrev_b32 v220, 16, v34
  v_mfma_f32_32x32x16_bf16 v[96:111], v[36:39], v[48:51], v[96:111]
  buffer_load_dwordx4 v6, s[12:15], s37 offen offset:2080 lds
  v_and_b32 v221, s3, v34
  v_fmac_f32 v206, v218, v218
  v_fmac_f32 v207, v219, v219
  v_lshlrev_b32 v222, 16, v35
  v_and_b32 v223, s3, v35
  v_mfma_f32_32x32x16_bf16 v[112:127], v[36:39], v[52:55], v[112:127]
  v_fmac_f32 v206, v220, v220
  v_fmac_f32 v207, v221, v221
  v_fmac_f32 v206, v222, v222
  v_fmac_f32 v207, v223, v223
  buffer_load_dwordx4 v7, s[12:15], s37 offen offset:3120 lds
  s_add_u32 m0, s61, s39
  v_mfma_f32_16x16x32_bf16 v[208:211], v[20:23], v[32:35], v[208:211]
  s_waitcnt lgkmcnt(0)
  v_mfma_f32_32x32x16_bf16 v[64:79], v[40:43], v[56:59], v[64:79]
  ds_read_b128 v[32:35], v16 offset:64
  ds_read_b64_tr_b16 v[48:49], v18 offset:8192
  ds_read_b64_tr_b16 v[50:51], v18 offset:9216
  v_lshlrev_b32 v216, 16, v40
  v_and_b32 v217, s3, v40
  v_lshlrev_b32 v218, 16, v41
  v_mfma_f32_32x32x16_bf16 v[80:95], v[40:43], v[60:63], v[80:95]
  ds_read_b128 v[36:39], v17 offset:64
  ds_read_b64_tr_b16 v[52:53], v19 offset:8192
  ds_read_b64_tr_b16 v[54:55], v19 offset:9216
  buffer_load_dwordx4 v8, s[16:19], s38 offen offset:0 lds
  buffer_load_dwordx4 v9, s[16:19], s38 offen offset:1024 lds
  v_and_b32 v219, s3, v41
  v_fmac_f32 v206, v216, v216
  v_mfma_f32_16x16x32_bf16 v[212:215], v[20:23], v[56:59], v[212:215]
  v_fmac_f32 v207, v217, v217
  v_lshlrev_b32 v220, 16, v42
  v_mfma_f32_32x32x16_bf16 v[96:111], v[44:47], v[56:59], v[96:111]
  buffer_load_dwordx4 v10, s[16:19], s38 offen offset:2048 lds
  v_and_b32 v221, s3, v42
  v_fmac_f32 v206, v218, v218
  v_fmac_f32 v207, v219, v219
  v_lshlrev_b32 v222, 16, v43
  v_and_b32 v223, s3, v43
  v_mfma_f32_32x32x16_bf16 v[112:127], v[44:47], v[60:63], v[112:127]
  v_fmac_f32 v206, v220, v220
  v_fmac_f32 v207, v221, v221
  v_fmac_f32 v206, v222, v222
  v_fmac_f32 v207, v223, v223
  buffer_load_dwordx4 v11, s[16:19], s38 offen offset:3072 lds
  s_mov_b32 s39, s40
  v_mfma_f32_16x16x32_bf16 v[208:211], v[20:23], v[40:43], v[208:211]
  s_waitcnt lgkmcnt(0)
  v_mfma_f32_32x32x16_bf16 v[64:79], v[32:35], v[48:51], v[64:79]
  ds_read_b128 v[40:43], v16 offset:96
  ds_read_b64_tr_b16 v[56:57], v18 offset:12288
  ds_read_b64_tr_b16 v[58:59], v18 offset:13312
  v_lshlrev_b32 v216, 16, v32
  v_and_b32 v217, s3, v32
  v_lshlrev_b32 v218, 16, v33
  v_mfma_f32_32x32x16_bf16 v[80:95], v[32:35], v[52:55], v[80:95]
  ds_read_b128 v[44:47], v17 offset:96
  ds_read_b64_tr_b16 v[60:61], v19 offset:12288
  ds_read_b64_tr_b16 v[62:63], v19 offset:13312
  s_add_u32 s40, s40, 33024
  s_cmp_eq_u32 s40, 99072
  s_cselect_b32 s40, 0, s40
  v_and_b32 v219, s3, v33
  v_fmac_f32 v206, v216, v216
  v_mfma_f32_16x16x32_bf16 v[212:215], v[20:23], v[48:51], v[212:215]
  v_fmac_f32 v207, v217, v217
  v_lshlrev_b32 v220, 16, v34
  v_mfma_f32_32x32x16_bf16 v[96:111], v[36:39], v[48:51], v[96:111]
  s_add_u32 s41, s41, 1
  v_and_b32 v221, s3, v34
  v_fmac_f32 v206, v218, v218
  v_fmac_f32 v207, v219, v219
  v_lshlrev_b32 v222, 16, v35
  v_and_b32 v223, s3, v35
  v_mfma_f32_32x32x16_bf16 v[112:127], v[36:39], v[52:55], v[112:127]
  v_fmac_f32 v206, v220, v220
  v_fmac_f32 v207, v221, v221
  v_fmac_f32 v206, v222, v222
  v_fmac_f32 v207, v223, v223
  v_add_u32 v16, s40, v12
  v_add_u32 v17, s40, v13
  v_add_u32 v18, s40, v14
  v_add_u32 v19, s40, v15
  v_mfma_f32_16x16x32_bf16 v[208:211], v[20:23], v[32:35], v[208:211]
  s_waitcnt lgkmcnt(0)
  v_mfma_f32_32x32x16_bf16 v[64:79], v[40:43], v[56:59], v[64:79]
  s_waitcnt vmcnt(8)
  s_barrier
  ds_read_b128 v[32:35], v16 offset:0
  ds_read_b64_tr_b16 v[48:49], v18 offset:0
  ds_read_b64_tr_b16 v[50:51], v18 offset:1024
  v_mfma_f32_32x32x16_bf16 v[80:95], v[40:43], v[60:63], v[80:95]
  ds_read_b128 v[36:39], v17 offset:0
  ds_read_b64_tr_b16 v[52:53], v19 offset:0
  ds_read_b64_tr_b16 v[54:55], v19 offset:1024
  v_lshlrev_b32 v216, 16, v40
  v_and_b32 v217, s3, v40
  v_lshlrev_b32 v218, 16, v41
  v_and_b32 v219, s3, v41
  v_mfma_f32_16x16x32_bf16 v[212:215], v[20:23], v[56:59], v[212:215]
  v_fmac_f32 v206, v216, v216
  v_fmac_f32 v207, v217, v217
  v_mfma_f32_32x32x16_bf16 v[96:111], v[44:47], v[56:59], v[96:111]
  v_lshlrev_b32 v220, 16, v42
  v_and_b32 v221, s3, v42
  v_fmac_f32 v206, v218, v218
  v_fmac_f32 v207, v219, v219
  v_lshlrev_b32 v222, 16, v43
  v_and_b32 v223, s3, v43
  v_mfma_f32_32x32x16_bf16 v[112:127], v[44:47], v[60:63], v[112:127]
  v_fmac_f32 v206, v220, v220
  v_fmac_f32 v207, v221, v221
  v_fmac_f32 v206, v222, v222
  v_fmac_f32 v207, v223, v223
  v_mfma_f32_16x16x32_bf16 v[208:211], v[20:23], v[40:43], v[208:211]
  s_lshl_b32 s37, s62, 7
  s_add_u32 s37, s37, s63
  s_mul_i32 s38, s62, 245760
  s_add_u32 s38, s38, s29
  s_add_u32 s62, s62, 1
  s_cmp_eq_u32 s62, 10
  s_cselect_b32 s62, 0, s62
  s_cmp_eq_u32 s41, 2
  s_cbranch_scc1 L_qhook_91
  s_cmp_lt_u32 s41, 8
  s_cbranch_scc1 L_qloop_89
  s_sub_u32 s33, 127, s101
  s_lshl_b32 s34, s33, 13
  s_cmp_ge_u32 s34, L_mk_end-L_att_begin
  s_cbranch_scc1 L_npf_98
  s_getpc_b64 s[50:51]
L_pc_97:
  s_add_u32 s50, s50, L_att_begin-L_pc_97
  s_addc_u32 s51, s51, 0
  v_lshl_add_u32 v255, v1, 7, s34
  v_min_u32 v255, L_mk_end-L_att_begin-4, v255
  global_load_dword v255, v255, s[50:51]
L_npf_98:
  buffer_load_dword v135, v137, s[8:11], 0 offen sc1
  buffer_load_dword v254, v128, s[8:11], 0 offen sc1
L_qloop_90:
  s_waitcnt lgkmcnt(0)
  v_mfma_f32_32x32x16_bf16 v[64:79], v[32:35], v[48:51], v[64:79]
  ds_read_b128 v[40:43], v16 offset:32
  ds_read_b64_tr_b16 v[56:57], v18 offset:4096
  ds_read_b64_tr_b16 v[58:59], v18 offset:5120
  v_lshlrev_b32 v216, 16, v32
  v_and_b32 v217, s3, v32
  v_lshlrev_b32 v218, 16, v33
  v_mfma_f32_32x32x16_bf16 v[80:95], v[32:35], v[52:55], v[80:95]
  ds_read_b128 v[44:47], v17 offset:32
  ds_read_b64_tr_b16 v[60:61], v19 offset:4096
  ds_read_b64_tr_b16 v[62:63], v19 offset:5120
  v_and_b32 v219, s3, v33
  v_fmac_f32 v206, v216, v216
  v_mfma_f32_16x16x32_bf16 v[212:215], v[20:23], v[48:51], v[212:215]
  v_fmac_f32 v207, v217, v217
  v_lshlrev_b32 v220, 16, v34
  v_mfma_f32_32x32x16_bf16 v[96:111], v[36:39], v[48:51], v[96:111]
  v_and_b32 v221, s3, v34
  v_fmac_f32 v206, v218, v218
  v_fmac_f32 v207, v219, v219
  v_lshlrev_b32 v222, 16, v35
  v_and_b32 v223, s3, v35
  v_mfma_f32_32x32x16_bf16 v[112:127], v[36:39], v[52:55], v[112:127]
  v_fmac_f32 v206, v220, v220
  v_fmac_f32 v207, v221, v221
  v_fmac_f32 v206, v222, v222
  v_fmac_f32 v207, v223, v223
  v_mfma_f32_16x16x32_bf16 v[208:211], v[20:23], v[32:35], v[208:211]
  s_waitcnt lgkmcnt(0)
  v_mfma_f32_32x32x16_bf16 v[64:79], v[40:43], v[56:59], v[64:79]
  ds_read_b128 v[32:35], v16 offset:64
  ds_read_b64_tr_b16 v[48:49], v18 offset:8192
  ds_read_b64_tr_b16 v[50:51], v18 offset:9216
  v_lshlrev_b32 v216, 16, v40
  v_and_b32 v217, s3, v40
  v_lshlrev_b32 v218, 16, v41
  v_mfma_f32_32x32x16_bf16 v[80:95], v[40:43], v[60:63], v[80:95]
  ds_read_b128 v[36:39], v17 offset:64
  ds_read_b64_tr_b16 v[52:53], v19 offset:8192
  ds_read_b64_tr_b16 v[54:55], v19 offset:9216
  v_and_b32 v219, s3, v41
  v_fmac_f32 v206, v216, v216
  v_mfma_f32_16x16x32_bf16 v[212:215], v[20:23], v[56:59], v[212:215]
  v_fmac_f32 v207, v217, v217
  v_lshlrev_b32 v220, 16, v42
  v_mfma_f32_32x32x16_bf16 v[96:111], v[44:47], v[56:59], v[96:111]
  v_and_b32 v221, s3, v42
  v_fmac_f32 v206, v218, v218
  v_fmac_f32 v207, v219, v219
  v_lshlrev_b32 v222, 16, v43
  v_and_b32 v223, s3, v43
  v_mfma_f32_32x32x16_bf16 v[112:127], v[44:47], v[60:63], v[112:127]
  v_fmac_f32 v206, v220, v220
  v_fmac_f32 v207, v221, v221
  v_fmac_f32 v206, v222, v222
  v_fmac_f32 v207, v223, v223
  v_mfma_f32_16x16x32_bf16 v[208:211], v[20:23], v[40:43], v[208:211]
  s_waitcnt lgkmcnt(0)
  v_mfma_f32_32x32x16_bf16 v[64:79], v[32:35], v[48:51], v[64:79]
  ds_read_b128 v[40:43], v16 offset:96
  ds_read_b64_tr_b16 v[56:57], v18 offset:12288
  ds_read_b64_tr_b16 v[58:59], v18 offset:13312
  v_lshlrev_b32 v216, 16, v32
  v_and_b32 v217, s3, v32
  v_lshlrev_b32 v218, 16, v33
  v_mfma_f32_32x32x16_bf16 v[80:95], v[32:35], v[52:55], v[80:95]
  ds_read_b128 v[44:47], v17 offset:96
  ds_read_b64_tr_b16 v[60:61], v19 offset:12288
  ds_read_b64_tr_b16 v[62:63], v19 offset:13312
  s_add_u32 s40, s40, 33024
  s_cmp_eq_u32 s40, 99072
  s_cselect_b32 s40, 0, s40
  v_and_b32 v219, s3, v33
  v_fmac_f32 v206, v216, v216
  v_mfma_f32_16x16x32_bf16 v[212:215], v[20:23], v[48:51], v[212:215]
  v_fmac_f32 v207, v217, v217
  v_lshlrev_b32 v220, 16, v34
  v_mfma_f32_32x32x16_bf16 v[96:111], v[36:39], v[48:51], v[96:111]
  s_add_u32 s41, s41, 1
  v_and_b32 v221, s3, v34
  v_fmac_f32 v206, v218, v218
  v_fmac_f32 v207, v219, v219
  v_lshlrev_b32 v222, 16, v35
  v_and_b32 v223, s3, v35
  v_mfma_f32_32x32x16_bf16 v[112:127], v[36:39], v[52:55], v[112:127]
  v_fmac_f32 v206, v220, v220
  v_fmac_f32 v207, v221, v221
  v_fmac_f32 v206, v222, v222
  v_fmac_f32 v207, v223, v223
  v_add_u32 v16, s40, v12
  v_add_u32 v17, s40, v13
  v_add_u32 v18, s40, v14
  v_add_u32 v19, s40, v15
  v_mfma_f32_16x16x32_bf16 v[208:211], v[20:23], v[32:35], v[208:211]
  s_waitcnt lgkmcnt(0)
  v_mfma_f32_32x32x16_bf16 v[64:79], v[40:43], v[56:59], v[64:79]
  s_waitcnt vmcnt(2)
  s_barrier
  ds_read_b128 v[32:35], v16 offset:0
  ds_read_b64_tr_b16 v[48:49], v18 offset:0
  ds_read_b64_tr_b16 v[50:51], v18 offset:1024
  v_mfma_f32_32x32x16_bf16 v[80:95], v[40:43], v[60:63], v[80:95]
  ds_read_b128 v[36:39], v17 offset:0
  ds_read_b64_tr_b16 v[52:53], v19 offset:0
  ds_read_b64_tr_b16 v[54:55], v19 offset:1024
  v_lshlrev_b32 v216, 16, v40
  v_and_b32 v217, s3, v40
  v_lshlrev_b32 v218, 16, v41
  v_and_b32 v219, s3, v41
  v_mfma_f32_16x16x32_bf16 v[212:215], v[20:23], v[56:59], v[212:215]
  v_fmac_f32 v206, v216, v216
  v_fmac_f32 v207, v217, v217
  v_mfma_f32_32x32x16_bf16 v[96:111], v[44:47], v[56:59], v[96:111]
  v_lshlrev_b32 v220, 16, v42
  v_and_b32 v221, s3, v42
  v_fmac_f32 v206, v218, v218
  v_fmac_f32 v207, v219, v219
  v_lshlrev_b32 v222, 16, v43
  v_and_b32 v223, s3, v43
  v_mfma_f32_32x32x16_bf16 v[112:127], v[44:47], v[60:63], v[112:127]
  v_fmac_f32 v206, v220, v220
  v_fmac_f32 v207, v221, v221
  v_fmac_f32 v206, v222, v222
  v_fmac_f32 v207, v223, v223
  v_mfma_f32_16x16x32_bf16 v[208:211], v[20:23], v[40:43], v[208:211]
  s_cmp_lt_u32 s41, 10
  s_cbranch_scc1 L_qloop_90
  s_waitcnt vmcnt(1)
  s_mov_b32 s31, 200000
L_idp_103:
  v_xor_b32 v131, s32, v135
  v_cmp_lt_u32 vcc, 15, v131
  s_cbranch_vccz L_idk_104
  buffer_load_dword v135, v137, s[8:11], 0 offen sc1
  s_sub_u32 s31, s31, 1
  s_waitcnt vmcnt(0)
  s_cbranch_scc0 L_idp_103
L_idk_104:
  v_cmp_ne_u32 vcc, 0, v131
  v_add_f32 v206, v206, v207
  v_mov_b32 v131, v206
  s_cmp_lg_u64 vcc, 0
  s_cselect_b32 s30, 0, 1
  v_permlane32_swap_b32 v131, v206
  s_nop 1
  v_add_f32 v206, v206, v131
  v_mul_f32 v208, 0x3acccccd, v208
  v_mul_f32 v206, 0x3acccccd, v206
  v_fma_f32 v206, -v208, v208, v206
  v_max_f32 v206, 0, v206
  v_add_f32 v206, 0x3727c5ac, v206
  v_rsq_f32 v206, v206
  v_sub_f32 v208, 0, v208
  s_lshl_b32 s35, s28, 7
  s_add_u32 s35, s35, 132096
  v_lshl_add_u32 v131, v129, 2, s35
  s_lshl_b32 s33, s43, 8
  s_lshl_b32 s34, s42, 7
  s_add_u32 s33, s33, s34
  s_add_u32 s33, s33, 133120
  v_lshl_add_u32 v132, v129, 2, s33
  ds_write_b32 v131, v206
  ds_write_b32 v131, v208 offset:512
  ds_write_b32 v132, v212
  v_xor_b32 v4, 128, v131
  v_xor_b32 v5, 128, v132
  v_lshl_add_u32 v6, v130, 4, s33
  v_xor_b32 v7, 128, v6
  v_lshl_add_u32 v8, v130, 4, s35
  v_xor_b32 v9, 128, v8
  s_waitcnt lgkmcnt(0)
  s_barrier
  ds_read_b32 v216, v132
  ds_read_b32 v218, v5
  ds_read_b128 v[172:175], v8 offset:512
  ds_read_b128 v[176:179], v8 offset:544
  ds_read_b128 v[180:183], v8 offset:576
  ds_read_b128 v[184:187], v8 offset:608
  ds_read_b128 v[140:143], v8 offset:0
  ds_read_b128 v[144:147], v8 offset:32
  ds_read_b128 v[148:151], v8 offset:64
  ds_read_b128 v[152:155], v8 offset:96
  ds_read_b128 v[188:191], v9 offset:512
  ds_read_b128 v[192:195], v9 offset:544
  ds_read_b128 v[196:199], v9 offset:576
  ds_read_b128 v[200:203], v9 offset:608
  ds_read_b128 v[156:159], v9 offset:0
  ds_read_b128 v[160:163], v9 offset:32
  ds_read_b128 v[164:167], v9 offset:64
  ds_read_b128 v[168:171], v9 offset:96
  s_waitcnt lgkmcnt(0)
  v_pk_fma_f32 v[64:65], v[172:173], v[216:217], v[64:65] op_sel_hi:[1,0,1]
  v_pk_fma_f32 v[66:67], v[174:175], v[216:217], v[66:67] op_sel_hi:[1,0,1]
  v_pk_fma_f32 v[68:69], v[176:177], v[216:217], v[68:69] op_sel_hi:[1,0,1]
  v_pk_fma_f32 v[70:71], v[178:179], v[216:217], v[70:71] op_sel_hi:[1,0,1]
  v_pk_fma_f32 v[72:73], v[180:181], v[216:217], v[72:73] op_sel_hi:[1,0,1]
  v_pk_fma_f32 v[74:75], v[182:183], v[216:217], v[74:75] op_sel_hi:[1,0,1]
  v_pk_fma_f32 v[76:77], v[184:185], v[216:217], v[76:77] op_sel_hi:[1,0,1]
  v_pk_fma_f32 v[78:79], v[186:187], v[216:217], v[78:79] op_sel_hi:[1,0,1]
  v_pk_mul_f32 v[64:65], v[64:65], v[140:141]
  v_pk_mul_f32 v[66:67], v[66:67], v[142:143]
  v_pk_mul_f32 v[68:69], v[68:69], v[144:145]
  v_pk_mul_f32 v[70:71], v[70:71], v[146:147]
  v_pk_mul_f32 v[72:73], v[72:73], v[148:149]
  v_pk_mul_f32 v[74:75], v[74:75], v[150:151]
  v_pk_mul_f32 v[76:77], v[76:77], v[152:153]
  v_pk_mul_f32 v[78:79], v[78:79], v[154:155]
  v_cvt_pk_bf16_f32 v64, v64, v65
  v_cvt_pk_bf16_f32 v65, v66, v67
  v_cvt_pk_bf16_f32 v66, v68, v69
  v_cvt_pk_bf16_f32 v67, v70, v71
  v_cvt_pk_bf16_f32 v68, v72, v73
  v_cvt_pk_bf16_f32 v69, v74, v75
  v_cvt_pk_bf16_f32 v70, v76, v77
  v_cvt_pk_bf16_f32 v71, v78, v79
  s_cmp_eq_u32 s30, 0
  s_cbranch_scc1 L_wt_105
  buffer_store_dwordx4 v[64:67], v24, s[8:11], s58 offen offset:0
  buffer_store_dwordx4 v[68:71], v24, s[8:11], s58 offen offset:640
L_wj_106:
  v_pk_fma_f32 v[80:81], v[172:173], v[218:219], v[80:81] op_sel_hi:[1,0,1]
  v_pk_fma_f32 v[82:83], v[174:175], v[218:219], v[82:83] op_sel_hi:[1,0,1]
  v_pk_fma_f32 v[84:85], v[176:177], v[218:219], v[84:85] op_sel_hi:[1,0,1]
  v_pk_fma_f32 v[86:87], v[178:179], v[218:219], v[86:87] op_sel_hi:[1,0,1]
  v_pk_fma_f32 v[88:89], v[180:181], v[218:219], v[88:89] op_sel_hi:[1,0,1]
  v_pk_fma_f32 v[90:91], v[182:183], v[218:219], v[90:91] op_sel_hi:[1,0,1]
  v_pk_fma_f32 v[92:93], v[184:185], v[218:219], v[92:93] op_sel_hi:[1,0,1]
  v_pk_fma_f32 v[94:95], v[186:187], v[218:219], v[94:95] op_sel_hi:[1,0,1]
  v_pk_mul_f32 v[80:81], v[80:81], v[140:141]
  v_pk_mul_f32 v[82:83], v[82:83], v[142:143]
  v_pk_mul_f32 v[84:85], v[84:85], v[144:145]
  v_pk_mul_f32 v[86:87], v[86:87], v[146:147]
  v_pk_mul_f32 v[88:89], v[88:89], v[148:149]
  v_pk_mul_f32 v[90:91], v[90:91], v[150:151]
  v_pk_mul_f32 v[92:93], v[92:93], v[152:153]
  v_pk_mul_f32 v[94:95], v[94:95], v[154:155]
  v_cvt_pk_bf16_f32 v80, v80, v81
  v_cvt_pk_bf16_f32 v81, v82, v83
  v_cvt_pk_bf16_f32 v82, v84, v85
  v_cvt_pk_bf16_f32 v83, v86, v87
  v_cvt_pk_bf16_f32 v84, v88, v89
  v_cvt_pk_bf16_f32 v85, v90, v91
  v_cvt_pk_bf16_f32 v86, v92, v93
  v_cvt_pk_bf16_f32 v87, v94, v95
  s_cmp_eq_u32 s30, 0
  s_cbranch_scc1 L_wt_107
  buffer_store_dwordx4 v[80:83], v28, s[8:11], s58 offen offset:0
  buffer_store_dwordx4 v[84:87], v28, s[8:11], s58 offen offset:640
L_wj_108:
  v_pk_fma_f32 v[96:97], v[188:189], v[216:217], v[96:97] op_sel_hi:[1,0,1]
  v_pk_fma_f32 v[98:99], v[190:191], v[216:217], v[98:99] op_sel_hi:[1,0,1]
  v_pk_fma_f32 v[100:101], v[192:193], v[216:217], v[100:101] op_sel_hi:[1,0,1]
  v_pk_fma_f32 v[102:103], v[194:195], v[216:217], v[102:103] op_sel_hi:[1,0,1]
  v_pk_fma_f32 v[104:105], v[196:197], v[216:217], v[104:105] op_sel_hi:[1,0,1]
  v_pk_fma_f32 v[106:107], v[198:199], v[216:217], v[106:107] op_sel_hi:[1,0,1]
  v_pk_fma_f32 v[108:109], v[200:201], v[216:217], v[108:109] op_sel_hi:[1,0,1]
  v_pk_fma_f32 v[110:111], v[202:203], v[216:217], v[110:111] op_sel_hi:[1,0,1]
  v_pk_mul_f32 v[96:97], v[96:97], v[156:157]
  v_pk_mul_f32 v[98:99], v[98:99], v[158:159]
  v_pk_mul_f32 v[100:101], v[100:101], v[160:161]
  v_pk_mul_f32 v[102:103], v[102:103], v[162:163]
  v_pk_mul_f32 v[104:105], v[104:105], v[164:165]
  v_pk_mul_f32 v[106:107], v[106:107], v[166:167]
  v_pk_mul_f32 v[108:109], v[108:109], v[168:169]
  v_pk_mul_f32 v[110:111], v[110:111], v[170:171]
  v_cvt_pk_bf16_f32 v96, v96, v97
  v_cvt_pk_bf16_f32 v97, v98, v99
  v_cvt_pk_bf16_f32 v98, v100, v101
  v_cvt_pk_bf16_f32 v99, v102, v103
  v_cvt_pk_bf16_f32 v100, v104, v105
  v_cvt_pk_bf16_f32 v101, v106, v107
  v_cvt_pk_bf16_f32 v102, v108, v109
  v_cvt_pk_bf16_f32 v103, v110, v111
  s_cmp_eq_u32 s30, 0
  s_cbranch_scc1 L_wt_109
  buffer_store_dwordx4 v[96:99], v24, s[8:11], s59 offen offset:0
  buffer_store_dwordx4 v[100:103], v24, s[8:11], s59 offen offset:640
L_wj_110:
  v_pk_fma_f32 v[112:113], v[188:189], v[218:219], v[112:113] op_sel_hi:[1,0,1]
  v_pk_fma_f32 v[114:115], v[190:191], v[218:219], v[114:115] op_sel_hi:[1,0,1]
  v_pk_fma_f32 v[116:117], v[192:193], v[218:219], v[116:117] op_sel_hi:[1,0,1]
  v_pk_fma_f32 v[118:119], v[194:195], v[218:219], v[118:119] op_sel_hi:[1,0,1]
  v_pk_fma_f32 v[120:121], v[196:197], v[218:219], v[120:121] op_sel_hi:[1,0,1]
  v_pk_fma_f32 v[122:123], v[198:199], v[218:219], v[122:123] op_sel_hi:[1,0,1]
  v_pk_fma_f32 v[124:125], v[200:201], v[218:219], v[124:125] op_sel_hi:[1,0,1]
  v_pk_fma_f32 v[126:127], v[202:203], v[218:219], v[126:127] op_sel_hi:[1,0,1]
  v_pk_mul_f32 v[112:113], v[112:113], v[156:157]
  v_pk_mul_f32 v[114:115], v[114:115], v[158:159]
  v_pk_mul_f32 v[116:117], v[116:117], v[160:161]
  v_pk_mul_f32 v[118:119], v[118:119], v[162:163]
  v_pk_mul_f32 v[120:121], v[120:121], v[164:165]
  v_pk_mul_f32 v[122:123], v[122:123], v[166:167]
  v_pk_mul_f32 v[124:125], v[124:125], v[168:169]
  v_pk_mul_f32 v[126:127], v[126:127], v[170:171]
  v_cvt_pk_bf16_f32 v112, v112, v113
  v_cvt_pk_bf16_f32 v113, v114, v115
  v_cvt_pk_bf16_f32 v114, v116, v117
  v_cvt_pk_bf16_f32 v115, v118, v119
  v_cvt_pk_bf16_f32 v116, v120, v121
  v_cvt_pk_bf16_f32 v117, v122, v123
  v_cvt_pk_bf16_f32 v118, v124, v125
  v_cvt_pk_bf16_f32 v119, v126, v127
  s_cmp_eq_u32 s30, 0
  s_cbranch_scc1 L_wt_111
  buffer_store_dwordx4 v[112:115], v28, s[8:11], s59 offen offset:0
  buffer_store_dwordx4 v[116:119], v28, s[8:11], s59 offen offset:640
L_wj_112:
L_qjoin_13:
  s_nop 1
  s_load_dwordx2 s[6:7], s[0:1], 56
L_att_begin:
  v_lshlrev_b32 v2, 4, v1
  v_and_b32 v9, 31, v1
  v_lshrrev_b32 v10, 5, v1
  v_lshlrev_b32 v3, 3, v9
  v_lshl_add_u32 v3, v10, 9, v3
  s_lshl_b32 s50, s26, 2
  s_and_b32 s33, s27, 3
  s_add_u32 s50, s50, s33
  s_lshr_b32 s51, s27, 2
  s_lshl_b32 s33, s51, 2
  s_add_u32 s33, s33, s28
  s_mul_i32 s33, s33, 5120
  s_mul_i32 s35, s26, 1114112
  s_add_u32 s33, s33, s35
  s_bfe_u32 s34, s27, 0x10001
  s_mul_i32 s34, s34, 163840
  s_add_u32 s52, s33, s34
  s_and_b32 s34, s27, 1
  s_mul_i32 s34, s34, 1280
  s_add_u32 s42, s52, s34
  s_and_b32 s34, s27, 3
  s_mul_i32 s34, s34, 163840
  s_add_u32 s35, s35, s34
  s_lshl_b32 s29, s28, 12
  s_mov_b32 m0, s29
  s_add_u32 s35, s35, 327680
  v_mov_b32 v18, 0
  v_mov_b32 v19, 0
  v_mov_b32 v24, 0
  v_mov_b32 v25, 0
  s_waitcnt lgkmcnt(0)
  s_mov_b32 s16, s6
  s_mov_b32 s17, s7
  s_mov_b32 s18, 2621440
  s_mov_b32 s19, 0x20000
  s_add_u32 s59, s35, s29
  s_mov_b32 s12, s4
  s_mov_b32 s13, s5
  s_mov_b32 s14, 2621440
  s_mov_b32 s15, 0x20000
  v_mul_u32_u24 v6, 320, v10
  v_lshl_add_u32 v6, v9, 4, v6
  v_add_u32 v6, 1280, v6
  v_add_u32 v4, 61440, v3
  v_add_u32 v7, 61440, v6
  v_add_u32 v5, 122880, v3
  v_add_u32 v8, 122880, v6
  s_mov_b32 s38, 0xfffff
  s_mov_b32 s39, 0xfffff
  v_mov_b32 v38, 0x3f803f80
  v_mov_b32 v46, 0x3f803f80
  v_mov_b32 v39, 0x3f803f80
  v_mov_b32 v47, 0x3f803f80
  v_mov_b32 v40, 0x3f803f80
  v_mov_b32 v48, 0x3f803f80
  v_mov_b32 v41, 0x3f803f80
  v_mov_b32 v49, 0x3f803f80
  v_mov_b32 v42, 0x3f803f80
  v_mov_b32 v50, 0x3f803f80
  v_mov_b32 v43, 0x3f803f80
  v_mov_b32 v51, 0x3f803f80
  v_mov_b32 v44, 0x3f803f80
  v_mov_b32 v52, 0x3f803f80
  v_mov_b32 v45, 0x3f803f80
  v_mov_b32 v53, 0x3f803f80
  s_mov_b32 s37, 0
  s_lshl_b32 s33, s26, 9
  s_add_u32 s33, s33, 32519168
  v_lshlrev_b32 v9, 3, v1
  s_lshl_b32 s40, s2, 2
  s_add_u32 s40, s40, 32523264
  s_mov_b32 s41, 32523264
  v_mov_b32 v192, s100
  v_mov_b32 v193, 0
  s_lshl_b32 s34, s101, 2
  s_add_u32 s34, s34, s33
  v_mov_b32 v132, s100
  v_mov_b32 v133, 0
  s_mov_b64 exec, 1
  s_waitcnt vmcnt(0)
  s_cmp_eq_u32 s30, 0
  s_cbranch_scc1 L_wt_115
  buffer_store_dword v132, v133, s[8:11], s34 offen
L_wj_116:
  s_mov_b64 exec, -1
  s_barrier
  s_mov_b32 s31, 200000
L_poll_117:
  buffer_load_dwordx2 v[64:65], v9, s[8:11], s33 offen sc1
  s_sub_u32 s31, s31, 1
  s_waitcnt vmcnt(0)
  v_xor_b32 v64, s100, v64
  v_xor_b32 v65, s100, v65
  v_or_b32 v64, v64, v65
  v_cmp_ne_u32 vcc, 0, v64
  s_cbranch_scc1 L_pout_118
  s_cbranch_vccnz L_poll_117
L_pout_118:
  buffer_load_dwordx2 v[14:15], v3, s[8:11], s42 offen offset:0 sc1
  buffer_load_dwordx2 v[16:17], v3, s[8:11], s42 offen offset:256 sc1
  buffer_load_dwordx2 v[20:21], v3, s[8:11], s42 offen offset:2560 sc1
  buffer_load_dwordx2 v[22:23], v3, s[8:11], s42 offen offset:2816 sc1
  s_mov_b32 exec_hi, 0
  buffer_load_dwordx2 v[18:19], v3, s[8:11], s42 offen offset:1024 sc1
  buffer_load_dwordx2 v[24:25], v3, s[8:11], s42 offen offset:3584 sc1
  s_mov_b64 exec, -1
  buffer_load_dwordx4 v2, s[8:11], s59 offen offset:0 sc1 lds
  buffer_load_dwordx4 v2, s[8:11], s59 offen offset:1024 sc1 lds
  buffer_load_dwordx4 v2, s[8:11], s59 offen offset:2048 sc1 lds
  buffer_load_dwordx4 v2, s[8:11], s59 offen offset:3072 sc1 lds
  s_add_u32 m0, m0, 16384
  s_add_u32 s59, s59, 16384
  buffer_load_dwordx4 v2, s[8:11], s59 offen offset:0 sc1 lds
  buffer_load_dwordx4 v2, s[8:11], s59 offen offset:1024 sc1 lds
  buffer_load_dwordx4 v2, s[8:11], s59 offen offset:2048 sc1 lds
  buffer_load_dwordx4 v2, s[8:11], s59 offen offset:3072 sc1 lds
  v_mov_b32 v128, 0
  v_mov_b32 v129, 0
  v_mov_b32 v130, 0
  v_mov_b32 v131, 0
  v_mov_b32 v132, 0
  v_mov_b32 v133, 0
  v_mov_b32 v134, 0
  v_mov_b32 v135, 0
  v_mov_b32 v136, 0
  v_mov_b32 v137, 0
  v_mov_b32 v138, 0
  v_mov_b32 v139, 0
  v_mov_b32 v140, 0
  v_mov_b32 v141, 0
  v_mov_b32 v142, 0
  v_mov_b32 v143, 0
  v_mov_b32 v144, 0
  v_mov_b32 v145, 0
  v_mov_b32 v146, 0
  v_mov_b32 v147, 0
  v_mov_b32 v148, 0
  v_mov_b32 v149, 0
  v_mov_b32 v150, 0
  v_mov_b32 v151, 0
  v_mov_b32 v152, 0
  v_mov_b32 v153, 0
  v_mov_b32 v154, 0
  v_mov_b32 v155, 0
  v_mov_b32 v156, 0
  v_mov_b32 v157, 0
  v_mov_b32 v158, 0
  v_mov_b32 v159, 0
  v_mov_b32 v58, 0
  v_mov_b32 v59, 0
  v_mov_b32 v60, 0
  v_mov_b32 v61, 0
  s_lshr_b32 s33, s27, 2
  s_mul_i32 s43, s33, 102400
  s_mul_i32 s34, s28, 25600
  s_add_u32 s43, s43, s34
  s_add_u32 s43, s43, 23068672
  s_lshl_b32 s34, s33, 1
  s_and_b32 s35, s27, 1
  s_add_u32 s34, s34, s35
  s_lshl_b32 s34, s34, 2
  s_add_u32 s34, s34, s28
  s_mul_i32 s58, s34, 61440
  s_add_u32 s58, s58, 24117248
  s_lshl_b32 s34, s26, 2
  s_and_b32 s35, s27, 3
  s_add_u32 s34, s34, s35
  s_lshl_b32 s34, s34, 2
  s_add_u32 s34, s34, s28
  s_mul_i32 s34, s34, 20480
  s_mul_i32 s33, s33, 160
  s_add_u32 s33, s33, s34
  v_and_b32 v9, 15, v1
  v_lshrrev_b32 v10, 4, v1
  v_mul_u32_u24 v13, 1280, v9
  v_mad_u32_u24 v13, v10, 40, v13
  v_add_u32 v13, s33, v13
  s_lshl_b32 s33, s26, 5
  s_add_u32 s33, s33, s27
  s_lshl_b32 s33, s33, 2
  s_add_u32 s33, s33, s28
  s_mul_i32 s60, s33, 2560
  s_mul_i32 s61, s101, 6144
  s_mul_i32 s34, s26, 1114112
  s_add_u32 s61, s61, s34
  s_add_u32 s61, s61, 327680
  v_min_u32 v62, 19, v1
  v_lshlrev_b32 v62, 7, v62
  v_lshlrev_b32 v63, 7, v9
  s_lshl_b32 s63, s33, 7
  s_mov_b32 s62, 31457280
  s_waitcnt vmcnt(4)
  s_barrier
  ds_read_b64 v[26:27], v3 offset:0
  ds_read_b64 v[28:29], v3 offset:256
  ds_read_b64 v[30:31], v3 offset:1024
  v_mov_b32 v9, 0xff800000
  v_mov_b32 v10, 0xff800000
  s_waitcnt lgkmcnt(0)
  v_mfma_f32_32x32x16_bf16 v[96:111], v[26:29], v[14:17], 0
  v_mfma_f32_32x32x16_bf16 v[112:127], v[26:29], v[20:23], 0
  v_mfma_f32_32x32x8_bf16 v[96:111], v[30:31], v[18:19], v[96:111]
  v_mfma_f32_32x32x8_bf16 v[112:127], v[30:31], v[24:25], v[112:127]
  s_nop 7
  s_nop 4
  v_max3_f32 v9, v96, v97, v9
  v_max3_f32 v9, v98, v99, v9
  v_max3_f32 v9, v100, v101, v9
  v_max3_f32 v9, v102, v103, v9
  v_max3_f32 v9, v104, v105, v9
  v_max3_f32 v9, v106, v107, v9
  v_max3_f32 v9, v108, v109, v9
  v_max3_f32 v9, v110, v111, v9
  v_max3_f32 v10, v112, v113, v10
  v_max3_f32 v10, v114, v115, v10
  v_max3_f32 v10, v116, v117, v10
  v_max3_f32 v10, v118, v119, v10
  v_max3_f32 v10, v120, v121, v10
  v_max3_f32 v10, v122, v123, v10
  v_max3_f32 v10, v124, v125, v10
  v_max3_f32 v10, v126, v127, v10
  v_mov_b32 v11, v9
  v_mov_b32 v12, v10
  s_nop 1
  v_permlane32_swap_b32 v11, v9
  v_permlane32_swap_b32 v12, v10
  s_nop 1
  v_max_f32 v9, v9, v11
  v_max_f32 v10, v10, v12
  v_sub_f32 v64, 0, v9
  v_sub_f32 v65, 0, v9
  v_sub_f32 v66, 0, v9
  v_sub_f32 v67, 0, v9
  v_sub_f32 v68, 0, v9
  v_sub_f32 v69, 0, v9
  v_sub_f32 v70, 0, v9
  v_sub_f32 v71, 0, v9
  v_sub_f32 v72, 0, v9
  v_sub_f32 v73, 0, v9
  v_sub_f32 v74, 0, v9
  v_sub_f32 v75, 0, v9
  v_sub_f32 v76, 0, v9
  v_sub_f32 v77, 0, v9
  v_sub_f32 v78, 0, v9
  v_sub_f32 v79, 0, v9
  ds_read_b64 v[32:33], v3 offset:2560
  ds_read_b64 v[34:35], v3 offset:2816
  ds_read_b64 v[36:37], v3 offset:3584
  v_mfma_f32_32x32x16_bf16 v[96:111], v[26:29], v[14:17], v[64:79]
  v_mfma_f32_32x32x8_bf16 v[96:111], v[30:31], v[18:19], v[96:111]
  s_mov_b64 exec, s[38:39]
  ds_read_b128 v[38:41], v6 offset:0
  ds_read_b128 v[42:45], v6 offset:640
  s_mov_b64 exec, -1
  v_sub_f32 v80, 0, v10
  v_sub_f32 v81, 0, v10
  v_sub_f32 v82, 0, v10
  v_sub_f32 v83, 0, v10
  v_sub_f32 v84, 0, v10
  v_sub_f32 v85, 0, v10
  v_sub_f32 v86, 0, v10
  v_sub_f32 v87, 0, v10
  v_sub_f32 v88, 0, v10
  v_sub_f32 v89, 0, v10
  v_sub_f32 v90, 0, v10
  v_sub_f32 v91, 0, v10
  v_sub_f32 v92, 0, v10
  v_sub_f32 v93, 0, v10
  v_sub_f32 v94, 0, v10
  v_sub_f32 v95, 0, v10
  s_waitcnt lgkmcnt(0)
  v_exp_f32 v96, v96
  v_exp_f32 v97, v97
  v_and_b32 v9, 3, v1
  v_bfe_u32 v10, v1, 2, 1
  v_lshlrev_b32 v9, 7, v9
  v_lshl_add_u32 v9, v10, 12, v9
  s_lshl_b32 s34, s26, 9
  s_add_u32 s34, s34, 1053696
  v_add_u32 v12, s34, v9
  v_writelane_b32 v12, s63, 63
  v_exp_f32 v98, v98
  v_mfma_f32_32x32x16_bf16 v[144:159], v[50:53], v[58:61], v[144:159]
  buffer_load_dwordx2 v[208:209], v240, s[20:23], 0 offen
  v_cvt_pk_bf16_f32 v54, v96, v97
  v_exp_f32 v99, v99
  v_exp_f32 v100, v100
  v_cvt_pk_bf16_f32 v55, v98, v99
  v_exp_f32 v101, v101
  v_mfma_f32_32x32x16_bf16 v[112:127], v[26:29], v[20:23], v[80:95]
  s_mov_b64 exec, s[38:39]
  ds_read_b128 v[46:49], v6 offset:2560
  ds_read_b128 v[50:53], v6 offset:3200
  s_mov_b64 exec, -1
  v_exp_f32 v102, v102
  v_cvt_pk_bf16_f32 v56, v100, v101
  v_exp_f32 v103, v103
  v_exp_f32 v104, v104
  v_mfma_f32_32x32x8_bf16 v[112:127], v[30:31], v[24:25], v[112:127]
  v_cvt_pk_bf16_f32 v57, v102, v103
  v_exp_f32 v105, v105
  v_exp_f32 v106, v106
  v_cvt_pk_bf16_f32 v58, v104, v105
  v_exp_f32 v107, v107
  v_exp_f32 v108, v108
  v_cvt_pk_bf16_f32 v59, v106, v107
  v_exp_f32 v109, v109
  v_mfma_f32_32x32x16_bf16 v[128:143], v[38:41], v[54:57], v[128:143]
  buffer_load_dwordx2 v[210:211], v240, s[20:23], s94 offen
  v_exp_f32 v110, v110
  v_cvt_pk_bf16_f32 v60, v108, v109
  v_exp_f32 v111, v111
  v_exp_f32 v112, v112
  v_cvt_pk_bf16_f32 v61, v110, v111
  v_exp_f32 v113, v113
  v_exp_f32 v114, v114
  v_mfma_f32_32x32x16_bf16 v[128:143], v[42:45], v[58:61], v[128:143]
  s_waitcnt lgkmcnt(0)
  buffer_load_dwordx2 v[212:213], v240, s[20:23], s95 offen
  v_cvt_pk_bf16_f32 v54, v112, v113
  v_exp_f32 v115, v115
  v_exp_f32 v116, v116
  v_cvt_pk_bf16_f32 v55, v114, v115
  v_exp_f32 v117, v117
  v_mfma_f32_32x32x16_bf16 v[96:111], v[32:35], v[14:17], v[64:79]
  ds_read_b64 v[26:27], v3 offset:5120
  ds_read_b64 v[28:29], v3 offset:5376
  ds_read_b64 v[30:31], v3 offset:6144
  v_exp_f32 v118, v118
  v_cvt_pk_bf16_f32 v56, v116, v117
  v_exp_f32 v119, v119
  v_exp_f32 v120, v120
  v_mfma_f32_32x32x8_bf16 v[96:111], v[36:37], v[18:19], v[96:111]
  v_cvt_pk_bf16_f32 v57, v118, v119
  v_exp_f32 v121, v121
  v_exp_f32 v122, v122
  v_cvt_pk_bf16_f32 v58, v120, v121
  v_exp_f32 v123, v123
  v_exp_f32 v124, v124
  v_cvt_pk_bf16_f32 v59, v122, v123
  v_exp_f32 v125, v125
  v_mfma_f32_32x32x16_bf16 v[144:159], v[38:41], v[54:57], v[144:159]
  buffer_load_dwordx2 v[214:215], v240, s[20:23], s96 offen
  v_exp_f32 v126, v126
  v_cvt_pk_bf16_f32 v60, v124, v125
  v_exp_f32 v127, v127
  v_exp_f32 v96, v96
  v_cvt_pk_bf16_f32 v61, v126, v127
  v_exp_f32 v97, v97
  v_exp_f32 v98, v98
  v_mfma_f32_32x32x16_bf16 v[144:159], v[42:45], v[58:61], v[144:159]
  buffer_load_dwordx2 v[216:217], v241, s[20:23], 0 offen
  v_cvt_pk_bf16_f32 v54, v96, v97
  v_exp_f32 v99, v99
  v_exp_f32 v100, v100
  v_cvt_pk_bf16_f32 v55, v98, v99
  v_exp_f32 v101, v101
  v_mfma_f32_32x32x16_bf16 v[112:127], v[32:35], v[20:23], v[80:95]
  s_mov_b64 exec, s[38:39]
  ds_read_b128 v[38:41], v6 offset:5120
  ds_read_b128 v[42:45], v6 offset:5760
  s_mov_b64 exec, -1
  v_exp_f32 v102, v102
  v_cvt_pk_bf16_f32 v56, v100, v101
  v_exp_f32 v103, v103
  v_exp_f32 v104, v104
  v_mfma_f32_32x32x8_bf16 v[112:127], v[36:37], v[24:25], v[112:127]
  v_cvt_pk_bf16_f32 v57, v102, v103
  v_exp_f32 v105, v105
  v_exp_f32 v106, v106
  v_cvt_pk_bf16_f32 v58, v104, v105
  v_exp_f32 v107, v107
  v_exp_f32 v108, v108
  v_cvt_pk_bf16_f32 v59, v106, v107
  v_exp_f32 v109, v109
  v_mfma_f32_32x32x16_bf16 v[128:143], v[46:49], v[54:57], v[128:143]
  buffer_load_dwordx2 v[218:219], v241, s[20:23], s94 offen
  v_exp_f32 v110, v110
  v_cvt_pk_bf16_f32 v60, v108, v109
  v_exp_f32 v111, v111
  v_exp_f32 v112, v112
  v_cvt_pk_bf16_f32 v61, v110, v111
  v_exp_f32 v113, v113
  v_exp_f32 v114, v114
  v_mfma_f32_32x32x16_bf16 v[128:143], v[50:53], v[58:61], v[128:143]
  s_waitcnt lgkmcnt(0)
  buffer_load_dwordx2 v[220:221], v241, s[20:23], s95 offen
  v_cvt_pk_bf16_f32 v54, v112, v113
  v_exp_f32 v115, v115
  v_exp_f32 v116, v116
  v_cvt_pk_bf16_f32 v55, v114, v115
  v_exp_f32 v117, v117
  v_mfma_f32_32x32x16_bf16 v[96:111], v[26:29], v[14:17], v[64:79]
  ds_read_b64 v[32:33], v3 offset:7680
  ds_read_b64 v[34:35], v3 offset:7936
  ds_read_b64 v[36:37], v3 offset:8704
  v_exp_f32 v118, v118
  v_cvt_pk_bf16_f32 v56, v116, v117
  v_exp_f32 v119, v119
  v_exp_f32 v120, v120
  v_mfma_f32_32x32x8_bf16 v[96:111], v[30:31], v[18:19], v[96:111]
  v_cvt_pk_bf16_f32 v57, v118, v119
  v_exp_f32 v121, v121
  v_exp_f32 v122, v122
  v_cvt_pk_bf16_f32 v58, v120, v121
  v_exp_f32 v123, v123
  v_exp_f32 v124, v124
  v_cvt_pk_bf16_f32 v59, v122, v123
  v_exp_f32 v125, v125
  v_mfma_f32_32x32x16_bf16 v[144:159], v[46:49], v[54:57], v[144:159]
  buffer_load_dwordx2 v[222:223], v241, s[20:23], s96 offen
  v_exp_f32 v126, v126
  v_cvt_pk_bf16_f32 v60, v124, v125
  v_exp_f32 v127, v127
  v_exp_f32 v96, v96
  v_cvt_pk_bf16_f32 v61, v126, v127
  v_exp_f32 v97, v97
  v_exp_f32 v98, v98
  v_mfma_f32_32x32x16_bf16 v[144:159], v[50:53], v[58:61], v[144:159]
  buffer_load_dwordx2 v[224:225], v242, s[44:47], 0 offen
  v_cvt_pk_bf16_f32 v54, v96, v97
  v_exp_f32 v99, v99
  v_exp_f32 v100, v100
  v_cvt_pk_bf16_f32 v55, v98, v99
  v_exp_f32 v101, v101
  v_mfma_f32_32x32x16_bf16 v[112:127], v[26:29], v[20:23], v[80:95]
  s_mov_b64 exec, s[38:39]
  ds_read_b128 v[46:49], v6 offset:7680
  ds_read_b128 v[50:53], v6 offset:8320
  s_mov_b64 exec, -1
  v_exp_f32 v102, v102
  v_cvt_pk_bf16_f32 v56, v100, v101
  v_exp_f32 v103, v103
  v_exp_f32 v104, v104
  v_mfma_f32_32x32x8_bf16 v[112:127], v[30:31], v[24:25], v[112:127]
  v_cvt_pk_bf16_f32 v57, v102, v103
  v_exp_f32 v105, v105
  v_exp_f32 v106, v106
  v_cvt_pk_bf16_f32 v58, v104, v105
  v_exp_f32 v107, v107
  v_exp_f32 v108, v108
  v_cvt_pk_bf16_f32 v59, v106, v107
  v_exp_f32 v109, v109
  v_mfma_f32_32x32x16_bf16 v[128:143], v[38:41], v[54:57], v[128:143]
  buffer_load_dwordx2 v[226:227], v242, s[44:47], s97 offen
  v_exp_f32 v110, v110
  v_cvt_pk_bf16_f32 v60, v108, v109
  v_exp_f32 v111, v111
  v_exp_f32 v112, v112
  v_cvt_pk_bf16_f32 v61, v110, v111
  v_exp_f32 v113, v113
  v_exp_f32 v114, v114
  v_mfma_f32_32x32x16_bf16 v[128:143], v[42:45], v[58:61], v[128:143]
  s_waitcnt lgkmcnt(0)
  buffer_load_dwordx2 v[228:229], v242, s[44:47], s98 offen
  v_cvt_pk_bf16_f32 v54, v112, v113
  v_exp_f32 v115, v115
  v_exp_f32 v116, v116
  v_cvt_pk_bf16_f32 v55, v114, v115
  v_exp_f32 v117, v117
  v_mfma_f32_32x32x16_bf16 v[96:111], v[32:35], v[14:17], v[64:79]
  ds_read_b64 v[26:27], v3 offset:10240
  ds_read_b64 v[28:29], v3 offset:10496
  ds_read_b64 v[30:31], v3 offset:11264
  v_exp_f32 v118, v118
  v_cvt_pk_bf16_f32 v56, v116, v117
  v_exp_f32 v119, v119
  v_exp_f32 v120, v120
  v_mfma_f32_32x32x8_bf16 v[96:111], v[36:37], v[18:19], v[96:111]
  v_cvt_pk_bf16_f32 v57, v118, v119
  v_exp_f32 v121, v121
  v_exp_f32 v122, v122
  v_cvt_pk_bf16_f32 v58, v120, v121
  v_exp_f32 v123, v123
  v_exp_f32 v124, v124
  v_cvt_pk_bf16_f32 v59, v122, v123
  v_exp_f32 v125, v125
  v_mfma_f32_32x32x16_bf16 v[144:159], v[38:41], v[54:57], v[144:159]
  buffer_load_dwordx2 v[230:231], v242, s[44:47], s99 offen
  v_exp_f32 v126, v126
  v_cvt_pk_bf16_f32 v60, v124, v125
  v_exp_f32 v127, v127
  v_exp_f32 v96, v96
  v_cvt_pk_bf16_f32 v61, v126, v127
  v_exp_f32 v97, v97
  v_exp_f32 v98, v98
  v_mfma_f32_32x32x16_bf16 v[144:159], v[42:45], v[58:61], v[144:159]
  s_waitcnt vmcnt(12)
  s_barrier
  v_cvt_pk_bf16_f32 v54, v96, v97
  v_exp_f32 v99, v99
  v_exp_f32 v100, v100
  v_cvt_pk_bf16_f32 v55, v98, v99
  v_exp_f32 v101, v101
  v_mfma_f32_32x32x16_bf16 v[112:127], v[32:35], v[20:23], v[80:95]
  s_mov_b64 exec, s[38:39]
  ds_read_b128 v[38:41], v6 offset:10240
  ds_read_b128 v[42:45], v6 offset:10880
  s_mov_b64 exec, -1
  v_exp_f32 v102, v102
  v_cvt_pk_bf16_f32 v56, v100, v101
  v_exp_f32 v103, v103
  v_exp_f32 v104, v104
  v_mfma_f32_32x32x8_bf16 v[112:127], v[36:37], v[24:25], v[112:127]
  v_cvt_pk_bf16_f32 v57, v102, v103
  v_exp_f32 v105, v105
  v_exp_f32 v106, v106
  v_cvt_pk_bf16_f32 v58, v104, v105
  v_exp_f32 v107, v107
  v_exp_f32 v108, v108
  v_cvt_pk_bf16_f32 v59, v106, v107
  v_exp_f32 v109, v109
  v_mfma_f32_32x32x16_bf16 v[128:143], v[46:49], v[54:57], v[128:143]
  buffer_load_dwordx2 v[232:233], v243, s[44:47], 0 offen
  v_exp_f32 v110, v110
  v_cvt_pk_bf16_f32 v60, v108, v109
  v_exp_f32 v111, v111
  v_exp_f32 v112, v112
  v_cvt_pk_bf16_f32 v61, v110, v111
  v_exp_f32 v113, v113
  v_exp_f32 v114, v114
  v_mfma_f32_32x32x16_bf16 v[128:143], v[50:53], v[58:61], v[128:143]
  s_waitcnt lgkmcnt(0)
  buffer_load_dwordx2 v[234:235], v243, s[44:47], s97 offen
  v_cvt_pk_bf16_f32 v54, v112, v113
  v_exp_f32 v115, v115
  v_exp_f32 v116, v116
  v_cvt_pk_bf16_f32 v55, v114, v115
  v_exp_f32 v117, v117
  v_mfma_f32_32x32x16_bf16 v[96:111], v[26:29], v[14:17], v[64:79]
  ds_read_b64 v[32:33], v3 offset:12800
  ds_read_b64 v[34:35], v3 offset:13056
  ds_read_b64 v[36:37], v3 offset:13824
  v_exp_f32 v118, v118
  v_cvt_pk_bf16_f32 v56, v116, v117
  v_exp_f32 v119, v119
  v_exp_f32 v120, v120
  v_mfma_f32_32x32x8_bf16 v[96:111], v[30:31], v[18:19], v[96:111]
  v_cvt_pk_bf16_f32 v57, v118, v119
  v_exp_f32 v121, v121
  v_exp_f32 v122, v122
  v_cvt_pk_bf16_f32 v58, v120, v121
  v_exp_f32 v123, v123
  v_exp_f32 v124, v124
  v_cvt_pk_bf16_f32 v59, v122, v123
  v_exp_f32 v125, v125
  v_mfma_f32_32x32x16_bf16 v[144:159], v[46:49], v[54:57], v[144:159]
  buffer_load_dwordx2 v[236:237], v243, s[44:47], s98 offen
  v_exp_f32 v126, v126
  v_cvt_pk_bf16_f32 v60, v124, v125
  v_exp_f32 v127, v127
  v_exp_f32 v96, v96
  v_cvt_pk_bf16_f32 v61, v126, v127
  v_exp_f32 v97, v97
  v_exp_f32 v98, v98
  v_mfma_f32_32x32x16_bf16 v[144:159], v[50:53], v[58:61], v[144:159]
  buffer_load_dwordx2 v[238:239], v243, s[44:47], s99 offen
  v_cvt_pk_bf16_f32 v54, v96, v97
  v_exp_f32 v99, v99
  v_exp_f32 v100, v100
  v_cvt_pk_bf16_f32 v55, v98, v99
  v_exp_f32 v101, v101
  v_mfma_f32_32x32x16_bf16 v[112:127], v[26:29], v[20:23], v[80:95]
  s_mov_b64 exec, s[38:39]
  ds_read_b128 v[46:49], v6 offset:12800
  ds_read_b128 v[50:53], v6 offset:13440
  s_mov_b64 exec, -1
  v_exp_f32 v102, v102
  v_cvt_pk_bf16_f32 v56, v100, v101
  v_exp_f32 v103, v103
  v_exp_f32 v104, v104
  v_mfma_f32_32x32x8_bf16 v[112:127], v[30:31], v[24:25], v[112:127]
  v_cvt_pk_bf16_f32 v57, v102, v103
  v_exp_f32 v105, v105
  v_exp_f32 v106, v106
  v_cvt_pk_bf16_f32 v58, v104, v105
  v_exp_f32 v107, v107
  v_exp_f32 v108, v108
  v_cvt_pk_bf16_f32 v59, v106, v107
  v_exp_f32 v109, v109
  v_mfma_f32_32x32x16_bf16 v[128:143], v[38:41], v[54:57], v[128:143]
  s_add_u32 m0, m0, 16384
  s_add_u32 s59, s59, 16384
  buffer_load_dwordx4 v2, s[8:11], s59 offen offset:0 sc1 lds
  v_exp_f32 v110, v110
  v_cvt_pk_bf16_f32 v60, v108, v109
  v_exp_f32 v111, v111
  v_exp_f32 v112, v112
  v_cvt_pk_bf16_f32 v61, v110, v111
  v_exp_f32 v113, v113
  v_exp_f32 v114, v114
  v_mfma_f32_32x32x16_bf16 v[128:143], v[42:45], v[58:61], v[128:143]
  s_waitcnt lgkmcnt(0)
  buffer_load_dwordx4 v2, s[8:11], s59 offen offset:1024 sc1 lds
  v_cvt_pk_bf16_f32 v54, v112, v113
  v_exp_f32 v115, v115
  v_exp_f32 v116, v116
  v_cvt_pk_bf16_f32 v55, v114, v115
  v_exp_f32 v117, v117
  v_mfma_f32_32x32x16_bf16 v[96:111], v[32:35], v[14:17], v[64:79]
  ds_read_b64 v[26:27], v3 offset:15360
  ds_read_b64 v[28:29], v3 offset:15616
  ds_read_b64 v[30:31], v3 offset:16384
  v_exp_f32 v118, v118
  v_cvt_pk_bf16_f32 v56, v116, v117
  v_exp_f32 v119, v119
  v_exp_f32 v120, v120
  v_mfma_f32_32x32x8_bf16 v[96:111], v[36:37], v[18:19], v[96:111]
  v_cvt_pk_bf16_f32 v57, v118, v119
  v_exp_f32 v121, v121
  v_exp_f32 v122, v122
  v_cvt_pk_bf16_f32 v58, v120, v121
  v_exp_f32 v123, v123
  v_exp_f32 v124, v124
  v_cvt_pk_bf16_f32 v59, v122, v123
  v_exp_f32 v125, v125
  v_mfma_f32_32x32x16_bf16 v[144:159], v[38:41], v[54:57], v[144:159]
  buffer_load_dwordx4 v2, s[8:11], s59 offen offset:2048 sc1 lds
  v_exp_f32 v126, v126
  v_cvt_pk_bf16_f32 v60, v124, v125
  v_exp_f32 v127, v127
  v_exp_f32 v96, v96
  v_cvt_pk_bf16_f32 v61, v126, v127
  v_exp_f32 v97, v97
  v_exp_f32 v98, v98
  v_mfma_f32_32x32x16_bf16 v[144:159], v[42:45], v[58:61], v[144:159]
  buffer_load_dwordx4 v2, s[8:11], s59 offen offset:3072 sc1 lds
  v_cvt_pk_bf16_f32 v54, v96, v97
  v_exp_f32 v99, v99
  v_exp_f32 v100, v100
  v_cvt_pk_bf16_f32 v55, v98, v99
  v_exp_f32 v101, v101
  v_mfma_f32_32x32x16_bf16 v[112:127], v[32:35], v[20:23], v[80:95]
  s_mov_b64 exec, s[38:39]
  ds_read_b128 v[38:41], v6 offset:15360
  ds_read_b128 v[42:45], v6 offset:16000
  s_mov_b64 exec, -1
  v_exp_f32 v102, v102
  v_cvt_pk_bf16_f32 v56, v100, v101
  v_exp_f32 v103, v103
  v_exp_f32 v104, v104
  v_mfma_f32_32x32x8_bf16 v[112:127], v[36:37], v[24:25], v[112:127]
  v_cvt_pk_bf16_f32 v57, v102, v103
  v_exp_f32 v105, v105
  v_exp_f32 v106, v106
  v_cvt_pk_bf16_f32 v58, v104, v105
  v_exp_f32 v107, v107
  v_exp_f32 v108, v108
  v_cvt_pk_bf16_f32 v59, v106, v107
  v_exp_f32 v109, v109
  v_mfma_f32_32x32x16_bf16 v[128:143], v[46:49], v[54:57], v[128:143]
  s_add_u32 m0, m0, 16384
  s_add_u32 s59, s59, 16384
  buffer_load_dwordx4 v2, s[8:11], s59 offen offset:0 sc1 lds
  v_exp_f32 v110, v110
  v_cvt_pk_bf16_f32 v60, v108, v109
  v_exp_f32 v111, v111
  v_exp_f32 v112, v112
  v_cvt_pk_bf16_f32 v61, v110, v111
  v_exp_f32 v113, v113
  v_exp_f32 v114, v114
  v_mfma_f32_32x32x16_bf16 v[128:143], v[50:53], v[58:61], v[128:143]
  s_waitcnt lgkmcnt(0)
  buffer_load_dwordx4 v2, s[8:11], s59 offen offset:1024 sc1 lds
  v_cvt_pk_bf16_f32 v54, v112, v113
  v_exp_f32 v115, v115
  v_exp_f32 v116, v116
  v_cvt_pk_bf16_f32 v55, v114, v115
  v_exp_f32 v117, v117
  v_mfma_f32_32x32x16_bf16 v[96:111], v[26:29], v[14:17], v[64:79]
  ds_read_b64 v[32:33], v3 offset:17920
  ds_read_b64 v[34:35], v3 offset:18176
  ds_read_b64 v[36:37], v3 offset:18944
  v_exp_f32 v118, v118
  v_cvt_pk_bf16_f32 v56, v116, v117
  v_exp_f32 v119, v119
  v_exp_f32 v120, v120
  v_mfma_f32_32x32x8_bf16 v[96:111], v[30:31], v[18:19], v[96:111]
  v_cvt_pk_bf16_f32 v57, v118, v119
  v_exp_f32 v121, v121
  v_exp_f32 v122, v122
  v_cvt_pk_bf16_f32 v58, v120, v121
  v_exp_f32 v123, v123
  v_exp_f32 v124, v124
  v_cvt_pk_bf16_f32 v59, v122, v123
  v_exp_f32 v125, v125
  v_mfma_f32_32x32x16_bf16 v[144:159], v[46:49], v[54:57], v[144:159]
  buffer_load_dwordx4 v2, s[8:11], s59 offen offset:2048 sc1 lds
  v_exp_f32 v126, v126
  v_cvt_pk_bf16_f32 v60, v124, v125
  v_exp_f32 v127, v127
  v_exp_f32 v96, v96
  v_cvt_pk_bf16_f32 v61, v126, v127
  v_exp_f32 v97, v97
  v_exp_f32 v98, v98
  v_mfma_f32_32x32x16_bf16 v[144:159], v[50:53], v[58:61], v[144:159]
  v_cvt_pk_bf16_f32 v54, v96, v97
  v_exp_f32 v99, v99
  v_exp_f32 v100, v100
  v_cvt_pk_bf16_f32 v55, v98, v99
  v_exp_f32 v101, v101
  v_mfma_f32_32x32x16_bf16 v[112:127], v[26:29], v[20:23], v[80:95]
  s_mov_b64 exec, s[38:39]
  ds_read_b128 v[46:49], v6 offset:17920
  ds_read_b128 v[50:53], v6 offset:18560
  s_mov_b64 exec, -1
  v_exp_f32 v102, v102
  v_cvt_pk_bf16_f32 v56, v100, v101
  v_exp_f32 v103, v103
  v_exp_f32 v104, v104
  v_mfma_f32_32x32x8_bf16 v[112:127], v[30:31], v[24:25], v[112:127]
  v_cvt_pk_bf16_f32 v57, v102, v103
  v_exp_f32 v105, v105
  v_exp_f32 v106, v106
  v_cvt_pk_bf16_f32 v58, v104, v105
  v_exp_f32 v107, v107
  v_exp_f32 v108, v108
  v_cvt_pk_bf16_f32 v59, v106, v107
  v_exp_f32 v109, v109
  v_mfma_f32_32x32x16_bf16 v[128:143], v[38:41], v[54:57], v[128:143]
  buffer_load_dwordx4 v2, s[8:11], s59 offen offset:3072 sc1 lds
  v_exp_f32 v110, v110
  v_cvt_pk_bf16_f32 v60, v108, v109
  v_exp_f32 v111, v111
  v_exp_f32 v112, v112
  v_cvt_pk_bf16_f32 v61, v110, v111
  v_exp_f32 v113, v113
  v_exp_f32 v114, v114
  v_mfma_f32_32x32x16_bf16 v[128:143], v[42:45], v[58:61], v[128:143]
  s_waitcnt lgkmcnt(0)
  v_cvt_pk_bf16_f32 v54, v112, v113
  v_exp_f32 v115, v115
  v_exp_f32 v116, v116
  v_cvt_pk_bf16_f32 v55, v114, v115
  v_exp_f32 v117, v117
  v_mfma_f32_32x32x16_bf16 v[96:111], v[32:35], v[14:17], v[64:79]
  ds_read_b64 v[26:27], v3 offset:20480
  ds_read_b64 v[28:29], v3 offset:20736
  ds_read_b64 v[30:31], v3 offset:21504
  v_exp_f32 v118, v118
  v_cvt_pk_bf16_f32 v56, v116, v117
  v_exp_f32 v119, v119
  v_exp_f32 v120, v120
  v_mfma_f32_32x32x8_bf16 v[96:111], v[36:37], v[18:19], v[96:111]
  v_cvt_pk_bf16_f32 v57, v118, v119
  v_exp_f32 v121, v121
  v_exp_f32 v122, v122
  v_cvt_pk_bf16_f32 v58, v120, v121
  v_exp_f32 v123, v123
  v_exp_f32 v124, v124
  v_cvt_pk_bf16_f32 v59, v122, v123
  v_exp_f32 v125, v125
  v_mfma_f32_32x32x16_bf16 v[144:159], v[38:41], v[54:57], v[144:159]
  v_exp_f32 v126, v126
  v_cvt_pk_bf16_f32 v60, v124, v125
  v_exp_f32 v127, v127
  v_exp_f32 v96, v96
  v_cvt_pk_bf16_f32 v61, v126, v127
  v_exp_f32 v97, v97
  v_exp_f32 v98, v98
  v_mfma_f32_32x32x16_bf16 v[144:159], v[42:45], v[58:61], v[144:159]
  v_cvt_pk_bf16_f32 v54, v96, v97
  v_exp_f32 v99, v99
  v_exp_f32 v100, v100
  v_cvt_pk_bf16_f32 v55, v98, v99
  v_exp_f32 v101, v101
  v_mfma_f32_32x32x16_bf16 v[112:127], v[32:35], v[20:23], v[80:95]
  s_mov_b64 exec, s[38:39]
  ds_read_b128 v[38:41], v6 offset:20480
  ds_read_b128 v[42:45], v6 offset:21120
  s_mov_b64 exec, -1
  v_exp_f32 v102, v102
  v_cvt_pk_bf16_f32 v56, v100, v101
  v_exp_f32 v103, v103
  v_exp_f32 v104, v104
  v_mfma_f32_32x32x8_bf16 v[112:127], v[36:37], v[24:25], v[112:127]
  v_cvt_pk_bf16_f32 v57, v102, v103
  v_exp_f32 v105, v105
  v_exp_f32 v106, v106
  v_cvt_pk_bf16_f32 v58, v104, v105
  v_exp_f32 v107, v107
  v_exp_f32 v108, v108
  v_cvt_pk_bf16_f32 v59, v106, v107
  v_exp_f32 v109, v109
  v_mfma_f32_32x32x16_bf16 v[128:143], v[46:49], v[54:57], v[128:143]
  v_exp_f32 v110, v110
  v_cvt_pk_bf16_f32 v60, v108, v109
  v_exp_f32 v111, v111
  v_exp_f32 v112, v112
  v_cvt_pk_bf16_f32 v61, v110, v111
  v_exp_f32 v113, v113
  v_exp_f32 v114, v114
  v_mfma_f32_32x32x16_bf16 v[128:143], v[50:53], v[58:61], v[128:143]
  s_waitcnt lgkmcnt(0)
  v_cvt_pk_bf16_f32 v54, v112, v113
  v_exp_f32 v115, v115
  v_exp_f32 v116, v116
  v_cvt_pk_bf16_f32 v55, v114, v115
  v_exp_f32 v117, v117
  v_mfma_f32_32x32x16_bf16 v[96:111], v[26:29], v[14:17], v[64:79]
  ds_read_b64 v[32:33], v3 offset:23040
  ds_read_b64 v[34:35], v3 offset:23296
  ds_read_b64 v[36:37], v3 offset:24064
  v_exp_f32 v118, v118
  v_cvt_pk_bf16_f32 v56, v116, v117
  v_exp_f32 v119, v119
  v_exp_f32 v120, v120
  v_mfma_f32_32x32x8_bf16 v[96:111], v[30:31], v[18:19], v[96:111]
  v_cvt_pk_bf16_f32 v57, v118, v119
  v_exp_f32 v121, v121
  v_exp_f32 v122, v122
  v_cvt_pk_bf16_f32 v58, v120, v121
  v_exp_f32 v123, v123
  v_exp_f32 v124, v124
  v_cvt_pk_bf16_f32 v59, v122, v123
  v_exp_f32 v125, v125
  v_mfma_f32_32x32x16_bf16 v[144:159], v[46:49], v[54:57], v[144:159]
  v_exp_f32 v126, v126
  v_cvt_pk_bf16_f32 v60, v124, v125
  v_exp_f32 v127, v127
  v_exp_f32 v96, v96
  v_cvt_pk_bf16_f32 v61, v126, v127
  v_exp_f32 v97, v97
  v_exp_f32 v98, v98
  v_mfma_f32_32x32x16_bf16 v[144:159], v[50:53], v[58:61], v[144:159]
  v_cvt_pk_bf16_f32 v54, v96, v97
  v_exp_f32 v99, v99
  v_exp_f32 v100, v100
  v_cvt_pk_bf16_f32 v55, v98, v99
  v_exp_f32 v101, v101
  v_mfma_f32_32x32x16_bf16 v[112:127], v[26:29], v[20:23], v[80:95]
  s_mov_b64 exec, s[38:39]
  ds_read_b128 v[46:49], v6 offset:23040
  ds_read_b128 v[50:53], v6 offset:23680
  s_mov_b64 exec, -1
  v_exp_f32 v102, v102
  v_cvt_pk_bf16_f32 v56, v100, v101
  v_exp_f32 v103, v103
  v_exp_f32 v104, v104
  v_mfma_f32_32x32x8_bf16 v[112:127], v[30:31], v[24:25], v[112:127]
  v_cvt_pk_bf16_f32 v57, v102, v103
  v_exp_f32 v105, v105
  v_exp_f32 v106, v106
  v_cvt_pk_bf16_f32 v58, v104, v105
  v_exp_f32 v107, v107
  v_exp_f32 v108, v108
  v_cvt_pk_bf16_f32 v59, v106, v107
  v_exp_f32 v109, v109
  v_mfma_f32_32x32x16_bf16 v[128:143], v[38:41], v[54:57], v[128:143]
  v_exp_f32 v110, v110
  v_cvt_pk_bf16_f32 v60, v108, v109
  v_exp_f32 v111, v111
  v_exp_f32 v112, v112
  v_cvt_pk_bf16_f32 v61, v110, v111
  v_exp_f32 v113, v113
  v_exp_f32 v114, v114
  v_mfma_f32_32x32x16_bf16 v[128:143], v[42:45], v[58:61], v[128:143]
  s_waitcnt lgkmcnt(0)
  v_cvt_pk_bf16_f32 v54, v112, v113
  v_exp_f32 v115, v115
  v_exp_f32 v116, v116
  v_cvt_pk_bf16_f32 v55, v114, v115
  v_exp_f32 v117, v117
  v_mfma_f32_32x32x16_bf16 v[96:111], v[32:35], v[14:17], v[64:79]
  ds_read_b64 v[26:27], v3 offset:25600
  ds_read_b64 v[28:29], v3 offset:25856
  ds_read_b64 v[30:31], v3 offset:26624
  v_exp_f32 v118, v118
  v_cvt_pk_bf16_f32 v56, v116, v117
  v_exp_f32 v119, v119
  v_exp_f32 v120, v120
  v_mfma_f32_32x32x8_bf16 v[96:111], v[36:37], v[18:19], v[96:111]
  v_cvt_pk_bf16_f32 v57, v118, v119
  v_exp_f32 v121, v121
  v_exp_f32 v122, v122
  v_cvt_pk_bf16_f32 v58, v120, v121
  v_exp_f32 v123, v123
  v_exp_f32 v124, v124
  v_cvt_pk_bf16_f32 v59, v122, v123
  v_exp_f32 v125, v125
  v_mfma_f32_32x32x16_bf16 v[144:159], v[38:41], v[54:57], v[144:159]
  v_exp_f32 v126, v126
  v_cvt_pk_bf16_f32 v60, v124, v125
  v_exp_f32 v127, v127
  v_exp_f32 v96, v96
  v_cvt_pk_bf16_f32 v61, v126, v127
  v_exp_f32 v97, v97
  v_exp_f32 v98, v98
  v_mfma_f32_32x32x16_bf16 v[144:159], v[42:45], v[58:61], v[144:159]
  s_waitcnt vmcnt(0)
  s_barrier
  v_cvt_pk_bf16_f32 v54, v96, v97
  v_exp_f32 v99, v99
  v_exp_f32 v100, v100
  v_cvt_pk_bf16_f32 v55, v98, v99
  v_exp_f32 v101, v101
  v_mfma_f32_32x32x16_bf16 v[112:127], v[32:35], v[20:23], v[80:95]
  s_mov_b64 exec, s[38:39]
  ds_read_b128 v[38:41], v6 offset:25600
  ds_read_b128 v[42:45], v6 offset:26240
  s_mov_b64 exec, -1
  v_exp_f32 v102, v102
  v_cvt_pk_bf16_f32 v56, v100, v101
  v_exp_f32 v103, v103
  v_exp_f32 v104, v104
  v_mfma_f32_32x32x8_bf16 v[112:127], v[36:37], v[24:25], v[112:127]
  v_cvt_pk_bf16_f32 v57, v102, v103
  v_exp_f32 v105, v105
  v_exp_f32 v106, v106
  v_cvt_pk_bf16_f32 v58, v104, v105
  v_exp_f32 v107, v107
  v_exp_f32 v108, v108
  v_cvt_pk_bf16_f32 v59, v106, v107
  v_exp_f32 v109, v109
  v_mfma_f32_32x32x16_bf16 v[128:143], v[46:49], v[54:57], v[128:143]
  s_mov_b32 s33, 0x05040100
  s_mov_b32 s34, 0x07060302
  s_cmp_ge_u32 s101, 60
  s_cbranch_scc1 L_rdn_113
  v_perm_b32 v160, v210, v208, s33
  v_perm_b32 v161, v214, v212, s33
  v_perm_b32 v162, v218, v216, s33
  v_perm_b32 v163, v222, v220, s33
  v_perm_b32 v164, v210, v208, s34
  v_perm_b32 v165, v214, v212, s34
  v_perm_b32 v166, v218, v216, s34
  v_perm_b32 v167, v222, v220, s34
  v_perm_b32 v168, v226, v224, s33
  v_perm_b32 v169, v230, v228, s33
  v_perm_b32 v170, v234, v232, s33
  v_perm_b32 v171, v238, v236, s33
  v_perm_b32 v172, v226, v224, s34
  v_perm_b32 v173, v230, v228, s34
  v_perm_b32 v174, v234, v232, s34
  v_perm_b32 v175, v238, v236, s34
  v_perm_b32 v176, v211, v209, s33
  v_perm_b32 v177, v215, v213, s33
  v_perm_b32 v178, v219, v217, s33
  v_perm_b32 v179, v223, v221, s33
  v_perm_b32 v180, v211, v209, s34
  v_perm_b32 v181, v215, v213, s34
  v_perm_b32 v182, v219, v217, s34
  v_perm_b32 v183, v223, v221, s34
  v_perm_b32 v184, v227, v225, s33
  v_perm_b32 v185, v231, v229, s33
  v_perm_b32 v186, v235, v233, s33
  v_perm_b32 v187, v239, v237, s33
  v_perm_b32 v188, v227, v225, s34
  v_perm_b32 v189, v231, v229, s34
  v_perm_b32 v190, v235, v233, s34
  v_perm_b32 v191, v239, v237, s34
  s_branch L_rjn_114
L_rdn_113:
  v_perm_b32 v160, v210, v208, s33
  v_perm_b32 v161, v214, v212, s33
  v_perm_b32 v162, v218, v216, s33
  v_perm_b32 v163, v222, v220, s33
  v_perm_b32 v164, v210, v208, s34
  v_perm_b32 v165, v214, v212, s34
  v_perm_b32 v166, v218, v216, s34
  v_perm_b32 v167, v222, v220, s34
  v_perm_b32 v168, v211, v209, s33
  v_perm_b32 v169, v215, v213, s33
  v_perm_b32 v170, v219, v217, s33
  v_perm_b32 v171, v223, v221, s33
  v_perm_b32 v172, v211, v209, s34
  v_perm_b32 v173, v215, v213, s34
  v_perm_b32 v174, v219, v217, s34
  v_perm_b32 v175, v223, v221, s34
  v_perm_b32 v176, v226, v224, s33
  v_perm_b32 v177, v230, v228, s33
  v_perm_b32 v178, v234, v232, s33
  v_perm_b32 v179, v238, v236, s33
  v_perm_b32 v180, v226, v224, s34
  v_perm_b32 v181, v230, v228, s34
  v_perm_b32 v182, v234, v232, s34
  v_perm_b32 v183, v238, v236, s34
  v_perm_b32 v184, v227, v225, s33
  v_perm_b32 v185, v231, v229, s33
  v_perm_b32 v186, v235, v233, s33
  v_perm_b32 v187, v239, v237, s33
  v_perm_b32 v188, v227, v225, s34
  v_perm_b32 v189, v231, v229, s34
  v_perm_b32 v190, v235, v233, s34
  v_perm_b32 v191, v239, v237, s34
L_rjn_114:
  v_permlane16_swap_b32 v160, v164
  v_permlane16_swap_b32 v168, v172
  v_permlane16_swap_b32 v161, v165
  v_permlane16_swap_b32 v169, v173
  v_permlane16_swap_b32 v162, v166
  v_permlane16_swap_b32 v170, v174
  v_permlane16_swap_b32 v163, v167
  v_permlane16_swap_b32 v171, v175
  v_permlane16_swap_b32 v176, v180
  v_permlane16_swap_b32 v184, v188
  v_permlane16_swap_b32 v177, v181
  v_permlane16_swap_b32 v185, v189
  v_permlane16_swap_b32 v178, v182
  v_permlane16_swap_b32 v186, v190
  v_permlane16_swap_b32 v179, v183
  v_permlane16_swap_b32 v187, v191
  v_permlane32_swap_b32 v160, v168
  v_permlane32_swap_b32 v164, v172
  v_permlane32_swap_b32 v161, v169
  v_permlane32_swap_b32 v165, v173
  v_permlane32_swap_b32 v162, v170
  v_permlane32_swap_b32 v166, v174
  v_permlane32_swap_b32 v163, v171
  v_permlane32_swap_b32 v167, v175
  v_permlane32_swap_b32 v176, v184
  v_permlane32_swap_b32 v180, v188
  v_permlane32_swap_b32 v177, v185
  v_permlane32_swap_b32 v181, v189
  v_permlane32_swap_b32 v178, v186
  v_permlane32_swap_b32 v182, v190
  v_permlane32_swap_b32 v179, v187
  v_permlane32_swap_b32 v183, v191
  v_exp_f32 v110, v110
  v_cvt_pk_bf16_f32 v60, v108, v109
  v_exp_f32 v111, v111
  v_exp_f32 v112, v112
  v_cvt_pk_bf16_f32 v61, v110, v111
  v_exp_f32 v113, v113
  v_exp_f32 v114, v114
  v_mfma_f32_32x32x16_bf16 v[128:143], v[50:53], v[58:61], v[128:143]
  s_waitcnt lgkmcnt(0)
  buffer_store_dwordx4 v[160:163], v204, s[8:11], 0 offen offset:0 sc0 sc1
  v_cvt_pk_bf16_f32 v54, v112, v113
  v_exp_f32 v115, v115
  v_exp_f32 v116, v116
  v_cvt_pk_bf16_f32 v55, v114, v115
  v_exp_f32 v117, v117
  v_mfma_f32_32x32x16_bf16 v[96:111], v[26:29], v[14:17], v[64:79]
  ds_read_b64 v[32:33], v3 offset:28160
  ds_read_b64 v[34:35], v3 offset:28416
  ds_read_b64 v[36:37], v3 offset:29184
  v_exp_f32 v118, v118
  v_cvt_pk_bf16_f32 v56, v116, v117
  v_exp_f32 v119, v119
  v_exp_f32 v120, v120
  v_mfma_f32_32x32x8_bf16 v[96:111], v[30:31], v[18:19], v[96:111]
  v_cvt_pk_bf16_f32 v57, v118, v119
  v_exp_f32 v121, v121
  v_exp_f32 v122, v122
  v_cvt_pk_bf16_f32 v58, v120, v121
  v_exp_f32 v123, v123
  v_exp_f32 v124, v124
  v_cvt_pk_bf16_f32 v59, v122, v123
  v_exp_f32 v125, v125
  v_mfma_f32_32x32x16_bf16 v[144:159], v[46:49], v[54:57], v[144:159]
  s_add_u32 m0, m0, 16384
  s_add_u32 s59, s59, 16384
  buffer_load_dwordx4 v2, s[8:11], s59 offen offset:0 sc1 lds
  v_exp_f32 v126, v126
  v_cvt_pk_bf16_f32 v60, v124, v125
  v_exp_f32 v127, v127
  v_exp_f32 v96, v96
  v_cvt_pk_bf16_f32 v61, v126, v127
  v_exp_f32 v97, v97
  v_exp_f32 v98, v98
  v_mfma_f32_32x32x16_bf16 v[144:159], v[50:53], v[58:61], v[144:159]
  buffer_store_dwordx4 v[164:167], v204, s[8:11], 0 offen offset:256 sc0 sc1
  v_cvt_pk_bf16_f32 v54, v96, v97
  v_exp_f32 v99, v99
  v_exp_f32 v100, v100
  v_cvt_pk_bf16_f32 v55, v98, v99
  v_exp_f32 v101, v101
  v_mfma_f32_32x32x16_bf16 v[112:127], v[26:29], v[20:23], v[80:95]
  s_mov_b64 exec, s[38:39]
  ds_read_b128 v[46:49], v6 offset:28160
  ds_read_b128 v[50:53], v6 offset:28800
  s_mov_b64 exec, -1
  v_exp_f32 v102, v102
  v_cvt_pk_bf16_f32 v56, v100, v101
  v_exp_f32 v103, v103
  v_exp_f32 v104, v104
  v_mfma_f32_32x32x8_bf16 v[112:127], v[30:31], v[24:25], v[112:127]
  v_cvt_pk_bf16_f32 v57, v102, v103
  v_exp_f32 v105, v105
  v_exp_f32 v106, v106
  v_cvt_pk_bf16_f32 v58, v104, v105
  v_exp_f32 v107, v107
  v_exp_f32 v108, v108
  v_cvt_pk_bf16_f32 v59, v106, v107
  v_exp_f32 v109, v109
  v_mfma_f32_32x32x16_bf16 v[128:143], v[38:41], v[54:57], v[128:143]
  buffer_load_dwordx4 v2, s[8:11], s59 offen offset:1024 sc1 lds
  v_exp_f32 v110, v110
  v_cvt_pk_bf16_f32 v60, v108, v109
  v_exp_f32 v111, v111
  v_exp_f32 v112, v112
  v_cvt_pk_bf16_f32 v61, v110, v111
  v_exp_f32 v113, v113
  v_exp_f32 v114, v114
  v_mfma_f32_32x32x16_bf16 v[128:143], v[42:45], v[58:61], v[128:143]
  s_waitcnt lgkmcnt(0)
  buffer_store_dwordx4 v[168:171], v204, s[8:11], 0 offen offset:512 sc0 sc1
  v_cvt_pk_bf16_f32 v54, v112, v113
  v_exp_f32 v115, v115
  v_exp_f32 v116, v116
  v_cvt_pk_bf16_f32 v55, v114, v115
  v_exp_f32 v117, v117
  v_mfma_f32_32x32x16_bf16 v[96:111], v[32:35], v[14:17], v[64:79]
  ds_read_b64 v[26:27], v3 offset:30720
  ds_read_b64 v[28:29], v3 offset:30976
  ds_read_b64 v[30:31], v3 offset:31744
  v_exp_f32 v118, v118
  v_cvt_pk_bf16_f32 v56, v116, v117
  v_exp_f32 v119, v119
  v_exp_f32 v120, v120
  v_mfma_f32_32x32x8_bf16 v[96:111], v[36:37], v[18:19], v[96:111]
  v_cvt_pk_bf16_f32 v57, v118, v119
  v_exp_f32 v121, v121
  v_exp_f32 v122, v122
  v_cvt_pk_bf16_f32 v58, v120, v121
  v_exp_f32 v123, v123
  v_exp_f32 v124, v124
  v_cvt_pk_bf16_f32 v59, v122, v123
  v_exp_f32 v125, v125
  v_mfma_f32_32x32x16_bf16 v[144:159], v[38:41], v[54:57], v[144:159]
  buffer_load_dwordx4 v2, s[8:11], s59 offen offset:2048 sc1 lds
  v_exp_f32 v126, v126
  v_cvt_pk_bf16_f32 v60, v124, v125
  v_exp_f32 v127, v127
  v_exp_f32 v96, v96
  v_cvt_pk_bf16_f32 v61, v126, v127
  v_exp_f32 v97, v97
  v_exp_f32 v98, v98
  v_mfma_f32_32x32x16_bf16 v[144:159], v[42:45], v[58:61], v[144:159]
  buffer_store_dwordx4 v[172:175], v204, s[8:11], 0 offen offset:768 sc0 sc1
  v_cvt_pk_bf16_f32 v54, v96, v97
  v_exp_f32 v99, v99
  v_exp_f32 v100, v100
  v_cvt_pk_bf16_f32 v55, v98, v99
  v_exp_f32 v101, v101
  v_mfma_f32_32x32x16_bf16 v[112:127], v[32:35], v[20:23], v[80:95]
  s_mov_b64 exec, s[38:39]
  ds_read_b128 v[38:41], v6 offset:30720
  ds_read_b128 v[42:45], v6 offset:31360
  s_mov_b64 exec, -1
  v_exp_f32 v102, v102
  v_cvt_pk_bf16_f32 v56, v100, v101
  v_exp_f32 v103, v103
  v_exp_f32 v104, v104
  v_mfma_f32_32x32x8_bf16 v[112:127], v[36:37], v[24:25], v[112:127]
  v_cvt_pk_bf16_f32 v57, v102, v103
  v_exp_f32 v105, v105
  v_exp_f32 v106, v106
  v_cvt_pk_bf16_f32 v58, v104, v105
  v_exp_f32 v107, v107
  v_exp_f32 v108, v108
  v_cvt_pk_bf16_f32 v59, v106, v107
  v_exp_f32 v109, v109
  v_mfma_f32_32x32x16_bf16 v[128:143], v[46:49], v[54:57], v[128:143]
  buffer_load_dwordx4 v2, s[8:11], s59 offen offset:3072 sc1 lds
  v_exp_f32 v110, v110
  v_cvt_pk_bf16_f32 v60, v108, v109
  v_exp_f32 v111, v111
  v_exp_f32 v112, v112
  v_cvt_pk_bf16_f32 v61, v110, v111
  v_exp_f32 v113, v113
  v_exp_f32 v114, v114
  v_mfma_f32_32x32x16_bf16 v[128:143], v[50:53], v[58:61], v[128:143]
  s_waitcnt lgkmcnt(0)
  buffer_store_dwordx4 v[176:179], v205, s[8:11], 0 offen offset:0 sc0 sc1
  v_cvt_pk_bf16_f32 v54, v112, v113
  v_exp_f32 v115, v115
  v_exp_f32 v116, v116
  v_cvt_pk_bf16_f32 v55, v114, v115
  v_exp_f32 v117, v117
  v_mfma_f32_32x32x16_bf16 v[96:111], v[26:29], v[14:17], v[64:79]
  ds_read_b64 v[32:33], v3 offset:33280
  ds_read_b64 v[34:35], v3 offset:33536
  ds_read_b64 v[36:37], v3 offset:34304
  v_exp_f32 v118, v118
  v_cvt_pk_bf16_f32 v56, v116, v117
  v_exp_f32 v119, v119
  v_exp_f32 v120, v120
  v_mfma_f32_32x32x8_bf16 v[96:111], v[30:31], v[18:19], v[96:111]
  v_cvt_pk_bf16_f32 v57, v118, v119
  v_exp_f32 v121, v121
  v_exp_f32 v122, v122
  v_cvt_pk_bf16_f32 v58, v120, v121
  v_exp_f32 v123, v123
  v_exp_f32 v124, v124
  v_cvt_pk_bf16_f32 v59, v122, v123
  v_exp_f32 v125, v125
  v_mfma_f32_32x32x16_bf16 v[144:159], v[46:49], v[54:57], v[144:159]
  s_add_u32 m0, m0, 16384
  s_add_u32 s59, s59, 16384
  buffer_load_dwordx4 v2, s[8:11], s59 offen offset:0 sc1 lds
  v_exp_f32 v126, v126
  v_cvt_pk_bf16_f32 v60, v124, v125
  v_exp_f32 v127, v127
  v_exp_f32 v96, v96
  v_cvt_pk_bf16_f32 v61, v126, v127
  v_exp_f32 v97, v97
  v_exp_f32 v98, v98
  v_mfma_f32_32x32x16_bf16 v[144:159], v[50:53], v[58:61], v[144:159]
  buffer_store_dwordx4 v[180:183], v205, s[8:11], 0 offen offset:256 sc0 sc1
  v_cvt_pk_bf16_f32 v54, v96, v97
  v_exp_f32 v99, v99
  v_exp_f32 v100, v100
  v_cvt_pk_bf16_f32 v55, v98, v99
  v_exp_f32 v101, v101
  v_mfma_f32_32x32x16_bf16 v[112:127], v[26:29], v[20:23], v[80:95]
  s_mov_b64 exec, s[38:39]
  ds_read_b128 v[46:49], v6 offset:33280
  ds_read_b128 v[50:53], v6 offset:33920
  s_mov_b64 exec, -1
  v_exp_f32 v102, v102
  v_cvt_pk_bf16_f32 v56, v100, v101
  v_exp_f32 v103, v103
  v_exp_f32 v104, v104
  v_mfma_f32_32x32x8_bf16 v[112:127], v[30:31], v[24:25], v[112:127]
  v_cvt_pk_bf16_f32 v57, v102, v103
  v_exp_f32 v105, v105
  v_exp_f32 v106, v106
  v_cvt_pk_bf16_f32 v58, v104, v105
  v_exp_f32 v107, v107
  v_exp_f32 v108, v108
  v_cvt_pk_bf16_f32 v59, v106, v107
  v_exp_f32 v109, v109
  v_mfma_f32_32x32x16_bf16 v[128:143], v[38:41], v[54:57], v[128:143]
  buffer_load_dwordx4 v2, s[8:11], s59 offen offset:1024 sc1 lds
  v_exp_f32 v110, v110
  v_cvt_pk_bf16_f32 v60, v108, v109
  v_exp_f32 v111, v111
  v_exp_f32 v112, v112
  v_cvt_pk_bf16_f32 v61, v110, v111
  v_exp_f32 v113, v113
  v_exp_f32 v114, v114
  v_mfma_f32_32x32x16_bf16 v[128:143], v[42:45], v[58:61], v[128:143]
  s_waitcnt lgkmcnt(0)
  buffer_store_dwordx4 v[184:187], v205, s[8:11], 0 offen offset:512 sc0 sc1
  v_cvt_pk_bf16_f32 v54, v112, v113
  v_exp_f32 v115, v115
  v_exp_f32 v116, v116
  v_cvt_pk_bf16_f32 v55, v114, v115
  v_exp_f32 v117, v117
  v_mfma_f32_32x32x16_bf16 v[96:111], v[32:35], v[14:17], v[64:79]
  ds_read_b64 v[26:27], v3 offset:35840
  ds_read_b64 v[28:29], v3 offset:36096
  ds_read_b64 v[30:31], v3 offset:36864
  v_exp_f32 v118, v118
  v_cvt_pk_bf16_f32 v56, v116, v117
  v_exp_f32 v119, v119
  v_exp_f32 v120, v120
  v_mfma_f32_32x32x8_bf16 v[96:111], v[36:37], v[18:19], v[96:111]
  v_cvt_pk_bf16_f32 v57, v118, v119
  v_exp_f32 v121, v121
  v_exp_f32 v122, v122
  v_cvt_pk_bf16_f32 v58, v120, v121
  v_exp_f32 v123, v123
  v_exp_f32 v124, v124
  v_cvt_pk_bf16_f32 v59, v122, v123
  v_exp_f32 v125, v125
  v_mfma_f32_32x32x16_bf16 v[144:159], v[38:41], v[54:57], v[144:159]
  buffer_load_dwordx4 v2, s[8:11], s59 offen offset:2048 sc1 lds
  v_exp_f32 v126, v126
  v_cvt_pk_bf16_f32 v60, v124, v125
  v_exp_f32 v127, v127
  v_exp_f32 v96, v96
  v_cvt_pk_bf16_f32 v61, v126, v127
  v_exp_f32 v97, v97
  v_exp_f32 v98, v98
  v_mfma_f32_32x32x16_bf16 v[144:159], v[42:45], v[58:61], v[144:159]
  buffer_store_dwordx4 v[188:191], v205, s[8:11], 0 offen offset:768 sc0 sc1
  v_cvt_pk_bf16_f32 v54, v96, v97
  v_exp_f32 v99, v99
  v_exp_f32 v100, v100
  v_cvt_pk_bf16_f32 v55, v98, v99
  v_exp_f32 v101, v101
  v_mfma_f32_32x32x16_bf16 v[112:127], v[32:35], v[20:23], v[80:95]
  s_mov_b64 exec, s[38:39]
  ds_read_b128 v[38:41], v6 offset:35840
  ds_read_b128 v[42:45], v6 offset:36480
  s_mov_b64 exec, -1
  v_exp_f32 v102, v102
  v_cvt_pk_bf16_f32 v56, v100, v101
  v_exp_f32 v103, v103
  v_exp_f32 v104, v104
  v_mfma_f32_32x32x8_bf16 v[112:127], v[36:37], v[24:25], v[112:127]
  v_cvt_pk_bf16_f32 v57, v102, v103
  v_exp_f32 v105, v105
  v_exp_f32 v106, v106
  v_cvt_pk_bf16_f32 v58, v104, v105
  v_exp_f32 v107, v107
  v_exp_f32 v108, v108
  v_cvt_pk_bf16_f32 v59, v106, v107
  v_exp_f32 v109, v109
  v_mfma_f32_32x32x16_bf16 v[128:143], v[46:49], v[54:57], v[128:143]
  buffer_load_dwordx4 v2, s[8:11], s59 offen offset:3072 sc1 lds
  v_exp_f32 v110, v110
  v_cvt_pk_bf16_f32 v60, v108, v109
  v_exp_f32 v111, v111
  v_exp_f32 v112, v112
  v_cvt_pk_bf16_f32 v61, v110, v111
  v_exp_f32 v113, v113
  v_exp_f32 v114, v114
  v_mfma_f32_32x32x16_bf16 v[128:143], v[50:53], v[58:61], v[128:143]
  s_waitcnt lgkmcnt(0)
  s_add_u32 m0, m0, 16384
  s_add_u32 s59, s59, 16384
  buffer_load_dwordx4 v2, s[8:11], s59 offen offset:0 sc1 lds
  v_cvt_pk_bf16_f32 v54, v112, v113
  v_exp_f32 v115, v115
  v_exp_f32 v116, v116
  v_cvt_pk_bf16_f32 v55, v114, v115
  v_exp_f32 v117, v117
  v_mfma_f32_32x32x16_bf16 v[96:111], v[26:29], v[14:17], v[64:79]
  ds_read_b64 v[32:33], v3 offset:38400
  ds_read_b64 v[34:35], v3 offset:38656
  ds_read_b64 v[36:37], v3 offset:39424
  v_exp_f32 v118, v118
  v_cvt_pk_bf16_f32 v56, v116, v117
  v_exp_f32 v119, v119
  v_exp_f32 v120, v120
  v_mfma_f32_32x32x8_bf16 v[96:111], v[30:31], v[18:19], v[96:111]
  v_cvt_pk_bf16_f32 v57, v118, v119
  v_exp_f32 v121, v121
  v_exp_f32 v122, v122
  v_cvt_pk_bf16_f32 v58, v120, v121
  v_exp_f32 v123, v123
  v_exp_f32 v124, v124
  v_cvt_pk_bf16_f32 v59, v122, v123
  v_exp_f32 v125, v125
  v_mfma_f32_32x32x16_bf16 v[144:159], v[46:49], v[54:57], v[144:159]
  buffer_load_dwordx4 v2, s[8:11], s59 offen offset:1024 sc1 lds
  v_exp_f32 v126, v126
  v_cvt_pk_bf16_f32 v60, v124, v125
  v_exp_f32 v127, v127
  v_exp_f32 v96, v96
  v_cvt_pk_bf16_f32 v61, v126, v127
  v_exp_f32 v97, v97
  v_exp_f32 v98, v98
  v_mfma_f32_32x32x16_bf16 v[144:159], v[50:53], v[58:61], v[144:159]
  buffer_load_dwordx4 v2, s[8:11], s59 offen offset:2048 sc1 lds
  v_cvt_pk_bf16_f32 v54, v96, v97
  v_exp_f32 v99, v99
  v_exp_f32 v100, v100
  v_cvt_pk_bf16_f32 v55, v98, v99
  v_exp_f32 v101, v101
  v_mfma_f32_32x32x16_bf16 v[112:127], v[26:29], v[20:23], v[80:95]
  s_mov_b64 exec, s[38:39]
  ds_read_b128 v[46:49], v6 offset:38400
  ds_read_b128 v[50:53], v6 offset:39040
  s_mov_b64 exec, -1
  v_exp_f32 v102, v102
  v_cvt_pk_bf16_f32 v56, v100, v101
  v_exp_f32 v103, v103
  v_exp_f32 v104, v104
  v_mfma_f32_32x32x8_bf16 v[112:127], v[30:31], v[24:25], v[112:127]
  v_cvt_pk_bf16_f32 v57, v102, v103
  v_exp_f32 v105, v105
  v_exp_f32 v106, v106
  v_cvt_pk_bf16_f32 v58, v104, v105
  v_exp_f32 v107, v107
  v_exp_f32 v108, v108
  v_cvt_pk_bf16_f32 v59, v106, v107
  v_exp_f32 v109, v109
  v_mfma_f32_32x32x16_bf16 v[128:143], v[38:41], v[54:57], v[128:143]
  buffer_load_dwordx4 v2, s[8:11], s59 offen offset:3072 sc1 lds
  v_exp_f32 v110, v110
  v_cvt_pk_bf16_f32 v60, v108, v109
  v_exp_f32 v111, v111
  v_exp_f32 v112, v112
  v_cvt_pk_bf16_f32 v61, v110, v111
  v_exp_f32 v113, v113
  v_exp_f32 v114, v114
  v_mfma_f32_32x32x16_bf16 v[128:143], v[42:45], v[58:61], v[128:143]
  s_waitcnt lgkmcnt(0)
  v_cvt_pk_bf16_f32 v54, v112, v113
  v_exp_f32 v115, v115
  v_exp_f32 v116, v116
  v_cvt_pk_bf16_f32 v55, v114, v115
  v_exp_f32 v117, v117
  v_mfma_f32_32x32x16_bf16 v[96:111], v[32:35], v[14:17], v[64:79]
  ds_read_b64 v[26:27], v3 offset:40960
  ds_read_b64 v[28:29], v3 offset:41216
  ds_read_b64 v[30:31], v3 offset:41984
  v_exp_f32 v118, v118
  v_cvt_pk_bf16_f32 v56, v116, v117
  v_exp_f32 v119, v119
  v_exp_f32 v120, v120
  v_mfma_f32_32x32x8_bf16 v[96:111], v[36:37], v[18:19], v[96:111]
  v_cvt_pk_bf16_f32 v57, v118, v119
  v_exp_f32 v121, v121
  v_exp_f32 v122, v122
  v_cvt_pk_bf16_f32 v58, v120, v121
  v_exp_f32 v123, v123
  v_exp_f32 v124, v124
  v_cvt_pk_bf16_f32 v59, v122, v123
  v_exp_f32 v125, v125
  v_mfma_f32_32x32x16_bf16 v[144:159], v[38:41], v[54:57], v[144:159]
  v_exp_f32 v126, v126
  v_cvt_pk_bf16_f32 v60, v124, v125
  v_exp_f32 v127, v127
  v_exp_f32 v96, v96
  v_cvt_pk_bf16_f32 v61, v126, v127
  v_exp_f32 v97, v97
  v_exp_f32 v98, v98
  v_mfma_f32_32x32x16_bf16 v[144:159], v[42:45], v[58:61], v[144:159]
  v_cvt_pk_bf16_f32 v54, v96, v97
  v_exp_f32 v99, v99
  v_exp_f32 v100, v100
  v_cvt_pk_bf16_f32 v55, v98, v99
  v_exp_f32 v101, v101
  v_mfma_f32_32x32x16_bf16 v[112:127], v[32:35], v[20:23], v[80:95]
  s_mov_b64 exec, s[38:39]
  ds_read_b128 v[38:41], v6 offset:40960
  ds_read_b128 v[42:45], v6 offset:41600
  s_mov_b64 exec, -1
  v_exp_f32 v102, v102
  v_cvt_pk_bf16_f32 v56, v100, v101
  v_exp_f32 v103, v103
  v_exp_f32 v104, v104
  v_mfma_f32_32x32x8_bf16 v[112:127], v[36:37], v[24:25], v[112:127]
  v_cvt_pk_bf16_f32 v57, v102, v103
  v_exp_f32 v105, v105
  v_exp_f32 v106, v106
  v_cvt_pk_bf16_f32 v58, v104, v105
  v_exp_f32 v107, v107
  v_exp_f32 v108, v108
  v_cvt_pk_bf16_f32 v59, v106, v107
  v_exp_f32 v109, v109
  v_mfma_f32_32x32x16_bf16 v[128:143], v[46:49], v[54:57], v[128:143]
  v_exp_f32 v110, v110
  v_cvt_pk_bf16_f32 v60, v108, v109
  v_exp_f32 v111, v111
  v_exp_f32 v112, v112
  v_cvt_pk_bf16_f32 v61, v110, v111
  v_exp_f32 v113, v113
  v_exp_f32 v114, v114
  v_mfma_f32_32x32x16_bf16 v[128:143], v[50:53], v[58:61], v[128:143]
  s_waitcnt lgkmcnt(0)
  v_cvt_pk_bf16_f32 v54, v112, v113
  v_exp_f32 v115, v115
  v_exp_f32 v116, v116
  v_cvt_pk_bf16_f32 v55, v114, v115
  v_exp_f32 v117, v117
  v_mfma_f32_32x32x16_bf16 v[96:111], v[26:29], v[14:17], v[64:79]
  ds_read_b64 v[32:33], v3 offset:43520
  ds_read_b64 v[34:35], v3 offset:43776
  ds_read_b64 v[36:37], v3 offset:44544
  v_exp_f32 v118, v118
  v_cvt_pk_bf16_f32 v56, v116, v117
  v_exp_f32 v119, v119
  v_exp_f32 v120, v120
  v_mfma_f32_32x32x8_bf16 v[96:111], v[30:31], v[18:19], v[96:111]
  v_cvt_pk_bf16_f32 v57, v118, v119
  v_exp_f32 v121, v121
  v_exp_f32 v122, v122
  v_cvt_pk_bf16_f32 v58, v120, v121
  v_exp_f32 v123, v123
  v_exp_f32 v124, v124
  v_cvt_pk_bf16_f32 v59, v122, v123
  v_exp_f32 v125, v125
  v_mfma_f32_32x32x16_bf16 v[144:159], v[46:49], v[54:57], v[144:159]
  v_exp_f32 v126, v126
  v_cvt_pk_bf16_f32 v60, v124, v125
  v_exp_f32 v127, v127
  v_exp_f32 v96, v96
  v_cvt_pk_bf16_f32 v61, v126, v127
  v_exp_f32 v97, v97
  v_exp_f32 v98, v98
  v_mfma_f32_32x32x16_bf16 v[144:159], v[50:53], v[58:61], v[144:159]
  v_cvt_pk_bf16_f32 v54, v96, v97
  v_exp_f32 v99, v99
  v_exp_f32 v100, v100
  v_cvt_pk_bf16_f32 v55, v98, v99
  v_exp_f32 v101, v101
  v_mfma_f32_32x32x16_bf16 v[112:127], v[26:29], v[20:23], v[80:95]
  s_mov_b64 exec, s[38:39]
  ds_read_b128 v[46:49], v6 offset:43520
  ds_read_b128 v[50:53], v6 offset:44160
  s_mov_b64 exec, -1
  v_exp_f32 v102, v102
  v_cvt_pk_bf16_f32 v56, v100, v101
  v_exp_f32 v103, v103
  v_exp_f32 v104, v104
  v_mfma_f32_32x32x8_bf16 v[112:127], v[30:31], v[24:25], v[112:127]
  v_cvt_pk_bf16_f32 v57, v102, v103
  v_exp_f32 v105, v105
  v_exp_f32 v106, v106
  v_cvt_pk_bf16_f32 v58, v104, v105
  v_exp_f32 v107, v107
  v_exp_f32 v108, v108
  v_cvt_pk_bf16_f32 v59, v106, v107
  v_exp_f32 v109, v109
  v_mfma_f32_32x32x16_bf16 v[128:143], v[38:41], v[54:57], v[128:143]
  v_exp_f32 v110, v110
  v_cvt_pk_bf16_f32 v60, v108, v109
  v_exp_f32 v111, v111
  v_exp_f32 v112, v112
  v_cvt_pk_bf16_f32 v61, v110, v111
  v_exp_f32 v113, v113
  v_exp_f32 v114, v114
  v_mfma_f32_32x32x16_bf16 v[128:143], v[42:45], v[58:61], v[128:143]
  s_waitcnt lgkmcnt(0)
  v_cvt_pk_bf16_f32 v54, v112, v113
  v_exp_f32 v115, v115
  v_exp_f32 v116, v116
  v_cvt_pk_bf16_f32 v55, v114, v115
  v_exp_f32 v117, v117
  v_mfma_f32_32x32x16_bf16 v[96:111], v[32:35], v[14:17], v[64:79]
  ds_read_b64 v[26:27], v3 offset:46080
  ds_read_b64 v[28:29], v3 offset:46336
  ds_read_b64 v[30:31], v3 offset:47104
  v_exp_f32 v118, v118
  v_cvt_pk_bf16_f32 v56, v116, v117
  v_exp_f32 v119, v119
  v_exp_f32 v120, v120
  v_mfma_f32_32x32x8_bf16 v[96:111], v[36:37], v[18:19], v[96:111]
  v_cvt_pk_bf16_f32 v57, v118, v119
  v_exp_f32 v121, v121
  v_exp_f32 v122, v122
  v_cvt_pk_bf16_f32 v58, v120, v121
  v_exp_f32 v123, v123
  v_exp_f32 v124, v124
  v_cvt_pk_bf16_f32 v59, v122, v123
  v_exp_f32 v125, v125
  v_mfma_f32_32x32x16_bf16 v[144:159], v[38:41], v[54:57], v[144:159]
  v_exp_f32 v126, v126
  v_cvt_pk_bf16_f32 v60, v124, v125
  v_exp_f32 v127, v127
  v_exp_f32 v96, v96
  v_cvt_pk_bf16_f32 v61, v126, v127
  v_exp_f32 v97, v97
  v_exp_f32 v98, v98
  v_mfma_f32_32x32x16_bf16 v[144:159], v[42:45], v[58:61], v[144:159]
  v_cvt_pk_bf16_f32 v54, v96, v97
  v_exp_f32 v99, v99
  v_exp_f32 v100, v100
  v_cvt_pk_bf16_f32 v55, v98, v99
  v_exp_f32 v101, v101
  v_mfma_f32_32x32x16_bf16 v[112:127], v[32:35], v[20:23], v[80:95]
  s_mov_b64 exec, s[38:39]
  ds_read_b128 v[38:41], v6 offset:46080
  ds_read_b128 v[42:45], v6 offset:46720
  s_mov_b64 exec, -1
  v_exp_f32 v102, v102
  v_cvt_pk_bf16_f32 v56, v100, v101
  v_exp_f32 v103, v103
  v_exp_f32 v104, v104
  v_mfma_f32_32x32x8_bf16 v[112:127], v[36:37], v[24:25], v[112:127]
  v_cvt_pk_bf16_f32 v57, v102, v103
  v_exp_f32 v105, v105
  v_exp_f32 v106, v106
  v_cvt_pk_bf16_f32 v58, v104, v105
  v_exp_f32 v107, v107
  v_exp_f32 v108, v108
  v_cvt_pk_bf16_f32 v59, v106, v107
  v_exp_f32 v109, v109
  v_mfma_f32_32x32x16_bf16 v[128:143], v[46:49], v[54:57], v[128:143]
  v_exp_f32 v110, v110
  v_cvt_pk_bf16_f32 v60, v108, v109
  v_exp_f32 v111, v111
  v_exp_f32 v112, v112
  v_cvt_pk_bf16_f32 v61, v110, v111
  v_exp_f32 v113, v113
  v_exp_f32 v114, v114
  v_mfma_f32_32x32x16_bf16 v[128:143], v[50:53], v[58:61], v[128:143]
  s_waitcnt lgkmcnt(0)
  v_cvt_pk_bf16_f32 v54, v112, v113
  v_exp_f32 v115, v115
  v_exp_f32 v116, v116
  v_cvt_pk_bf16_f32 v55, v114, v115
  v_exp_f32 v117, v117
  v_mfma_f32_32x32x16_bf16 v[96:111], v[26:29], v[14:17], v[64:79]
  ds_read_b64 v[32:33], v3 offset:48640
  ds_read_b64 v[34:35], v3 offset:48896
  ds_read_b64 v[36:37], v3 offset:49664
  v_exp_f32 v118, v118
  v_cvt_pk_bf16_f32 v56, v116, v117
  v_exp_f32 v119, v119
  v_exp_f32 v120, v120
  v_mfma_f32_32x32x8_bf16 v[96:111], v[30:31], v[18:19], v[96:111]
  v_cvt_pk_bf16_f32 v57, v118, v119
  v_exp_f32 v121, v121
  v_exp_f32 v122, v122
  v_cvt_pk_bf16_f32 v58, v120, v121
  v_exp_f32 v123, v123
  v_exp_f32 v124, v124
  v_cvt_pk_bf16_f32 v59, v122, v123
  v_exp_f32 v125, v125
  v_mfma_f32_32x32x16_bf16 v[144:159], v[46:49], v[54:57], v[144:159]
  v_exp_f32 v126, v126
  v_cvt_pk_bf16_f32 v60, v124, v125
  v_exp_f32 v127, v127
  v_exp_f32 v96, v96
  v_cvt_pk_bf16_f32 v61, v126, v127
  v_exp_f32 v97, v97
  v_exp_f32 v98, v98
  v_mfma_f32_32x32x16_bf16 v[144:159], v[50:53], v[58:61], v[144:159]
  v_cvt_pk_bf16_f32 v54, v96, v97
  v_exp_f32 v99, v99
  v_exp_f32 v100, v100
  v_cvt_pk_bf16_f32 v55, v98, v99
  v_exp_f32 v101, v101
  v_mfma_f32_32x32x16_bf16 v[112:127], v[26:29], v[20:23], v[80:95]
  s_mov_b64 exec, s[38:39]
  ds_read_b128 v[46:49], v6 offset:48640
  ds_read_b128 v[50:53], v6 offset:49280
  s_mov_b64 exec, -1
  v_exp_f32 v102, v102
  v_cvt_pk_bf16_f32 v56, v100, v101
  v_exp_f32 v103, v103
  v_exp_f32 v104, v104
  v_mfma_f32_32x32x8_bf16 v[112:127], v[30:31], v[24:25], v[112:127]
  v_cvt_pk_bf16_f32 v57, v102, v103
  v_exp_f32 v105, v105
  v_exp_f32 v106, v106
  v_cvt_pk_bf16_f32 v58, v104, v105
  v_exp_f32 v107, v107
  v_exp_f32 v108, v108
  v_cvt_pk_bf16_f32 v59, v106, v107
  v_exp_f32 v109, v109
  v_mfma_f32_32x32x16_bf16 v[128:143], v[38:41], v[54:57], v[128:143]
  v_exp_f32 v110, v110
  v_cvt_pk_bf16_f32 v60, v108, v109
  v_exp_f32 v111, v111
  v_exp_f32 v112, v112
  v_cvt_pk_bf16_f32 v61, v110, v111
  v_exp_f32 v113, v113
  v_exp_f32 v114, v114
  v_mfma_f32_32x32x16_bf16 v[128:143], v[42:45], v[58:61], v[128:143]
  s_waitcnt lgkmcnt(0)
  v_cvt_pk_bf16_f32 v54, v112, v113
  v_exp_f32 v115, v115
  v_exp_f32 v116, v116
  v_cvt_pk_bf16_f32 v55, v114, v115
  v_exp_f32 v117, v117
  v_mfma_f32_32x32x16_bf16 v[96:111], v[32:35], v[14:17], v[64:79]
  ds_read_b64 v[26:27], v3 offset:51200
  ds_read_b64 v[28:29], v3 offset:51456
  ds_read_b64 v[30:31], v3 offset:52224
  v_exp_f32 v118, v118
  v_cvt_pk_bf16_f32 v56, v116, v117
  v_exp_f32 v119, v119
  v_exp_f32 v120, v120
  v_mfma_f32_32x32x8_bf16 v[96:111], v[36:37], v[18:19], v[96:111]
  v_cvt_pk_bf16_f32 v57, v118, v119
  v_exp_f32 v121, v121
  v_exp_f32 v122, v122
  v_cvt_pk_bf16_f32 v58, v120, v121
  v_exp_f32 v123, v123
  v_exp_f32 v124, v124
  v_cvt_pk_bf16_f32 v59, v122, v123
  v_exp_f32 v125, v125
  v_mfma_f32_32x32x16_bf16 v[144:159], v[38:41], v[54:57], v[144:159]
  v_exp_f32 v126, v126
  v_cvt_pk_bf16_f32 v60, v124, v125
  v_exp_f32 v127, v127
  v_exp_f32 v96, v96
  v_cvt_pk_bf16_f32 v61, v126, v127
  v_exp_f32 v97, v97
  v_exp_f32 v98, v98
  v_mfma_f32_32x32x16_bf16 v[144:159], v[42:45], v[58:61], v[144:159]
  v_cvt_pk_bf16_f32 v54, v96, v97
  v_exp_f32 v99, v99
  v_exp_f32 v100, v100
  v_cvt_pk_bf16_f32 v55, v98, v99
  v_exp_f32 v101, v101
  v_mfma_f32_32x32x16_bf16 v[112:127], v[32:35], v[20:23], v[80:95]
  s_mov_b64 exec, s[38:39]
  ds_read_b128 v[38:41], v6 offset:51200
  ds_read_b128 v[42:45], v6 offset:51840
  s_mov_b64 exec, -1
  v_exp_f32 v102, v102
  v_cvt_pk_bf16_f32 v56, v100, v101
  v_exp_f32 v103, v103
  v_exp_f32 v104, v104
  v_mfma_f32_32x32x8_bf16 v[112:127], v[36:37], v[24:25], v[112:127]
  v_cvt_pk_bf16_f32 v57, v102, v103
  v_exp_f32 v105, v105
  v_exp_f32 v106, v106
  v_cvt_pk_bf16_f32 v58, v104, v105
  v_exp_f32 v107, v107
  v_exp_f32 v108, v108
  v_cvt_pk_bf16_f32 v59, v106, v107
  v_exp_f32 v109, v109
  v_mfma_f32_32x32x16_bf16 v[128:143], v[46:49], v[54:57], v[128:143]
  s_waitcnt vmcnt(0)
  s_barrier
  s_cmp_lg_u32 s28, 0
  s_cbranch_scc1 L_nfl_120
  s_mov_b64 exec, 1
  buffer_store_dword v192, v193, s[8:11], s40 offen sc0 sc1
  s_mov_b64 exec, -1
L_nfl_120:
  v_exp_f32 v110, v110
  v_cvt_pk_bf16_f32 v60, v108, v109
  v_exp_f32 v111, v111
  v_exp_f32 v112, v112
  v_cvt_pk_bf16_f32 v61, v110, v111
  v_exp_f32 v113, v113
  v_exp_f32 v114, v114
  v_mfma_f32_32x32x16_bf16 v[128:143], v[50:53], v[58:61], v[128:143]
  s_waitcnt lgkmcnt(0)
  v_cvt_pk_bf16_f32 v54, v112, v113
  v_exp_f32 v115, v115
  v_exp_f32 v116, v116
  v_cvt_pk_bf16_f32 v55, v114, v115
  v_exp_f32 v117, v117
  v_mfma_f32_32x32x16_bf16 v[96:111], v[26:29], v[14:17], v[64:79]
  ds_read_b64 v[32:33], v3 offset:53760
  ds_read_b64 v[34:35], v3 offset:54016
  ds_read_b64 v[36:37], v3 offset:54784
  v_exp_f32 v118, v118
  v_cvt_pk_bf16_f32 v56, v116, v117
  v_exp_f32 v119, v119
  v_exp_f32 v120, v120
  v_mfma_f32_32x32x8_bf16 v[96:111], v[30:31], v[18:19], v[96:111]
  v_cvt_pk_bf16_f32 v57, v118, v119
  v_exp_f32 v121, v121
  v_exp_f32 v122, v122
  v_cvt_pk_bf16_f32 v58, v120, v121
  v_exp_f32 v123, v123
  v_exp_f32 v124, v124
  v_cvt_pk_bf16_f32 v59, v122, v123
  v_exp_f32 v125, v125
  v_mfma_f32_32x32x16_bf16 v[144:159], v[46:49], v[54:57], v[144:159]
  s_add_u32 m0, m0, 16384
  s_add_u32 s59, s59, 16384
  buffer_load_dwordx4 v2, s[8:11], s59 offen offset:0 sc1 lds
  v_exp_f32 v126, v126
  v_cvt_pk_bf16_f32 v60, v124, v125
  v_exp_f32 v127, v127
  v_exp_f32 v96, v96
  v_cvt_pk_bf16_f32 v61, v126, v127
  v_exp_f32 v97, v97
  v_exp_f32 v98, v98
  v_mfma_f32_32x32x16_bf16 v[144:159], v[50:53], v[58:61], v[144:159]
  v_cvt_pk_bf16_f32 v54, v96, v97
  v_exp_f32 v99, v99
  v_exp_f32 v100, v100
  v_cvt_pk_bf16_f32 v55, v98, v99
  v_exp_f32 v101, v101
  v_mfma_f32_32x32x16_bf16 v[112:127], v[26:29], v[20:23], v[80:95]
  s_mov_b64 exec, s[38:39]
  ds_read_b128 v[46:49], v6 offset:53760
  ds_read_b128 v[50:53], v6 offset:54400
  s_mov_b64 exec, -1
  v_exp_f32 v102, v102
  v_cvt_pk_bf16_f32 v56, v100, v101
  v_exp_f32 v103, v103
  v_exp_f32 v104, v104
  v_mfma_f32_32x32x8_bf16 v[112:127], v[30:31], v[24:25], v[112:127]
  v_cvt_pk_bf16_f32 v57, v102, v103
  v_exp_f32 v105, v105
  v_exp_f32 v106, v106
  v_cvt_pk_bf16_f32 v58, v104, v105
  v_exp_f32 v107, v107
  v_exp_f32 v108, v108
  v_cvt_pk_bf16_f32 v59, v106, v107
  v_exp_f32 v109, v109
  v_mfma_f32_32x32x16_bf16 v[128:143], v[38:41], v[54:57], v[128:143]
  v_exp_f32 v110, v110
  v_cvt_pk_bf16_f32 v60, v108, v109
  v_exp_f32 v111, v111
  v_exp_f32 v112, v112
  v_cvt_pk_bf16_f32 v61, v110, v111
  v_exp_f32 v113, v113
  v_exp_f32 v114, v114
  v_mfma_f32_32x32x16_bf16 v[128:143], v[42:45], v[58:61], v[128:143]
  s_waitcnt lgkmcnt(0)
  v_cvt_pk_bf16_f32 v54, v112, v113
  v_exp_f32 v115, v115
  v_exp_f32 v116, v116
  v_cvt_pk_bf16_f32 v55, v114, v115
  v_exp_f32 v117, v117
  v_mfma_f32_32x32x16_bf16 v[96:111], v[32:35], v[14:17], v[64:79]
  ds_read_b64 v[26:27], v3 offset:56320
  ds_read_b64 v[28:29], v3 offset:56576
  ds_read_b64 v[30:31], v3 offset:57344
  v_exp_f32 v118, v118
  v_cvt_pk_bf16_f32 v56, v116, v117
  v_exp_f32 v119, v119
  v_exp_f32 v120, v120
  v_mfma_f32_32x32x8_bf16 v[96:111], v[36:37], v[18:19], v[96:111]
  v_cvt_pk_bf16_f32 v57, v118, v119
  v_exp_f32 v121, v121
  v_exp_f32 v122, v122
  v_cvt_pk_bf16_f32 v58, v120, v121
  v_exp_f32 v123, v123
  v_exp_f32 v124, v124
  v_cvt_pk_bf16_f32 v59, v122, v123
  v_exp_f32 v125, v125
  v_mfma_f32_32x32x16_bf16 v[144:159], v[38:41], v[54:57], v[144:159]
  buffer_load_dwordx4 v2, s[8:11], s59 offen offset:1024 sc1 lds
  v_exp_f32 v126, v126
  v_cvt_pk_bf16_f32 v60, v124, v125
  v_exp_f32 v127, v127
  v_exp_f32 v96, v96
  v_cvt_pk_bf16_f32 v61, v126, v127
  v_exp_f32 v97, v97
  v_exp_f32 v98, v98
  v_mfma_f32_32x32x16_bf16 v[144:159], v[42:45], v[58:61], v[144:159]
  v_cvt_pk_bf16_f32 v54, v96, v97
  v_exp_f32 v99, v99
  v_exp_f32 v100, v100
  v_cvt_pk_bf16_f32 v55, v98, v99
  v_exp_f32 v101, v101
  v_mfma_f32_32x32x16_bf16 v[112:127], v[32:35], v[20:23], v[80:95]
  s_mov_b64 exec, s[38:39]
  ds_read_b128 v[38:41], v6 offset:56320
  ds_read_b128 v[42:45], v6 offset:56960
  s_mov_b64 exec, -1
  v_exp_f32 v102, v102
  v_cvt_pk_bf16_f32 v56, v100, v101
  v_exp_f32 v103, v103
  v_exp_f32 v104, v104
  v_mfma_f32_32x32x8_bf16 v[112:127], v[36:37], v[24:25], v[112:127]
  v_cvt_pk_bf16_f32 v57, v102, v103
  v_exp_f32 v105, v105
  v_exp_f32 v106, v106
  v_cvt_pk_bf16_f32 v58, v104, v105
  v_exp_f32 v107, v107
  v_exp_f32 v108, v108
  v_cvt_pk_bf16_f32 v59, v106, v107
  v_exp_f32 v109, v109
  v_mfma_f32_32x32x16_bf16 v[128:143], v[46:49], v[54:57], v[128:143]
  v_exp_f32 v110, v110
  v_cvt_pk_bf16_f32 v60, v108, v109
  v_exp_f32 v111, v111
  v_exp_f32 v112, v112
  v_cvt_pk_bf16_f32 v61, v110, v111
  v_exp_f32 v113, v113
  v_exp_f32 v114, v114
  v_mfma_f32_32x32x16_bf16 v[128:143], v[50:53], v[58:61], v[128:143]
  s_waitcnt lgkmcnt(0)
  v_cvt_pk_bf16_f32 v54, v112, v113
  v_exp_f32 v115, v115
  v_exp_f32 v116, v116
  v_cvt_pk_bf16_f32 v55, v114, v115
  v_exp_f32 v117, v117
  v_mfma_f32_32x32x16_bf16 v[96:111], v[26:29], v[14:17], v[64:79]
  ds_read_b64 v[32:33], v3 offset:58880
  ds_read_b64 v[34:35], v3 offset:59136
  ds_read_b64 v[36:37], v3 offset:59904
  v_exp_f32 v118, v118
  v_cvt_pk_bf16_f32 v56, v116, v117
  v_exp_f32 v119, v119
  v_exp_f32 v120, v120
  v_mfma_f32_32x32x8_bf16 v[96:111], v[30:31], v[18:19], v[96:111]
  v_cvt_pk_bf16_f32 v57, v118, v119
  v_exp_f32 v121, v121
  v_exp_f32 v122, v122
  v_cvt_pk_bf16_f32 v58, v120, v121
  v_exp_f32 v123, v123
  v_exp_f32 v124, v124
  v_cvt_pk_bf16_f32 v59, v122, v123
  v_exp_f32 v125, v125
  v_mfma_f32_32x32x16_bf16 v[144:159], v[46:49], v[54:57], v[144:159]
  buffer_load_dwordx4 v2, s[8:11], s59 offen offset:2048 sc1 lds
  v_exp_f32 v126, v126
  v_cvt_pk_bf16_f32 v60, v124, v125
  v_exp_f32 v127, v127
  v_exp_f32 v96, v96
  v_cvt_pk_bf16_f32 v61, v126, v127
  v_exp_f32 v97, v97
  v_exp_f32 v98, v98
  v_mfma_f32_32x32x16_bf16 v[144:159], v[50:53], v[58:61], v[144:159]
  v_cvt_pk_bf16_f32 v54, v96, v97
  v_exp_f32 v99, v99
  v_exp_f32 v100, v100
  v_cvt_pk_bf16_f32 v55, v98, v99
  v_exp_f32 v101, v101
  v_mfma_f32_32x32x16_bf16 v[112:127], v[26:29], v[20:23], v[80:95]
  s_mov_b64 exec, s[38:39]
  ds_read_b128 v[46:49], v6 offset:58880
  ds_read_b128 v[50:53], v6 offset:59520
  s_mov_b64 exec, -1
  v_exp_f32 v102, v102
  v_cvt_pk_bf16_f32 v56, v100, v101
  v_exp_f32 v103, v103
  v_exp_f32 v104, v104
  v_mfma_f32_32x32x8_bf16 v[112:127], v[30:31], v[24:25], v[112:127]
  v_cvt_pk_bf16_f32 v57, v102, v103
  v_exp_f32 v105, v105
  v_exp_f32 v106, v106
  v_cvt_pk_bf16_f32 v58, v104, v105
  v_exp_f32 v107, v107
  v_exp_f32 v108, v108
  v_cvt_pk_bf16_f32 v59, v106, v107
  v_exp_f32 v109, v109
  v_mfma_f32_32x32x16_bf16 v[128:143], v[38:41], v[54:57], v[128:143]
  v_exp_f32 v110, v110
  v_cvt_pk_bf16_f32 v60, v108, v109
  v_exp_f32 v111, v111
  v_exp_f32 v112, v112
  v_cvt_pk_bf16_f32 v61, v110, v111
  v_exp_f32 v113, v113
  v_exp_f32 v114, v114
  v_mfma_f32_32x32x16_bf16 v[128:143], v[42:45], v[58:61], v[128:143]
  s_waitcnt lgkmcnt(0)
  v_cvt_pk_bf16_f32 v54, v112, v113
  v_exp_f32 v115, v115
  v_exp_f32 v116, v116
  v_cvt_pk_bf16_f32 v55, v114, v115
  v_exp_f32 v117, v117
  v_mfma_f32_32x32x16_bf16 v[96:111], v[32:35], v[14:17], v[64:79]
  ds_read_b64 v[26:27], v4 offset:0
  ds_read_b64 v[28:29], v4 offset:256
  ds_read_b64 v[30:31], v4 offset:1024
  v_exp_f32 v118, v118
  v_cvt_pk_bf16_f32 v56, v116, v117
  v_exp_f32 v119, v119
  v_exp_f32 v120, v120
  v_mfma_f32_32x32x8_bf16 v[96:111], v[36:37], v[18:19], v[96:111]
  v_cvt_pk_bf16_f32 v57, v118, v119
  v_exp_f32 v121, v121
  v_exp_f32 v122, v122
  v_cvt_pk_bf16_f32 v58, v120, v121
  v_exp_f32 v123, v123
  v_exp_f32 v124, v124
  v_cvt_pk_bf16_f32 v59, v122, v123
  v_exp_f32 v125, v125
  v_mfma_f32_32x32x16_bf16 v[144:159], v[38:41], v[54:57], v[144:159]
  buffer_load_dwordx4 v2, s[8:11], s59 offen offset:3072 sc1 lds
  v_exp_f32 v126, v126
  v_cvt_pk_bf16_f32 v60, v124, v125
  v_exp_f32 v127, v127
  v_exp_f32 v96, v96
  v_cvt_pk_bf16_f32 v61, v126, v127
  v_exp_f32 v97, v97
  v_exp_f32 v98, v98
  v_mfma_f32_32x32x16_bf16 v[144:159], v[42:45], v[58:61], v[144:159]
  v_cvt_pk_bf16_f32 v54, v96, v97
  v_exp_f32 v99, v99
  v_exp_f32 v100, v100
  v_cvt_pk_bf16_f32 v55, v98, v99
  v_exp_f32 v101, v101
  v_mfma_f32_32x32x16_bf16 v[112:127], v[32:35], v[20:23], v[80:95]
  s_mov_b64 exec, s[38:39]
  ds_read_b128 v[38:41], v7 offset:0
  ds_read_b128 v[42:45], v7 offset:640
  s_mov_b64 exec, -1
  v_exp_f32 v102, v102
  v_cvt_pk_bf16_f32 v56, v100, v101
  v_exp_f32 v103, v103
  v_exp_f32 v104, v104
  v_mfma_f32_32x32x8_bf16 v[112:127], v[36:37], v[24:25], v[112:127]
  v_cvt_pk_bf16_f32 v57, v102, v103
  v_exp_f32 v105, v105
  v_exp_f32 v106, v106
  v_cvt_pk_bf16_f32 v58, v104, v105
  v_exp_f32 v107, v107
  v_exp_f32 v108, v108
  v_cvt_pk_bf16_f32 v59, v106, v107
  v_exp_f32 v109, v109
  v_mfma_f32_32x32x16_bf16 v[128:143], v[46:49], v[54:57], v[128:143]
  v_exp_f32 v110, v110
  v_cvt_pk_bf16_f32 v60, v108, v109
  v_exp_f32 v111, v111
  v_exp_f32 v112, v112
  v_cvt_pk_bf16_f32 v61, v110, v111
  v_exp_f32 v113, v113
  v_exp_f32 v114, v114
  v_mfma_f32_32x32x16_bf16 v[128:143], v[50:53], v[58:61], v[128:143]
  s_waitcnt lgkmcnt(0)
  v_cvt_pk_bf16_f32 v54, v112, v113
  v_exp_f32 v115, v115
  v_exp_f32 v116, v116
  v_cvt_pk_bf16_f32 v55, v114, v115
  v_exp_f32 v117, v117
  v_mfma_f32_32x32x16_bf16 v[96:111], v[26:29], v[14:17], v[64:79]
  ds_read_b64 v[32:33], v4 offset:2560
  ds_read_b64 v[34:35], v4 offset:2816
  ds_read_b64 v[36:37], v4 offset:3584
  v_exp_f32 v118, v118
  v_cvt_pk_bf16_f32 v56, v116, v117
  v_exp_f32 v119, v119
  v_exp_f32 v120, v120
  v_mfma_f32_32x32x8_bf16 v[96:111], v[30:31], v[18:19], v[96:111]
  v_cvt_pk_bf16_f32 v57, v118, v119
  v_exp_f32 v121, v121
  v_exp_f32 v122, v122
  v_cvt_pk_bf16_f32 v58, v120, v121
  v_exp_f32 v123, v123
  v_exp_f32 v124, v124
  v_cvt_pk_bf16_f32 v59, v122, v123
  v_exp_f32 v125, v125
  v_mfma_f32_32x32x16_bf16 v[144:159], v[46:49], v[54:57], v[144:159]
  s_add_u32 m0, m0, 16384
  s_add_u32 s59, s59, 16384
  buffer_load_dwordx4 v2, s[8:11], s59 offen offset:0 sc1 lds
  v_exp_f32 v126, v126
  v_cvt_pk_bf16_f32 v60, v124, v125
  v_exp_f32 v127, v127
  v_exp_f32 v96, v96
  v_cvt_pk_bf16_f32 v61, v126, v127
  v_exp_f32 v97, v97
  v_exp_f32 v98, v98
  v_mfma_f32_32x32x16_bf16 v[144:159], v[50:53], v[58:61], v[144:159]
  v_cvt_pk_bf16_f32 v54, v96, v97
  v_exp_f32 v99, v99
  v_exp_f32 v100, v100
  v_cvt_pk_bf16_f32 v55, v98, v99
  v_exp_f32 v101, v101
  v_mfma_f32_32x32x16_bf16 v[112:127], v[26:29], v[20:23], v[80:95]
  s_mov_b64 exec, s[38:39]
  ds_read_b128 v[46:49], v7 offset:2560
  ds_read_b128 v[50:53], v7 offset:3200
  s_mov_b64 exec, -1
  v_exp_f32 v102, v102
  v_cvt_pk_bf16_f32 v56, v100, v101
  v_exp_f32 v103, v103
  v_exp_f32 v104, v104
  v_mfma_f32_32x32x8_bf16 v[112:127], v[30:31], v[24:25], v[112:127]
  v_cvt_pk_bf16_f32 v57, v102, v103
  v_exp_f32 v105, v105
  v_exp_f32 v106, v106
  v_cvt_pk_bf16_f32 v58, v104, v105
  v_exp_f32 v107, v107
  v_exp_f32 v108, v108
  v_cvt_pk_bf16_f32 v59, v106, v107
  v_exp_f32 v109, v109
  v_mfma_f32_32x32x16_bf16 v[128:143], v[38:41], v[54:57], v[128:143]
  v_exp_f32 v110, v110
  v_cvt_pk_bf16_f32 v60, v108, v109
  v_exp_f32 v111, v111
  v_exp_f32 v112, v112
  v_cvt_pk_bf16_f32 v61, v110, v111
  v_exp_f32 v113, v113
  v_exp_f32 v114, v114
  v_mfma_f32_32x32x16_bf16 v[128:143], v[42:45], v[58:61], v[128:143]
  s_waitcnt lgkmcnt(0)
  v_cvt_pk_bf16_f32 v54, v112, v113
  v_exp_f32 v115, v115
  v_exp_f32 v116, v116
  v_cvt_pk_bf16_f32 v55, v114, v115
  v_exp_f32 v117, v117
  v_mfma_f32_32x32x16_bf16 v[96:111], v[32:35], v[14:17], v[64:79]
  ds_read_b64 v[26:27], v4 offset:5120
  ds_read_b64 v[28:29], v4 offset:5376
  ds_read_b64 v[30:31], v4 offset:6144
  v_exp_f32 v118, v118
  v_cvt_pk_bf16_f32 v56, v116, v117
  v_exp_f32 v119, v119
  v_exp_f32 v120, v120
  v_mfma_f32_32x32x8_bf16 v[96:111], v[36:37], v[18:19], v[96:111]
  v_cvt_pk_bf16_f32 v57, v118, v119
  v_exp_f32 v121, v121
  v_exp_f32 v122, v122
  v_cvt_pk_bf16_f32 v58, v120, v121
  v_exp_f32 v123, v123
  v_exp_f32 v124, v124
  v_cvt_pk_bf16_f32 v59, v122, v123
  v_exp_f32 v125, v125
  v_mfma_f32_32x32x16_bf16 v[144:159], v[38:41], v[54:57], v[144:159]
  buffer_load_dwordx4 v2, s[8:11], s59 offen offset:1024 sc1 lds
  v_exp_f32 v126, v126
  v_cvt_pk_bf16_f32 v60, v124, v125
  v_exp_f32 v127, v127
  v_exp_f32 v96, v96
  v_cvt_pk_bf16_f32 v61, v126, v127
  v_exp_f32 v97, v97
  v_exp_f32 v98, v98
  v_mfma_f32_32x32x16_bf16 v[144:159], v[42:45], v[58:61], v[144:159]
  v_cvt_pk_bf16_f32 v54, v96, v97
  v_exp_f32 v99, v99
  v_exp_f32 v100, v100
  v_cvt_pk_bf16_f32 v55, v98, v99
  v_exp_f32 v101, v101
  v_mfma_f32_32x32x16_bf16 v[112:127], v[32:35], v[20:23], v[80:95]
  s_mov_b64 exec, s[38:39]
  ds_read_b128 v[38:41], v7 offset:5120
  ds_read_b128 v[42:45], v7 offset:5760
  s_mov_b64 exec, -1
  v_exp_f32 v102, v102
  v_cvt_pk_bf16_f32 v56, v100, v101
  v_exp_f32 v103, v103
  v_exp_f32 v104, v104
  v_mfma_f32_32x32x8_bf16 v[112:127], v[36:37], v[24:25], v[112:127]
  v_cvt_pk_bf16_f32 v57, v102, v103
  v_exp_f32 v105, v105
  v_exp_f32 v106, v106
  v_cvt_pk_bf16_f32 v58, v104, v105
  v_exp_f32 v107, v107
  v_exp_f32 v108, v108
  v_cvt_pk_bf16_f32 v59, v106, v107
  v_exp_f32 v109, v109
  v_mfma_f32_32x32x16_bf16 v[128:143], v[46:49], v[54:57], v[128:143]
  buffer_load_dwordx4 v[196:199], v2, s[8:11], s41 offen sc1
  v_exp_f32 v110, v110
  v_cvt_pk_bf16_f32 v60, v108, v109
  v_exp_f32 v111, v111
  v_exp_f32 v112, v112
  v_cvt_pk_bf16_f32 v61, v110, v111
  v_exp_f32 v113, v113
  v_exp_f32 v114, v114
  v_mfma_f32_32x32x16_bf16 v[128:143], v[50:53], v[58:61], v[128:143]
  s_waitcnt lgkmcnt(0)
  v_cvt_pk_bf16_f32 v54, v112, v113
  v_exp_f32 v115, v115
  v_exp_f32 v116, v116
  v_cvt_pk_bf16_f32 v55, v114, v115
  v_exp_f32 v117, v117
  v_mfma_f32_32x32x16_bf16 v[96:111], v[26:29], v[14:17], v[64:79]
  ds_read_b64 v[32:33], v4 offset:7680
  ds_read_b64 v[34:35], v4 offset:7936
  ds_read_b64 v[36:37], v4 offset:8704
  v_exp_f32 v118, v118
  v_cvt_pk_bf16_f32 v56, v116, v117
  v_exp_f32 v119, v119
  v_exp_f32 v120, v120
  v_mfma_f32_32x32x8_bf16 v[96:111], v[30:31], v[18:19], v[96:111]
  v_cvt_pk_bf16_f32 v57, v118, v119
  v_exp_f32 v121, v121
  v_exp_f32 v122, v122
  v_cvt_pk_bf16_f32 v58, v120, v121
  v_exp_f32 v123, v123
  v_exp_f32 v124, v124
  v_cvt_pk_bf16_f32 v59, v122, v123
  v_exp_f32 v125, v125
  v_mfma_f32_32x32x16_bf16 v[144:159], v[46:49], v[54:57], v[144:159]
  buffer_load_dwordx4 v2, s[8:11], s59 offen offset:2048 sc1 lds
  v_exp_f32 v126, v126
  v_cvt_pk_bf16_f32 v60, v124, v125
  v_exp_f32 v127, v127
  v_exp_f32 v96, v96
  v_cvt_pk_bf16_f32 v61, v126, v127
  v_exp_f32 v97, v97
  v_exp_f32 v98, v98
  v_mfma_f32_32x32x16_bf16 v[144:159], v[50:53], v[58:61], v[144:159]
  v_cvt_pk_bf16_f32 v54, v96, v97
  v_exp_f32 v99, v99
  v_exp_f32 v100, v100
  v_cvt_pk_bf16_f32 v55, v98, v99
  v_exp_f32 v101, v101
  v_mfma_f32_32x32x16_bf16 v[112:127], v[26:29], v[20:23], v[80:95]
  s_mov_b64 exec, s[38:39]
  ds_read_b128 v[46:49], v7 offset:7680
  ds_read_b128 v[50:53], v7 offset:8320
  s_mov_b64 exec, -1
  v_exp_f32 v102, v102
  v_cvt_pk_bf16_f32 v56, v100, v101
  v_exp_f32 v103, v103
  v_exp_f32 v104, v104
  v_mfma_f32_32x32x8_bf16 v[112:127], v[30:31], v[24:25], v[112:127]
  v_cvt_pk_bf16_f32 v57, v102, v103
  v_exp_f32 v105, v105
  v_exp_f32 v106, v106
  v_cvt_pk_bf16_f32 v58, v104, v105
  v_exp_f32 v107, v107
  v_exp_f32 v108, v108
  v_cvt_pk_bf16_f32 v59, v106, v107
  v_exp_f32 v109, v109
  v_mfma_f32_32x32x16_bf16 v[128:143], v[38:41], v[54:57], v[128:143]
  v_exp_f32 v110, v110
  v_cvt_pk_bf16_f32 v60, v108, v109
  v_exp_f32 v111, v111
  v_exp_f32 v112, v112
  v_cvt_pk_bf16_f32 v61, v110, v111
  v_exp_f32 v113, v113
  v_exp_f32 v114, v114
  v_mfma_f32_32x32x16_bf16 v[128:143], v[42:45], v[58:61], v[128:143]
  s_waitcnt lgkmcnt(0)
  v_cvt_pk_bf16_f32 v54, v112, v113
  v_exp_f32 v115, v115
  v_exp_f32 v116, v116
  v_cvt_pk_bf16_f32 v55, v114, v115
  v_exp_f32 v117, v117
  v_mfma_f32_32x32x16_bf16 v[96:111], v[32:35], v[14:17], v[64:79]
  ds_read_b64 v[26:27], v4 offset:10240
  ds_read_b64 v[28:29], v4 offset:10496
  ds_read_b64 v[30:31], v4 offset:11264
  v_exp_f32 v118, v118
  v_cvt_pk_bf16_f32 v56, v116, v117
  v_exp_f32 v119, v119
  v_exp_f32 v120, v120
  v_mfma_f32_32x32x8_bf16 v[96:111], v[36:37], v[18:19], v[96:111]
  v_cvt_pk_bf16_f32 v57, v118, v119
  v_exp_f32 v121, v121
  v_exp_f32 v122, v122
  v_cvt_pk_bf16_f32 v58, v120, v121
  v_exp_f32 v123, v123
  v_exp_f32 v124, v124
  v_cvt_pk_bf16_f32 v59, v122, v123
  v_exp_f32 v125, v125
  v_mfma_f32_32x32x16_bf16 v[144:159], v[38:41], v[54:57], v[144:159]
  buffer_load_dwordx4 v2, s[8:11], s59 offen offset:3072 sc1 lds
  v_exp_f32 v126, v126
  v_cvt_pk_bf16_f32 v60, v124, v125
  v_exp_f32 v127, v127
  v_exp_f32 v96, v96
  v_cvt_pk_bf16_f32 v61, v126, v127
  v_exp_f32 v97, v97
  v_exp_f32 v98, v98
  v_mfma_f32_32x32x16_bf16 v[144:159], v[42:45], v[58:61], v[144:159]
  v_cvt_pk_bf16_f32 v54, v96, v97
  v_exp_f32 v99, v99
  v_exp_f32 v100, v100
  v_cvt_pk_bf16_f32 v55, v98, v99
  v_exp_f32 v101, v101
  v_mfma_f32_32x32x16_bf16 v[112:127], v[32:35], v[20:23], v[80:95]
  s_mov_b64 exec, s[38:39]
  ds_read_b128 v[38:41], v7 offset:10240
  ds_read_b128 v[42:45], v7 offset:10880
  s_mov_b64 exec, -1
  v_exp_f32 v102, v102
  v_cvt_pk_bf16_f32 v56, v100, v101
  v_exp_f32 v103, v103
  v_exp_f32 v104, v104
  v_mfma_f32_32x32x8_bf16 v[112:127], v[36:37], v[24:25], v[112:127]
  v_cvt_pk_bf16_f32 v57, v102, v103
  v_exp_f32 v105, v105
  v_exp_f32 v106, v106
  v_cvt_pk_bf16_f32 v58, v104, v105
  v_exp_f32 v107, v107
  v_exp_f32 v108, v108
  v_cvt_pk_bf16_f32 v59, v106, v107
  v_exp_f32 v109, v109
  v_mfma_f32_32x32x16_bf16 v[128:143], v[46:49], v[54:57], v[128:143]
  s_waitcnt vmcnt(2)
  v_xor_b32 v196, s100, v196
  v_xor_b32 v197, s100, v197
  v_xor_b32 v198, s100, v198
  v_xor_b32 v199, s100, v199
  v_or3_b32 v196, v196, v197, v198
  v_or_b32 v196, v196, v199
  v_cmp_ne_u32 vcc, 0, v196
  s_cbranch_vccnz L_pck_123
L_pout_122:
  v_exp_f32 v110, v110
  v_cvt_pk_bf16_f32 v60, v108, v109
  v_exp_f32 v111, v111
  v_exp_f32 v112, v112
  v_cvt_pk_bf16_f32 v61, v110, v111
  v_exp_f32 v113, v113
  v_exp_f32 v114, v114
  v_mfma_f32_32x32x16_bf16 v[128:143], v[50:53], v[58:61], v[128:143]
  s_waitcnt lgkmcnt(0)
  s_add_u32 m0, m0, 16384
  s_add_u32 s59, s59, 16384
  buffer_load_dwordx4 v2, s[8:11], s59 offen offset:0 sc1 lds
  v_cvt_pk_bf16_f32 v54, v112, v113
  v_exp_f32 v115, v115
  v_exp_f32 v116, v116
  v_cvt_pk_bf16_f32 v55, v114, v115
  v_exp_f32 v117, v117
  v_mfma_f32_32x32x16_bf16 v[96:111], v[26:29], v[14:17], v[64:79]
  ds_read_b64 v[32:33], v4 offset:12800
  ds_read_b64 v[34:35], v4 offset:13056
  ds_read_b64 v[36:37], v4 offset:13824
  v_exp_f32 v118, v118
  v_cvt_pk_bf16_f32 v56, v116, v117
  v_exp_f32 v119, v119
  v_exp_f32 v120, v120
  v_mfma_f32_32x32x8_bf16 v[96:111], v[30:31], v[18:19], v[96:111]
  v_cvt_pk_bf16_f32 v57, v118, v119
  v_exp_f32 v121, v121
  v_exp_f32 v122, v122
  v_cvt_pk_bf16_f32 v58, v120, v121
  v_exp_f32 v123, v123
  v_exp_f32 v124, v124
  v_cvt_pk_bf16_f32 v59, v122, v123
  v_exp_f32 v125, v125
  v_mfma_f32_32x32x16_bf16 v[144:159], v[46:49], v[54:57], v[144:159]
  buffer_load_dwordx4 a[0:3], v2, s[8:11], s58 offen offset:0 sc1
  v_exp_f32 v126, v126
  v_cvt_pk_bf16_f32 v60, v124, v125
  v_exp_f32 v127, v127
  v_exp_f32 v96, v96
  v_cvt_pk_bf16_f32 v61, v126, v127
  v_exp_f32 v97, v97
  v_exp_f32 v98, v98
  v_mfma_f32_32x32x16_bf16 v[144:159], v[50:53], v[58:61], v[144:159]
  buffer_load_dwordx4 a[12:15], v2, s[8:11], s58 offen offset:1024 sc1
  v_cvt_pk_bf16_f32 v54, v96, v97
  v_exp_f32 v99, v99
  v_exp_f32 v100, v100
  v_cvt_pk_bf16_f32 v55, v98, v99
  v_exp_f32 v101, v101
  v_mfma_f32_32x32x16_bf16 v[112:127], v[26:29], v[20:23], v[80:95]
  s_mov_b64 exec, s[38:39]
  ds_read_b128 v[46:49], v7 offset:12800
  ds_read_b128 v[50:53], v7 offset:13440
  s_mov_b64 exec, -1
  v_exp_f32 v102, v102
  v_cvt_pk_bf16_f32 v56, v100, v101
  v_exp_f32 v103, v103
  v_exp_f32 v104, v104
  v_mfma_f32_32x32x8_bf16 v[112:127], v[30:31], v[24:25], v[112:127]
  v_cvt_pk_bf16_f32 v57, v102, v103
  v_exp_f32 v105, v105
  v_exp_f32 v106, v106
  v_cvt_pk_bf16_f32 v58, v104, v105
  v_exp_f32 v107, v107
  v_exp_f32 v108, v108
  v_cvt_pk_bf16_f32 v59, v106, v107
  v_exp_f32 v109, v109
  v_mfma_f32_32x32x16_bf16 v[128:143], v[38:41], v[54:57], v[128:143]
  buffer_load_dwordx4 a[24:27], v2, s[8:11], s58 offen offset:2048 sc1
  v_exp_f32 v110, v110
  v_cvt_pk_bf16_f32 v60, v108, v109
  v_exp_f32 v111, v111
  v_exp_f32 v112, v112
  v_cvt_pk_bf16_f32 v61, v110, v111
  v_exp_f32 v113, v113
  v_exp_f32 v114, v114
  v_mfma_f32_32x32x16_bf16 v[128:143], v[42:45], v[58:61], v[128:143]
  s_waitcnt lgkmcnt(0)
  buffer_load_dwordx4 v2, s[8:11], s59 offen offset:1024 sc1 lds
  v_cvt_pk_bf16_f32 v54, v112, v113
  v_exp_f32 v115, v115
  v_exp_f32 v116, v116
  v_cvt_pk_bf16_f32 v55, v114, v115
  v_exp_f32 v117, v117
  v_mfma_f32_32x32x16_bf16 v[96:111], v[32:35], v[14:17], v[64:79]
  ds_read_b64 v[26:27], v4 offset:15360
  ds_read_b64 v[28:29], v4 offset:15616
  ds_read_b64 v[30:31], v4 offset:16384
  v_exp_f32 v118, v118
  v_cvt_pk_bf16_f32 v56, v116, v117
  v_exp_f32 v119, v119
  v_exp_f32 v120, v120
  v_mfma_f32_32x32x8_bf16 v[96:111], v[36:37], v[18:19], v[96:111]
  v_cvt_pk_bf16_f32 v57, v118, v119
  v_exp_f32 v121, v121
  v_exp_f32 v122, v122
  v_cvt_pk_bf16_f32 v58, v120, v121
  v_exp_f32 v123, v123
  v_exp_f32 v124, v124
  v_cvt_pk_bf16_f32 v59, v122, v123
  v_exp_f32 v125, v125
  v_mfma_f32_32x32x16_bf16 v[144:159], v[38:41], v[54:57], v[144:159]
  buffer_load_dwordx4 a[36:39], v2, s[8:11], s58 offen offset:3072 sc1
  v_exp_f32 v126, v126
  v_cvt_pk_bf16_f32 v60, v124, v125
  v_exp_f32 v127, v127
  v_exp_f32 v96, v96
  v_cvt_pk_bf16_f32 v61, v126, v127
  v_exp_f32 v97, v97
  v_exp_f32 v98, v98
  v_mfma_f32_32x32x16_bf16 v[144:159], v[42:45], v[58:61], v[144:159]
  s_add_u32 s58, s58, 4096
  buffer_load_dwordx4 a[48:51], v2, s[8:11], s58 offen offset:0 sc1
  v_cvt_pk_bf16_f32 v54, v96, v97
  v_exp_f32 v99, v99
  v_exp_f32 v100, v100
  v_cvt_pk_bf16_f32 v55, v98, v99
  v_exp_f32 v101, v101
  v_mfma_f32_32x32x16_bf16 v[112:127], v[32:35], v[20:23], v[80:95]
  s_mov_b64 exec, s[38:39]
  ds_read_b128 v[38:41], v7 offset:15360
  ds_read_b128 v[42:45], v7 offset:16000
  s_mov_b64 exec, -1
  v_exp_f32 v102, v102
  v_cvt_pk_bf16_f32 v56, v100, v101
  v_exp_f32 v103, v103
  v_exp_f32 v104, v104
  v_mfma_f32_32x32x8_bf16 v[112:127], v[36:37], v[24:25], v[112:127]
  v_cvt_pk_bf16_f32 v57, v102, v103
  v_exp_f32 v105, v105
  v_exp_f32 v106, v106
  v_cvt_pk_bf16_f32 v58, v104, v105
  v_exp_f32 v107, v107
  v_exp_f32 v108, v108
  v_cvt_pk_bf16_f32 v59, v106, v107
  v_exp_f32 v109, v109
  v_mfma_f32_32x32x16_bf16 v[128:143], v[46:49], v[54:57], v[128:143]
  buffer_load_dwordx4 a[60:63], v2, s[8:11], s58 offen offset:1024 sc1
  v_exp_f32 v110, v110
  v_cvt_pk_bf16_f32 v60, v108, v109
  v_exp_f32 v111, v111
  v_exp_f32 v112, v112
  v_cvt_pk_bf16_f32 v61, v110, v111
  v_exp_f32 v113, v113
  v_exp_f32 v114, v114
  v_mfma_f32_32x32x16_bf16 v[128:143], v[50:53], v[58:61], v[128:143]
  s_waitcnt lgkmcnt(0)
  buffer_load_dwordx4 v2, s[8:11], s59 offen offset:2048 sc1 lds
  v_cvt_pk_bf16_f32 v54, v112, v113
  v_exp_f32 v115, v115
  v_exp_f32 v116, v116
  v_cvt_pk_bf16_f32 v55, v114, v115
  v_exp_f32 v117, v117
  v_mfma_f32_32x32x16_bf16 v[96:111], v[26:29], v[14:17], v[64:79]
  ds_read_b64 v[32:33], v4 offset:17920
  ds_read_b64 v[34:35], v4 offset:18176
  ds_read_b64 v[36:37], v4 offset:18944
  v_exp_f32 v118, v118
  v_cvt_pk_bf16_f32 v56, v116, v117
  v_exp_f32 v119, v119
  v_exp_f32 v120, v120
  v_mfma_f32_32x32x8_bf16 v[96:111], v[30:31], v[18:19], v[96:111]
  v_cvt_pk_bf16_f32 v57, v118, v119
  v_exp_f32 v121, v121
  v_exp_f32 v122, v122
  v_cvt_pk_bf16_f32 v58, v120, v121
  v_exp_f32 v123, v123
  v_exp_f32 v124, v124
  v_cvt_pk_bf16_f32 v59, v122, v123
  v_exp_f32 v125, v125
  v_mfma_f32_32x32x16_bf16 v[144:159], v[46:49], v[54:57], v[144:159]
  buffer_load_dwordx4 a[72:75], v2, s[8:11], s58 offen offset:2048 sc1
  v_exp_f32 v126, v126
  v_cvt_pk_bf16_f32 v60, v124, v125
  v_exp_f32 v127, v127
  v_exp_f32 v96, v96
  v_cvt_pk_bf16_f32 v61, v126, v127
  v_exp_f32 v97, v97
  v_exp_f32 v98, v98
  v_mfma_f32_32x32x16_bf16 v[144:159], v[50:53], v[58:61], v[144:159]
  v_cvt_pk_bf16_f32 v54, v96, v97
  v_exp_f32 v99, v99
  v_exp_f32 v100, v100
  v_cvt_pk_bf16_f32 v55, v98, v99
  v_exp_f32 v101, v101
  v_mfma_f32_32x32x16_bf16 v[112:127], v[26:29], v[20:23], v[80:95]
  s_mov_b64 exec, s[38:39]
  ds_read_b128 v[46:49], v7 offset:17920
  ds_read_b128 v[50:53], v7 offset:18560
  s_mov_b64 exec, -1
  v_exp_f32 v102, v102
  v_cvt_pk_bf16_f32 v56, v100, v101
  v_exp_f32 v103, v103
  v_exp_f32 v104, v104
  v_mfma_f32_32x32x8_bf16 v[112:127], v[30:31], v[24:25], v[112:127]
  v_cvt_pk_bf16_f32 v57, v102, v103
  v_exp_f32 v105, v105
  v_exp_f32 v106, v106
  v_cvt_pk_bf16_f32 v58, v104, v105
  v_exp_f32 v107, v107
  v_exp_f32 v108, v108
  v_cvt_pk_bf16_f32 v59, v106, v107
  v_exp_f32 v109, v109
  v_mfma_f32_32x32x16_bf16 v[128:143], v[38:41], v[54:57], v[128:143]
  buffer_load_dwordx4 a[84:87], v2, s[8:11], s58 offen offset:3072 sc1
  v_exp_f32 v110, v110
  v_cvt_pk_bf16_f32 v60, v108, v109
  v_exp_f32 v111, v111
  v_exp_f32 v112, v112
  v_cvt_pk_bf16_f32 v61, v110, v111
  v_exp_f32 v113, v113
  v_exp_f32 v114, v114
  v_mfma_f32_32x32x16_bf16 v[128:143], v[42:45], v[58:61], v[128:143]
  s_waitcnt lgkmcnt(0)
  buffer_load_dwordx4 v2, s[8:11], s59 offen offset:3072 sc1 lds
  v_cvt_pk_bf16_f32 v54, v112, v113
  v_exp_f32 v115, v115
  v_exp_f32 v116, v116
  v_cvt_pk_bf16_f32 v55, v114, v115
  v_exp_f32 v117, v117
  v_mfma_f32_32x32x16_bf16 v[96:111], v[32:35], v[14:17], v[64:79]
  ds_read_b64 v[26:27], v4 offset:20480
  ds_read_b64 v[28:29], v4 offset:20736
  ds_read_b64 v[30:31], v4 offset:21504
  v_exp_f32 v118, v118
  v_cvt_pk_bf16_f32 v56, v116, v117
  v_exp_f32 v119, v119
  v_exp_f32 v120, v120
  v_mfma_f32_32x32x8_bf16 v[96:111], v[36:37], v[18:19], v[96:111]
  v_cvt_pk_bf16_f32 v57, v118, v119
  v_exp_f32 v121, v121
  v_exp_f32 v122, v122
  v_cvt_pk_bf16_f32 v58, v120, v121
  v_exp_f32 v123, v123
  v_exp_f32 v124, v124
  v_cvt_pk_bf16_f32 v59, v122, v123
  v_exp_f32 v125, v125
  v_mfma_f32_32x32x16_bf16 v[144:159], v[38:41], v[54:57], v[144:159]
  s_add_u32 s58, s58, 4096
  buffer_load_dwordx4 a[96:99], v2, s[8:11], s58 offen offset:0 sc1
  v_exp_f32 v126, v126
  v_cvt_pk_bf16_f32 v60, v124, v125
  v_exp_f32 v127, v127
  v_exp_f32 v96, v96
  v_cvt_pk_bf16_f32 v61, v126, v127
  v_exp_f32 v97, v97
  v_exp_f32 v98, v98
  v_mfma_f32_32x32x16_bf16 v[144:159], v[42:45], v[58:61], v[144:159]
  v_cvt_pk_bf16_f32 v54, v96, v97
  v_exp_f32 v99, v99
  v_exp_f32 v100, v100
  v_cvt_pk_bf16_f32 v55, v98, v99
  v_exp_f32 v101, v101
  v_mfma_f32_32x32x16_bf16 v[112:127], v[32:35], v[20:23], v[80:95]
  s_mov_b64 exec, s[38:39]
  ds_read_b128 v[38:41], v7 offset:20480
  ds_read_b128 v[42:45], v7 offset:21120
  s_mov_b64 exec, -1
  v_exp_f32 v102, v102
  v_cvt_pk_bf16_f32 v56, v100, v101
  v_exp_f32 v103, v103
  v_exp_f32 v104, v104
  v_mfma_f32_32x32x8_bf16 v[112:127], v[36:37], v[24:25], v[112:127]
  v_cvt_pk_bf16_f32 v57, v102, v103
  v_exp_f32 v105, v105
  v_exp_f32 v106, v106
  v_cvt_pk_bf16_f32 v58, v104, v105
  v_exp_f32 v107, v107
  v_exp_f32 v108, v108
  v_cvt_pk_bf16_f32 v59, v106, v107
  v_exp_f32 v109, v109
  v_mfma_f32_32x32x16_bf16 v[128:143], v[46:49], v[54:57], v[128:143]
  buffer_load_dwordx4 a[108:111], v2, s[8:11], s58 offen offset:1024 sc1
  v_exp_f32 v110, v110
  v_cvt_pk_bf16_f32 v60, v108, v109
  v_exp_f32 v111, v111
  v_exp_f32 v112, v112
  v_cvt_pk_bf16_f32 v61, v110, v111
  v_exp_f32 v113, v113
  v_exp_f32 v114, v114
  v_mfma_f32_32x32x16_bf16 v[128:143], v[50:53], v[58:61], v[128:143]
  s_waitcnt lgkmcnt(0)
  buffer_load_dwordx4 a[120:123], v2, s[8:11], s58 offen offset:2048 sc1
  v_cvt_pk_bf16_f32 v54, v112, v113
  v_exp_f32 v115, v115
  v_exp_f32 v116, v116
  v_cvt_pk_bf16_f32 v55, v114, v115
  v_exp_f32 v117, v117
  v_mfma_f32_32x32x16_bf16 v[96:111], v[26:29], v[14:17], v[64:79]
  ds_read_b64 v[32:33], v4 offset:23040
  ds_read_b64 v[34:35], v4 offset:23296
  ds_read_b64 v[36:37], v4 offset:24064
  v_exp_f32 v118, v118
  v_cvt_pk_bf16_f32 v56, v116, v117
  v_exp_f32 v119, v119
  v_exp_f32 v120, v120
  v_mfma_f32_32x32x8_bf16 v[96:111], v[30:31], v[18:19], v[96:111]
  v_cvt_pk_bf16_f32 v57, v118, v119
  v_exp_f32 v121, v121
  v_exp_f32 v122, v122
  v_cvt_pk_bf16_f32 v58, v120, v121
  v_exp_f32 v123, v123
  v_exp_f32 v124, v124
  v_cvt_pk_bf16_f32 v59, v122, v123
  v_exp_f32 v125, v125
  v_mfma_f32_32x32x16_bf16 v[144:159], v[46:49], v[54:57], v[144:159]
  buffer_load_dwordx4 a[132:135], v2, s[8:11], s58 offen offset:3072 sc1
  v_exp_f32 v126, v126
  v_cvt_pk_bf16_f32 v60, v124, v125
  v_exp_f32 v127, v127
  v_exp_f32 v96, v96
  v_cvt_pk_bf16_f32 v61, v126, v127
  v_exp_f32 v97, v97
  v_exp_f32 v98, v98
  v_mfma_f32_32x32x16_bf16 v[144:159], v[50:53], v[58:61], v[144:159]
  v_cvt_pk_bf16_f32 v54, v96, v97
  v_exp_f32 v99, v99
  v_exp_f32 v100, v100
  v_cvt_pk_bf16_f32 v55, v98, v99
  v_exp_f32 v101, v101
  v_mfma_f32_32x32x16_bf16 v[112:127], v[26:29], v[20:23], v[80:95]
  s_mov_b64 exec, s[38:39]
  ds_read_b128 v[46:49], v7 offset:23040
  ds_read_b128 v[50:53], v7 offset:23680
  s_mov_b64 exec, -1
  v_exp_f32 v102, v102
  v_cvt_pk_bf16_f32 v56, v100, v101
  v_exp_f32 v103, v103
  v_exp_f32 v104, v104
  v_mfma_f32_32x32x8_bf16 v[112:127], v[30:31], v[24:25], v[112:127]
  v_cvt_pk_bf16_f32 v57, v102, v103
  v_exp_f32 v105, v105
  v_exp_f32 v106, v106
  v_cvt_pk_bf16_f32 v58, v104, v105
  v_exp_f32 v107, v107
  v_exp_f32 v108, v108
  v_cvt_pk_bf16_f32 v59, v106, v107
  v_exp_f32 v109, v109
  v_mfma_f32_32x32x16_bf16 v[128:143], v[38:41], v[54:57], v[128:143]
  s_add_u32 s58, s58, 4096
  buffer_load_dwordx4 a[144:147], v2, s[8:11], s58 offen offset:0 sc1
  v_exp_f32 v110, v110
  v_cvt_pk_bf16_f32 v60, v108, v109
  v_exp_f32 v111, v111
  v_exp_f32 v112, v112
  v_cvt_pk_bf16_f32 v61, v110, v111
  v_exp_f32 v113, v113
  v_exp_f32 v114, v114
  v_mfma_f32_32x32x16_bf16 v[128:143], v[42:45], v[58:61], v[128:143]
  s_waitcnt lgkmcnt(0)
  v_cvt_pk_bf16_f32 v54, v112, v113
  v_exp_f32 v115, v115
  v_exp_f32 v116, v116
  v_cvt_pk_bf16_f32 v55, v114, v115
  v_exp_f32 v117, v117
  v_mfma_f32_32x32x16_bf16 v[96:111], v[32:35], v[14:17], v[64:79]
  ds_read_b64 v[26:27], v4 offset:25600
  ds_read_b64 v[28:29], v4 offset:25856
  ds_read_b64 v[30:31], v4 offset:26624
  v_exp_f32 v118, v118
  v_cvt_pk_bf16_f32 v56, v116, v117
  v_exp_f32 v119, v119
  v_exp_f32 v120, v120
  v_mfma_f32_32x32x8_bf16 v[96:111], v[36:37], v[18:19], v[96:111]
  v_cvt_pk_bf16_f32 v57, v118, v119
  v_exp_f32 v121, v121
  v_exp_f32 v122, v122
  v_cvt_pk_bf16_f32 v58, v120, v121
  v_exp_f32 v123, v123
  v_exp_f32 v124, v124
  v_cvt_pk_bf16_f32 v59, v122, v123
  v_exp_f32 v125, v125
  v_mfma_f32_32x32x16_bf16 v[144:159], v[38:41], v[54:57], v[144:159]
  buffer_load_dwordx4 a[156:159], v2, s[8:11], s58 offen offset:1024 sc1
  v_exp_f32 v126, v126
  v_cvt_pk_bf16_f32 v60, v124, v125
  v_exp_f32 v127, v127
  v_exp_f32 v96, v96
  v_cvt_pk_bf16_f32 v61, v126, v127
  v_exp_f32 v97, v97
  v_exp_f32 v98, v98
  v_mfma_f32_32x32x16_bf16 v[144:159], v[42:45], v[58:61], v[144:159]
  buffer_load_dwordx4 a[168:171], v2, s[8:11], s58 offen offset:2048 sc1
  v_cvt_pk_bf16_f32 v54, v96, v97
  v_exp_f32 v99, v99
  v_exp_f32 v100, v100
  v_cvt_pk_bf16_f32 v55, v98, v99
  v_exp_f32 v101, v101
  v_mfma_f32_32x32x16_bf16 v[112:127], v[32:35], v[20:23], v[80:95]
  s_mov_b64 exec, s[38:39]
  ds_read_b128 v[38:41], v7 offset:25600
  ds_read_b128 v[42:45], v7 offset:26240
  s_mov_b64 exec, -1
  v_exp_f32 v102, v102
  v_cvt_pk_bf16_f32 v56, v100, v101
  v_exp_f32 v103, v103
  v_exp_f32 v104, v104
  v_mfma_f32_32x32x8_bf16 v[112:127], v[36:37], v[24:25], v[112:127]
  v_cvt_pk_bf16_f32 v57, v102, v103
  v_exp_f32 v105, v105
  v_exp_f32 v106, v106
  v_cvt_pk_bf16_f32 v58, v104, v105
  v_exp_f32 v107, v107
  v_exp_f32 v108, v108
  v_cvt_pk_bf16_f32 v59, v106, v107
  v_exp_f32 v109, v109
  v_mfma_f32_32x32x16_bf16 v[128:143], v[46:49], v[54:57], v[128:143]
  buffer_load_dwordx4 a[180:183], v2, s[8:11], s58 offen offset:3072 sc1
  v_exp_f32 v110, v110
  v_cvt_pk_bf16_f32 v60, v108, v109
  v_exp_f32 v111, v111
  v_exp_f32 v112, v112
  v_cvt_pk_bf16_f32 v61, v110, v111
  v_exp_f32 v113, v113
  v_exp_f32 v114, v114
  v_mfma_f32_32x32x16_bf16 v[128:143], v[50:53], v[58:61], v[128:143]
  s_waitcnt lgkmcnt(0)
  v_cvt_pk_bf16_f32 v54, v112, v113
  v_exp_f32 v115, v115
  v_exp_f32 v116, v116
  v_cvt_pk_bf16_f32 v55, v114, v115
  v_exp_f32 v117, v117
  v_mfma_f32_32x32x16_bf16 v[96:111], v[26:29], v[14:17], v[64:79]
  ds_read_b64 v[32:33], v4 offset:28160
  ds_read_b64 v[34:35], v4 offset:28416
  ds_read_b64 v[36:37], v4 offset:29184
  v_exp_f32 v118, v118
  v_cvt_pk_bf16_f32 v56, v116, v117
  v_exp_f32 v119, v119
  v_exp_f32 v120, v120
  v_mfma_f32_32x32x8_bf16 v[96:111], v[30:31], v[18:19], v[96:111]
  v_cvt_pk_bf16_f32 v57, v118, v119
  v_exp_f32 v121, v121
  v_exp_f32 v122, v122
  v_cvt_pk_bf16_f32 v58, v120, v121
  v_exp_f32 v123, v123
  v_exp_f32 v124, v124
  v_cvt_pk_bf16_f32 v59, v122, v123
  v_exp_f32 v125, v125
  v_mfma_f32_32x32x16_bf16 v[144:159], v[46:49], v[54:57], v[144:159]
  s_add_u32 s58, s58, 4096
  buffer_load_dwordx4 a[192:195], v2, s[8:11], s58 offen offset:0 sc1
  v_exp_f32 v126, v126
  v_cvt_pk_bf16_f32 v60, v124, v125
  v_exp_f32 v127, v127
  v_exp_f32 v96, v96
  v_cvt_pk_bf16_f32 v61, v126, v127
  v_exp_f32 v97, v97
  v_exp_f32 v98, v98
  v_mfma_f32_32x32x16_bf16 v[144:159], v[50:53], v[58:61], v[144:159]
  v_cvt_pk_bf16_f32 v54, v96, v97
  v_exp_f32 v99, v99
  v_exp_f32 v100, v100
  v_cvt_pk_bf16_f32 v55, v98, v99
  v_exp_f32 v101, v101
  v_mfma_f32_32x32x16_bf16 v[112:127], v[26:29], v[20:23], v[80:95]
  s_mov_b64 exec, s[38:39]
  ds_read_b128 v[46:49], v7 offset:28160
  ds_read_b128 v[50:53], v7 offset:28800
  s_mov_b64 exec, -1
  v_exp_f32 v102, v102
  v_cvt_pk_bf16_f32 v56, v100, v101
  v_exp_f32 v103, v103
  v_exp_f32 v104, v104
  v_mfma_f32_32x32x8_bf16 v[112:127], v[30:31], v[24:25], v[112:127]
  v_cvt_pk_bf16_f32 v57, v102, v103
  v_exp_f32 v105, v105
  v_exp_f32 v106, v106
  v_cvt_pk_bf16_f32 v58, v104, v105
  v_exp_f32 v107, v107
  v_exp_f32 v108, v108
  v_cvt_pk_bf16_f32 v59, v106, v107
  v_exp_f32 v109, v109
  v_mfma_f32_32x32x16_bf16 v[128:143], v[38:41], v[54:57], v[128:143]
  buffer_load_dwordx4 a[204:207], v2, s[8:11], s58 offen offset:1024 sc1
  v_exp_f32 v110, v110
  v_cvt_pk_bf16_f32 v60, v108, v109
  v_exp_f32 v111, v111
  v_exp_f32 v112, v112
  v_cvt_pk_bf16_f32 v61, v110, v111
  v_exp_f32 v113, v113
  v_exp_f32 v114, v114
  v_mfma_f32_32x32x16_bf16 v[128:143], v[42:45], v[58:61], v[128:143]
  s_waitcnt lgkmcnt(0)
  v_cvt_pk_bf16_f32 v54, v112, v113
  v_exp_f32 v115, v115
  v_exp_f32 v116, v116
  v_cvt_pk_bf16_f32 v55, v114, v115
  v_exp_f32 v117, v117
  v_mfma_f32_32x32x16_bf16 v[96:111], v[32:35], v[14:17], v[64:79]
  ds_read_b64 v[26:27], v4 offset:30720
  ds_read_b64 v[28:29], v4 offset:30976
  ds_read_b64 v[30:31], v4 offset:31744
  v_exp_f32 v118, v118
  v_cvt_pk_bf16_f32 v56, v116, v117
  v_exp_f32 v119, v119
  v_exp_f32 v120, v120
  v_mfma_f32_32x32x8_bf16 v[96:111], v[36:37], v[18:19], v[96:111]
  v_cvt_pk_bf16_f32 v57, v118, v119
  v_exp_f32 v121, v121
  v_exp_f32 v122, v122
  v_cvt_pk_bf16_f32 v58, v120, v121
  v_exp_f32 v123, v123
  v_exp_f32 v124, v124
  v_cvt_pk_bf16_f32 v59, v122, v123
  v_exp_f32 v125, v125
  v_mfma_f32_32x32x16_bf16 v[144:159], v[38:41], v[54:57], v[144:159]
  buffer_load_dwordx4 a[216:219], v2, s[8:11], s58 offen offset:2048 sc1
  v_exp_f32 v126, v126
  v_cvt_pk_bf16_f32 v60, v124, v125
  v_exp_f32 v127, v127
  v_exp_f32 v96, v96
  v_cvt_pk_bf16_f32 v61, v126, v127
  v_exp_f32 v97, v97
  v_exp_f32 v98, v98
  v_mfma_f32_32x32x16_bf16 v[144:159], v[42:45], v[58:61], v[144:159]
  buffer_load_dwordx4 a[228:231], v2, s[8:11], s58 offen offset:3072 sc1
  v_cvt_pk_bf16_f32 v54, v96, v97
  v_exp_f32 v99, v99
  v_exp_f32 v100, v100
  v_cvt_pk_bf16_f32 v55, v98, v99
  v_exp_f32 v101, v101
  v_mfma_f32_32x32x16_bf16 v[112:127], v[32:35], v[20:23], v[80:95]
  s_mov_b64 exec, s[38:39]
  ds_read_b128 v[38:41], v7 offset:30720
  ds_read_b128 v[42:45], v7 offset:31360
  s_mov_b64 exec, -1
  v_exp_f32 v102, v102
  v_cvt_pk_bf16_f32 v56, v100, v101
  v_exp_f32 v103, v103
  v_exp_f32 v104, v104
  v_mfma_f32_32x32x8_bf16 v[112:127], v[36:37], v[24:25], v[112:127]
  v_cvt_pk_bf16_f32 v57, v102, v103
  v_exp_f32 v105, v105
  v_exp_f32 v106, v106
  v_cvt_pk_bf16_f32 v58, v104, v105
  v_exp_f32 v107, v107
  v_exp_f32 v108, v108
  v_cvt_pk_bf16_f32 v59, v106, v107
  v_exp_f32 v109, v109
  v_mfma_f32_32x32x16_bf16 v[128:143], v[46:49], v[54:57], v[128:143]
  s_add_u32 s58, s58, 4096
  buffer_load_dwordx4 a[4:7], v2, s[8:11], s58 offen offset:0 sc1
  v_exp_f32 v110, v110
  v_cvt_pk_bf16_f32 v60, v108, v109
  v_exp_f32 v111, v111
  v_exp_f32 v112, v112
  v_cvt_pk_bf16_f32 v61, v110, v111
  v_exp_f32 v113, v113
  v_exp_f32 v114, v114
  v_mfma_f32_32x32x16_bf16 v[128:143], v[50:53], v[58:61], v[128:143]
  s_waitcnt lgkmcnt(0)
  v_cvt_pk_bf16_f32 v54, v112, v113
  v_exp_f32 v115, v115
  v_exp_f32 v116, v116
  v_cvt_pk_bf16_f32 v55, v114, v115
  v_exp_f32 v117, v117
  v_mfma_f32_32x32x16_bf16 v[96:111], v[26:29], v[14:17], v[64:79]
  ds_read_b64 v[32:33], v4 offset:33280
  ds_read_b64 v[34:35], v4 offset:33536
  ds_read_b64 v[36:37], v4 offset:34304
  v_exp_f32 v118, v118
  v_cvt_pk_bf16_f32 v56, v116, v117
  v_exp_f32 v119, v119
  v_exp_f32 v120, v120
  v_mfma_f32_32x32x8_bf16 v[96:111], v[30:31], v[18:19], v[96:111]
  v_cvt_pk_bf16_f32 v57, v118, v119
  v_exp_f32 v121, v121
  v_exp_f32 v122, v122
  v_cvt_pk_bf16_f32 v58, v120, v121
  v_exp_f32 v123, v123
  v_exp_f32 v124, v124
  v_cvt_pk_bf16_f32 v59, v122, v123
  v_exp_f32 v125, v125
  v_mfma_f32_32x32x16_bf16 v[144:159], v[46:49], v[54:57], v[144:159]
  buffer_load_dwordx4 a[16:19], v2, s[8:11], s58 offen offset:1024 sc1
  v_exp_f32 v126, v126
  v_cvt_pk_bf16_f32 v60, v124, v125
  v_exp_f32 v127, v127
  v_exp_f32 v96, v96
  v_cvt_pk_bf16_f32 v61, v126, v127
  v_exp_f32 v97, v97
  v_exp_f32 v98, v98
  v_mfma_f32_32x32x16_bf16 v[144:159], v[50:53], v[58:61], v[144:159]
  v_cvt_pk_bf16_f32 v54, v96, v97
  v_exp_f32 v99, v99
  v_exp_f32 v100, v100
  v_cvt_pk_bf16_f32 v55, v98, v99
  v_exp_f32 v101, v101
  v_mfma_f32_32x32x16_bf16 v[112:127], v[26:29], v[20:23], v[80:95]
  s_mov_b64 exec, s[38:39]
  ds_read_b128 v[46:49], v7 offset:33280
  ds_read_b128 v[50:53], v7 offset:33920
  s_mov_b64 exec, -1
  v_exp_f32 v102, v102
  v_cvt_pk_bf16_f32 v56, v100, v101
  v_exp_f32 v103, v103
  v_exp_f32 v104, v104
  v_mfma_f32_32x32x8_bf16 v[112:127], v[30:31], v[24:25], v[112:127]
  v_cvt_pk_bf16_f32 v57, v102, v103
  v_exp_f32 v105, v105
  v_exp_f32 v106, v106
  v_cvt_pk_bf16_f32 v58, v104, v105
  v_exp_f32 v107, v107
  v_exp_f32 v108, v108
  v_cvt_pk_bf16_f32 v59, v106, v107
  v_exp_f32 v109, v109
  v_mfma_f32_32x32x16_bf16 v[128:143], v[38:41], v[54:57], v[128:143]
  buffer_load_dwordx4 a[28:31], v2, s[8:11], s58 offen offset:2048 sc1
  v_exp_f32 v110, v110
  v_cvt_pk_bf16_f32 v60, v108, v109
  v_exp_f32 v111, v111
  v_exp_f32 v112, v112
  v_cvt_pk_bf16_f32 v61, v110, v111
  v_exp_f32 v113, v113
  v_exp_f32 v114, v114
  v_mfma_f32_32x32x16_bf16 v[128:143], v[42:45], v[58:61], v[128:143]
  s_waitcnt lgkmcnt(0)
  buffer_load_dwordx4 a[40:43], v2, s[8:11], s58 offen offset:3072 sc1
  v_cvt_pk_bf16_f32 v54, v112, v113
  v_exp_f32 v115, v115
  v_exp_f32 v116, v116
  v_cvt_pk_bf16_f32 v55, v114, v115
  v_exp_f32 v117, v117
  v_mfma_f32_32x32x16_bf16 v[96:111], v[32:35], v[14:17], v[64:79]
  ds_read_b64 v[26:27], v4 offset:35840
  ds_read_b64 v[28:29], v4 offset:36096
  ds_read_b64 v[30:31], v4 offset:36864
  v_exp_f32 v118, v118
  v_cvt_pk_bf16_f32 v56, v116, v117
  v_exp_f32 v119, v119
  v_exp_f32 v120, v120
  v_mfma_f32_32x32x8_bf16 v[96:111], v[36:37], v[18:19], v[96:111]
  v_cvt_pk_bf16_f32 v57, v118, v119
  v_exp_f32 v121, v121
  v_exp_f32 v122, v122
  v_cvt_pk_bf16_f32 v58, v120, v121
  v_exp_f32 v123, v123
  v_exp_f32 v124, v124
  v_cvt_pk_bf16_f32 v59, v122, v123
  v_exp_f32 v125, v125
  v_mfma_f32_32x32x16_bf16 v[144:159], v[38:41], v[54:57], v[144:159]
  s_add_u32 s58, s58, 4096
  buffer_load_dwordx4 a[52:55], v2, s[8:11], s58 offen offset:0 sc1
  v_exp_f32 v126, v126
  v_cvt_pk_bf16_f32 v60, v124, v125
  v_exp_f32 v127, v127
  v_exp_f32 v96, v96
  v_cvt_pk_bf16_f32 v61, v126, v127
  v_exp_f32 v97, v97
  v_exp_f32 v98, v98
  v_mfma_f32_32x32x16_bf16 v[144:159], v[42:45], v[58:61], v[144:159]
  v_cvt_pk_bf16_f32 v54, v96, v97
  v_exp_f32 v99, v99
  v_exp_f32 v100, v100
  v_cvt_pk_bf16_f32 v55, v98, v99
  v_exp_f32 v101, v101
  v_mfma_f32_32x32x16_bf16 v[112:127], v[32:35], v[20:23], v[80:95]
  s_mov_b64 exec, s[38:39]
  ds_read_b128 v[38:41], v7 offset:35840
  ds_read_b128 v[42:45], v7 offset:36480
  s_mov_b64 exec, -1
  v_exp_f32 v102, v102
  v_cvt_pk_bf16_f32 v56, v100, v101
  v_exp_f32 v103, v103
  v_exp_f32 v104, v104
  v_mfma_f32_32x32x8_bf16 v[112:127], v[36:37], v[24:25], v[112:127]
  v_cvt_pk_bf16_f32 v57, v102, v103
  v_exp_f32 v105, v105
  v_exp_f32 v106, v106
  v_cvt_pk_bf16_f32 v58, v104, v105
  v_exp_f32 v107, v107
  v_exp_f32 v108, v108
  v_cvt_pk_bf16_f32 v59, v106, v107
  v_exp_f32 v109, v109
  v_mfma_f32_32x32x16_bf16 v[128:143], v[46:49], v[54:57], v[128:143]
  buffer_load_dwordx4 a[64:67], v2, s[8:11], s58 offen offset:1024 sc1
  v_exp_f32 v110, v110
  v_cvt_pk_bf16_f32 v60, v108, v109
  v_exp_f32 v111, v111
  v_exp_f32 v112, v112
  v_cvt_pk_bf16_f32 v61, v110, v111
  v_exp_f32 v113, v113
  v_exp_f32 v114, v114
  v_mfma_f32_32x32x16_bf16 v[128:143], v[50:53], v[58:61], v[128:143]
  s_waitcnt lgkmcnt(0)
  v_cvt_pk_bf16_f32 v54, v112, v113
  v_exp_f32 v115, v115
  v_exp_f32 v116, v116
  v_cvt_pk_bf16_f32 v55, v114, v115
  v_exp_f32 v117, v117
  v_mfma_f32_32x32x16_bf16 v[96:111], v[26:29], v[14:17], v[64:79]
  ds_read_b64 v[32:33], v4 offset:38400
  ds_read_b64 v[34:35], v4 offset:38656
  ds_read_b64 v[36:37], v4 offset:39424
  v_exp_f32 v118, v118
  v_cvt_pk_bf16_f32 v56, v116, v117
  v_exp_f32 v119, v119
  v_exp_f32 v120, v120
  v_mfma_f32_32x32x8_bf16 v[96:111], v[30:31], v[18:19], v[96:111]
  v_cvt_pk_bf16_f32 v57, v118, v119
  v_exp_f32 v121, v121
  v_exp_f32 v122, v122
  v_cvt_pk_bf16_f32 v58, v120, v121
  v_exp_f32 v123, v123
  v_exp_f32 v124, v124
  v_cvt_pk_bf16_f32 v59, v122, v123
  v_exp_f32 v125, v125
  v_mfma_f32_32x32x16_bf16 v[144:159], v[46:49], v[54:57], v[144:159]
  buffer_load_dwordx4 a[76:79], v2, s[8:11], s58 offen offset:2048 sc1
  v_exp_f32 v126, v126
  v_cvt_pk_bf16_f32 v60, v124, v125
  v_exp_f32 v127, v127
  v_exp_f32 v96, v96
  v_cvt_pk_bf16_f32 v61, v126, v127
  v_exp_f32 v97, v97
  v_exp_f32 v98, v98
  v_mfma_f32_32x32x16_bf16 v[144:159], v[50:53], v[58:61], v[144:159]
  buffer_load_dwordx4 a[88:91], v2, s[8:11], s58 offen offset:3072 sc1
  v_cvt_pk_bf16_f32 v54, v96, v97
  v_exp_f32 v99, v99
  v_exp_f32 v100, v100
  v_cvt_pk_bf16_f32 v55, v98, v99
  v_exp_f32 v101, v101
  v_mfma_f32_32x32x16_bf16 v[112:127], v[26:29], v[20:23], v[80:95]
  s_mov_b64 exec, s[38:39]
  ds_read_b128 v[46:49], v7 offset:38400
  ds_read_b128 v[50:53], v7 offset:39040
  s_mov_b64 exec, -1
  v_exp_f32 v102, v102
  v_cvt_pk_bf16_f32 v56, v100, v101
  v_exp_f32 v103, v103
  v_exp_f32 v104, v104
  v_mfma_f32_32x32x8_bf16 v[112:127], v[30:31], v[24:25], v[112:127]
  v_cvt_pk_bf16_f32 v57, v102, v103
  v_exp_f32 v105, v105
  v_exp_f32 v106, v106
  v_cvt_pk_bf16_f32 v58, v104, v105
  v_exp_f32 v107, v107
  v_exp_f32 v108, v108
  v_cvt_pk_bf16_f32 v59, v106, v107
  v_exp_f32 v109, v109
  v_mfma_f32_32x32x16_bf16 v[128:143], v[38:41], v[54:57], v[128:143]
  s_add_u32 s58, s58, 4096
  buffer_load_dwordx4 a[100:103], v2, s[8:11], s58 offen offset:0 sc1
  v_exp_f32 v110, v110
  v_cvt_pk_bf16_f32 v60, v108, v109
  v_exp_f32 v111, v111
  v_exp_f32 v112, v112
  v_cvt_pk_bf16_f32 v61, v110, v111
  v_exp_f32 v113, v113
  v_exp_f32 v114, v114
  v_mfma_f32_32x32x16_bf16 v[128:143], v[42:45], v[58:61], v[128:143]
  s_waitcnt lgkmcnt(0)
  v_cvt_pk_bf16_f32 v54, v112, v113
  v_exp_f32 v115, v115
  v_exp_f32 v116, v116
  v_cvt_pk_bf16_f32 v55, v114, v115
  v_exp_f32 v117, v117
  v_mfma_f32_32x32x16_bf16 v[96:111], v[32:35], v[14:17], v[64:79]
  ds_read_b64 v[26:27], v4 offset:40960
  ds_read_b64 v[28:29], v4 offset:41216
  ds_read_b64 v[30:31], v4 offset:41984
  v_exp_f32 v118, v118
  v_cvt_pk_bf16_f32 v56, v116, v117
  v_exp_f32 v119, v119
  v_exp_f32 v120, v120
  v_mfma_f32_32x32x8_bf16 v[96:111], v[36:37], v[18:19], v[96:111]
  v_cvt_pk_bf16_f32 v57, v118, v119
  v_exp_f32 v121, v121
  v_exp_f32 v122, v122
  v_cvt_pk_bf16_f32 v58, v120, v121
  v_exp_f32 v123, v123
  v_exp_f32 v124, v124
  v_cvt_pk_bf16_f32 v59, v122, v123
  v_exp_f32 v125, v125
  v_mfma_f32_32x32x16_bf16 v[144:159], v[38:41], v[54:57], v[144:159]
  buffer_load_dwordx4 a[112:115], v2, s[8:11], s58 offen offset:1024 sc1
  v_exp_f32 v126, v126
  v_cvt_pk_bf16_f32 v60, v124, v125
  v_exp_f32 v127, v127
  v_exp_f32 v96, v96
  v_cvt_pk_bf16_f32 v61, v126, v127
  v_exp_f32 v97, v97
  v_exp_f32 v98, v98
  v_mfma_f32_32x32x16_bf16 v[144:159], v[42:45], v[58:61], v[144:159]
  v_cvt_pk_bf16_f32 v54, v96, v97
  v_exp_f32 v99, v99
  v_exp_f32 v100, v100
  v_cvt_pk_bf16_f32 v55, v98, v99
  v_exp_f32 v101, v101
  v_mfma_f32_32x32x16_bf16 v[112:127], v[32:35], v[20:23], v[80:95]
  s_mov_b64 exec, s[38:39]
  ds_read_b128 v[38:41], v7 offset:40960
  ds_read_b128 v[42:45], v7 offset:41600
  s_mov_b64 exec, -1
  v_exp_f32 v102, v102
  v_cvt_pk_bf16_f32 v56, v100, v101
  v_exp_f32 v103, v103
  v_exp_f32 v104, v104
  v_mfma_f32_32x32x8_bf16 v[112:127], v[36:37], v[24:25], v[112:127]
  v_cvt_pk_bf16_f32 v57, v102, v103
  v_exp_f32 v105, v105
  v_exp_f32 v106, v106
  v_cvt_pk_bf16_f32 v58, v104, v105
  v_exp_f32 v107, v107
  v_exp_f32 v108, v108
  v_cvt_pk_bf16_f32 v59, v106, v107
  v_exp_f32 v109, v109
  v_mfma_f32_32x32x16_bf16 v[128:143], v[46:49], v[54:57], v[128:143]
  buffer_load_dwordx4 a[124:127], v2, s[8:11], s58 offen offset:2048 sc1
  v_exp_f32 v110, v110
  v_cvt_pk_bf16_f32 v60, v108, v109
  v_exp_f32 v111, v111
  v_exp_f32 v112, v112
  v_cvt_pk_bf16_f32 v61, v110, v111
  v_exp_f32 v113, v113
  v_exp_f32 v114, v114
  v_mfma_f32_32x32x16_bf16 v[128:143], v[50:53], v[58:61], v[128:143]
  s_waitcnt lgkmcnt(0)
  buffer_load_dwordx4 a[136:139], v2, s[8:11], s58 offen offset:3072 sc1
  v_cvt_pk_bf16_f32 v54, v112, v113
  v_exp_f32 v115, v115
  v_exp_f32 v116, v116
  v_cvt_pk_bf16_f32 v55, v114, v115
  v_exp_f32 v117, v117
  v_mfma_f32_32x32x16_bf16 v[96:111], v[26:29], v[14:17], v[64:79]
  ds_read_b64 v[32:33], v4 offset:43520
  ds_read_b64 v[34:35], v4 offset:43776
  ds_read_b64 v[36:37], v4 offset:44544
  v_exp_f32 v118, v118
  v_cvt_pk_bf16_f32 v56, v116, v117
  v_exp_f32 v119, v119
  v_exp_f32 v120, v120
  v_mfma_f32_32x32x8_bf16 v[96:111], v[30:31], v[18:19], v[96:111]
  v_cvt_pk_bf16_f32 v57, v118, v119
  v_exp_f32 v121, v121
  v_exp_f32 v122, v122
  v_cvt_pk_bf16_f32 v58, v120, v121
  v_exp_f32 v123, v123
  v_exp_f32 v124, v124
  v_cvt_pk_bf16_f32 v59, v122, v123
  v_exp_f32 v125, v125
  v_mfma_f32_32x32x16_bf16 v[144:159], v[46:49], v[54:57], v[144:159]
  s_add_u32 s58, s58, 4096
  buffer_load_dwordx4 a[148:151], v2, s[8:11], s58 offen offset:0 sc1
  v_exp_f32 v126, v126
  v_cvt_pk_bf16_f32 v60, v124, v125
  v_exp_f32 v127, v127
  v_exp_f32 v96, v96
  v_cvt_pk_bf16_f32 v61, v126, v127
  v_exp_f32 v97, v97
  v_exp_f32 v98, v98
  v_mfma_f32_32x32x16_bf16 v[144:159], v[50:53], v[58:61], v[144:159]
  v_cvt_pk_bf16_f32 v54, v96, v97
  v_exp_f32 v99, v99
  v_exp_f32 v100, v100
  v_cvt_pk_bf16_f32 v55, v98, v99
  v_exp_f32 v101, v101
  v_mfma_f32_32x32x16_bf16 v[112:127], v[26:29], v[20:23], v[80:95]
  s_mov_b64 exec, s[38:39]
  ds_read_b128 v[46:49], v7 offset:43520
  ds_read_b128 v[50:53], v7 offset:44160
  s_mov_b64 exec, -1
  v_exp_f32 v102, v102
  v_cvt_pk_bf16_f32 v56, v100, v101
  v_exp_f32 v103, v103
  v_exp_f32 v104, v104
  v_mfma_f32_32x32x8_bf16 v[112:127], v[30:31], v[24:25], v[112:127]
  v_cvt_pk_bf16_f32 v57, v102, v103
  v_exp_f32 v105, v105
  v_exp_f32 v106, v106
  v_cvt_pk_bf16_f32 v58, v104, v105
  v_exp_f32 v107, v107
  v_exp_f32 v108, v108
  v_cvt_pk_bf16_f32 v59, v106, v107
  v_exp_f32 v109, v109
  v_mfma_f32_32x32x16_bf16 v[128:143], v[38:41], v[54:57], v[128:143]
  buffer_load_dwordx4 a[160:163], v2, s[8:11], s58 offen offset:1024 sc1
  v_exp_f32 v110, v110
  v_cvt_pk_bf16_f32 v60, v108, v109
  v_exp_f32 v111, v111
  v_exp_f32 v112, v112
  v_cvt_pk_bf16_f32 v61, v110, v111
  v_exp_f32 v113, v113
  v_exp_f32 v114, v114
  v_mfma_f32_32x32x16_bf16 v[128:143], v[42:45], v[58:61], v[128:143]
  s_waitcnt lgkmcnt(0)
  v_cvt_pk_bf16_f32 v54, v112, v113
  v_exp_f32 v115, v115
  v_exp_f32 v116, v116
  v_cvt_pk_bf16_f32 v55, v114, v115
  v_exp_f32 v117, v117
  v_mfma_f32_32x32x16_bf16 v[96:111], v[32:35], v[14:17], v[64:79]
  ds_read_b64 v[26:27], v4 offset:46080
  ds_read_b64 v[28:29], v4 offset:46336
  ds_read_b64 v[30:31], v4 offset:47104
  v_exp_f32 v118, v118
  v_cvt_pk_bf16_f32 v56, v116, v117
  v_exp_f32 v119, v119
  v_exp_f32 v120, v120
  v_mfma_f32_32x32x8_bf16 v[96:111], v[36:37], v[18:19], v[96:111]
  v_cvt_pk_bf16_f32 v57, v118, v119
  v_exp_f32 v121, v121
  v_exp_f32 v122, v122
  v_cvt_pk_bf16_f32 v58, v120, v121
  v_exp_f32 v123, v123
  v_exp_f32 v124, v124
  v_cvt_pk_bf16_f32 v59, v122, v123
  v_exp_f32 v125, v125
  v_mfma_f32_32x32x16_bf16 v[144:159], v[38:41], v[54:57], v[144:159]
  buffer_load_dwordx4 a[172:175], v2, s[8:11], s58 offen offset:2048 sc1
  v_exp_f32 v126, v126
  v_cvt_pk_bf16_f32 v60, v124, v125
  v_exp_f32 v127, v127
  v_exp_f32 v96, v96
  v_cvt_pk_bf16_f32 v61, v126, v127
  v_exp_f32 v97, v97
  v_exp_f32 v98, v98
  v_mfma_f32_32x32x16_bf16 v[144:159], v[42:45], v[58:61], v[144:159]
  buffer_load_dwordx4 a[184:187], v2, s[8:11], s58 offen offset:3072 sc1
  v_cvt_pk_bf16_f32 v54, v96, v97
  v_exp_f32 v99, v99
  v_exp_f32 v100, v100
  v_cvt_pk_bf16_f32 v55, v98, v99
  v_exp_f32 v101, v101
  v_mfma_f32_32x32x16_bf16 v[112:127], v[32:35], v[20:23], v[80:95]
  s_mov_b64 exec, s[38:39]
  ds_read_b128 v[38:41], v7 offset:46080
  ds_read_b128 v[42:45], v7 offset:46720
  s_mov_b64 exec, -1
  v_exp_f32 v102, v102
  v_cvt_pk_bf16_f32 v56, v100, v101
  v_exp_f32 v103, v103
  v_exp_f32 v104, v104
  v_mfma_f32_32x32x8_bf16 v[112:127], v[36:37], v[24:25], v[112:127]
  v_cvt_pk_bf16_f32 v57, v102, v103
  v_exp_f32 v105, v105
  v_exp_f32 v106, v106
  v_cvt_pk_bf16_f32 v58, v104, v105
  v_exp_f32 v107, v107
  v_exp_f32 v108, v108
  v_cvt_pk_bf16_f32 v59, v106, v107
  v_exp_f32 v109, v109
  v_mfma_f32_32x32x16_bf16 v[128:143], v[46:49], v[54:57], v[128:143]
  s_add_u32 s58, s58, 4096
  buffer_load_dwordx4 a[196:199], v2, s[8:11], s58 offen offset:0 sc1
  v_exp_f32 v110, v110
  v_cvt_pk_bf16_f32 v60, v108, v109
  v_exp_f32 v111, v111
  v_exp_f32 v112, v112
  v_cvt_pk_bf16_f32 v61, v110, v111
  v_exp_f32 v113, v113
  v_exp_f32 v114, v114
  v_mfma_f32_32x32x16_bf16 v[128:143], v[50:53], v[58:61], v[128:143]
  s_waitcnt lgkmcnt(0)
  v_cvt_pk_bf16_f32 v54, v112, v113
  v_exp_f32 v115, v115
  v_exp_f32 v116, v116
  v_cvt_pk_bf16_f32 v55, v114, v115
  v_exp_f32 v117, v117
  v_mfma_f32_32x32x16_bf16 v[96:111], v[26:29], v[14:17], v[64:79]
  ds_read_b64 v[32:33], v4 offset:48640
  ds_read_b64 v[34:35], v4 offset:48896
  ds_read_b64 v[36:37], v4 offset:49664
  v_exp_f32 v118, v118
  v_cvt_pk_bf16_f32 v56, v116, v117
  v_exp_f32 v119, v119
  v_exp_f32 v120, v120
  v_mfma_f32_32x32x8_bf16 v[96:111], v[30:31], v[18:19], v[96:111]
  v_cvt_pk_bf16_f32 v57, v118, v119
  v_exp_f32 v121, v121
  v_exp_f32 v122, v122
  v_cvt_pk_bf16_f32 v58, v120, v121
  v_exp_f32 v123, v123
  v_exp_f32 v124, v124
  v_cvt_pk_bf16_f32 v59, v122, v123
  v_exp_f32 v125, v125
  v_mfma_f32_32x32x16_bf16 v[144:159], v[46:49], v[54:57], v[144:159]
  buffer_load_dwordx4 a[208:211], v2, s[8:11], s58 offen offset:1024 sc1
  v_exp_f32 v126, v126
  v_cvt_pk_bf16_f32 v60, v124, v125
  v_exp_f32 v127, v127
  v_exp_f32 v96, v96
  v_cvt_pk_bf16_f32 v61, v126, v127
  v_exp_f32 v97, v97
  v_exp_f32 v98, v98
  v_mfma_f32_32x32x16_bf16 v[144:159], v[50:53], v[58:61], v[144:159]
  s_waitcnt vmcnt(30)
  s_barrier
  v_cvt_pk_bf16_f32 v54, v96, v97
  v_exp_f32 v99, v99
  v_exp_f32 v100, v100
  v_cvt_pk_bf16_f32 v55, v98, v99
  v_exp_f32 v101, v101
  v_mfma_f32_32x32x16_bf16 v[112:127], v[26:29], v[20:23], v[80:95]
  s_mov_b64 exec, s[38:39]
  ds_read_b128 v[46:49], v7 offset:48640
  ds_read_b128 v[50:53], v7 offset:49280
  s_mov_b64 exec, -1
  v_exp_f32 v102, v102
  v_cvt_pk_bf16_f32 v56, v100, v101
  v_exp_f32 v103, v103
  v_exp_f32 v104, v104
  v_mfma_f32_32x32x8_bf16 v[112:127], v[30:31], v[24:25], v[112:127]
  v_cvt_pk_bf16_f32 v57, v102, v103
  v_exp_f32 v105, v105
  v_exp_f32 v106, v106
  v_cvt_pk_bf16_f32 v58, v104, v105
  v_exp_f32 v107, v107
  v_exp_f32 v108, v108
  v_cvt_pk_bf16_f32 v59, v106, v107
  v_exp_f32 v109, v109
  v_mfma_f32_32x32x16_bf16 v[128:143], v[38:41], v[54:57], v[128:143]
  buffer_load_dwordx4 a[220:223], v2, s[8:11], s58 offen offset:2048 sc1
  v_exp_f32 v110, v110
  v_cvt_pk_bf16_f32 v60, v108, v109
  v_exp_f32 v111, v111
  v_exp_f32 v112, v112
  v_cvt_pk_bf16_f32 v61, v110, v111
  v_exp_f32 v113, v113
  v_exp_f32 v114, v114
  v_mfma_f32_32x32x16_bf16 v[128:143], v[42:45], v[58:61], v[128:143]
  s_waitcnt lgkmcnt(0)
  v_cvt_pk_bf16_f32 v54, v112, v113
  v_exp_f32 v115, v115
  v_exp_f32 v116, v116
  v_cvt_pk_bf16_f32 v55, v114, v115
  v_exp_f32 v117, v117
  v_mfma_f32_32x32x16_bf16 v[96:111], v[32:35], v[14:17], v[64:79]
  ds_read_b64 v[26:27], v4 offset:51200
  ds_read_b64 v[28:29], v4 offset:51456
  ds_read_b64 v[30:31], v4 offset:52224
  v_exp_f32 v118, v118
  v_cvt_pk_bf16_f32 v56, v116, v117
  v_exp_f32 v119, v119
  v_exp_f32 v120, v120
  v_mfma_f32_32x32x8_bf16 v[96:111], v[36:37], v[18:19], v[96:111]
  v_cvt_pk_bf16_f32 v57, v118, v119
  v_exp_f32 v121, v121
  v_exp_f32 v122, v122
  v_cvt_pk_bf16_f32 v58, v120, v121
  v_exp_f32 v123, v123
  v_exp_f32 v124, v124
  v_cvt_pk_bf16_f32 v59, v122, v123
  v_exp_f32 v125, v125
  v_mfma_f32_32x32x16_bf16 v[144:159], v[38:41], v[54:57], v[144:159]
  buffer_load_dwordx4 a[232:235], v2, s[8:11], s58 offen offset:3072 sc1
  v_exp_f32 v126, v126
  v_cvt_pk_bf16_f32 v60, v124, v125
  v_exp_f32 v127, v127
  v_exp_f32 v96, v96
  v_cvt_pk_bf16_f32 v61, v126, v127
  v_exp_f32 v97, v97
  v_exp_f32 v98, v98
  v_mfma_f32_32x32x16_bf16 v[144:159], v[42:45], v[58:61], v[144:159]
  buffer_load_dwordx4 a[240:243], v2, s[8:11], s43 offen offset:0 sc1
  v_cvt_pk_bf16_f32 v54, v96, v97
  v_exp_f32 v99, v99
  v_exp_f32 v100, v100
  v_cvt_pk_bf16_f32 v55, v98, v99
  v_exp_f32 v101, v101
  v_mfma_f32_32x32x16_bf16 v[112:127], v[32:35], v[20:23], v[80:95]
  s_mov_b64 exec, s[38:39]
  ds_read_b128 v[38:41], v7 offset:51200
  ds_read_b128 v[42:45], v7 offset:51840
  s_mov_b64 exec, -1
  v_exp_f32 v102, v102
  v_cvt_pk_bf16_f32 v56, v100, v101
  v_exp_f32 v103, v103
  v_exp_f32 v104, v104
  v_mfma_f32_32x32x8_bf16 v[112:127], v[36:37], v[24:25], v[112:127]
  v_cvt_pk_bf16_f32 v57, v102, v103
  v_exp_f32 v105, v105
  v_exp_f32 v106, v106
  v_cvt_pk_bf16_f32 v58, v104, v105
  v_exp_f32 v107, v107
  v_exp_f32 v108, v108
  v_cvt_pk_bf16_f32 v59, v106, v107
  v_exp_f32 v109, v109
  v_mfma_f32_32x32x16_bf16 v[128:143], v[46:49], v[54:57], v[128:143]
  buffer_load_dwordx4 a[244:247], v2, s[8:11], s43 offen offset:1024 sc1
  v_exp_f32 v110, v110
  v_cvt_pk_bf16_f32 v60, v108, v109
  v_exp_f32 v111, v111
  v_exp_f32 v112, v112
  v_cvt_pk_bf16_f32 v61, v110, v111
  v_exp_f32 v113, v113
  v_exp_f32 v114, v114
  v_mfma_f32_32x32x16_bf16 v[128:143], v[50:53], v[58:61], v[128:143]
  s_waitcnt lgkmcnt(0)
  v_cvt_pk_bf16_f32 v54, v112, v113
  v_exp_f32 v115, v115
  v_exp_f32 v116, v116
  v_cvt_pk_bf16_f32 v55, v114, v115
  v_exp_f32 v117, v117
  v_mfma_f32_32x32x16_bf16 v[96:111], v[26:29], v[14:17], v[64:79]
  ds_read_b64 v[32:33], v4 offset:53760
  ds_read_b64 v[34:35], v4 offset:54016
  ds_read_b64 v[36:37], v4 offset:54784
  v_exp_f32 v118, v118
  v_cvt_pk_bf16_f32 v56, v116, v117
  v_exp_f32 v119, v119
  v_exp_f32 v120, v120
  v_mfma_f32_32x32x8_bf16 v[96:111], v[30:31], v[18:19], v[96:111]
  v_cvt_pk_bf16_f32 v57, v118, v119
  v_exp_f32 v121, v121
  v_exp_f32 v122, v122
  v_cvt_pk_bf16_f32 v58, v120, v121
  v_exp_f32 v123, v123
  v_exp_f32 v124, v124
  v_cvt_pk_bf16_f32 v59, v122, v123
  v_exp_f32 v125, v125
  v_mfma_f32_32x32x16_bf16 v[144:159], v[46:49], v[54:57], v[144:159]
  buffer_load_dwordx4 a[248:251], v2, s[8:11], s43 offen offset:2048 sc1
  v_exp_f32 v126, v126
  v_cvt_pk_bf16_f32 v60, v124, v125
  v_exp_f32 v127, v127
  v_exp_f32 v96, v96
  v_cvt_pk_bf16_f32 v61, v126, v127
  v_exp_f32 v97, v97
  v_exp_f32 v98, v98
  v_mfma_f32_32x32x16_bf16 v[144:159], v[50:53], v[58:61], v[144:159]
  buffer_load_dwordx4 v[244:247], v13, s[12:15], 0 offen
  v_cvt_pk_bf16_f32 v54, v96, v97
  v_exp_f32 v99, v99
  v_exp_f32 v100, v100
  v_cvt_pk_bf16_f32 v55, v98, v99
  v_exp_f32 v101, v101
  v_mfma_f32_32x32x16_bf16 v[112:127], v[26:29], v[20:23], v[80:95]
  s_mov_b64 exec, s[38:39]
  ds_read_b128 v[46:49], v7 offset:53760
  ds_read_b128 v[50:53], v7 offset:54400
  s_mov_b64 exec, -1
  v_exp_f32 v102, v102
  v_cvt_pk_bf16_f32 v56, v100, v101
  v_exp_f32 v103, v103
  v_exp_f32 v104, v104
  v_mfma_f32_32x32x8_bf16 v[112:127], v[30:31], v[24:25], v[112:127]
  v_cvt_pk_bf16_f32 v57, v102, v103
  v_exp_f32 v105, v105
  v_exp_f32 v106, v106
  v_cvt_pk_bf16_f32 v58, v104, v105
  v_exp_f32 v107, v107
  v_exp_f32 v108, v108
  v_cvt_pk_bf16_f32 v59, v106, v107
  v_exp_f32 v109, v109
  v_mfma_f32_32x32x16_bf16 v[128:143], v[38:41], v[54:57], v[128:143]
  buffer_load_dwordx4 a[252:255], v2, s[8:11], s43 offen offset:3072 sc1
  v_exp_f32 v110, v110
  v_cvt_pk_bf16_f32 v60, v108, v109
  v_exp_f32 v111, v111
  v_exp_f32 v112, v112
  v_cvt_pk_bf16_f32 v61, v110, v111
  v_exp_f32 v113, v113
  v_exp_f32 v114, v114
  v_mfma_f32_32x32x16_bf16 v[128:143], v[42:45], v[58:61], v[128:143]
  s_waitcnt lgkmcnt(0)
  s_add_u32 s43, s43, 4096
  buffer_load_dwordx4 v[160:163], v2, s[8:11], s43 offen offset:0 sc1
  v_cvt_pk_bf16_f32 v54, v112, v113
  v_exp_f32 v115, v115
  v_exp_f32 v116, v116
  v_cvt_pk_bf16_f32 v55, v114, v115
  v_exp_f32 v117, v117
  v_mfma_f32_32x32x16_bf16 v[96:111], v[32:35], v[14:17], v[64:79]
  ds_read_b64 v[26:27], v4 offset:56320
  ds_read_b64 v[28:29], v4 offset:56576
  ds_read_b64 v[30:31], v4 offset:57344
  v_exp_f32 v118, v118
  v_cvt_pk_bf16_f32 v56, v116, v117
  v_exp_f32 v119, v119
  v_exp_f32 v120, v120
  v_mfma_f32_32x32x8_bf16 v[96:111], v[36:37], v[18:19], v[96:111]
  v_cvt_pk_bf16_f32 v57, v118, v119
  v_exp_f32 v121, v121
  v_exp_f32 v122, v122
  v_cvt_pk_bf16_f32 v58, v120, v121
  v_exp_f32 v123, v123
  v_exp_f32 v124, v124
  v_cvt_pk_bf16_f32 v59, v122, v123
  v_exp_f32 v125, v125
  v_mfma_f32_32x32x16_bf16 v[144:159], v[38:41], v[54:57], v[144:159]
  buffer_load_dwordx4 v[164:167], v2, s[8:11], s43 offen offset:1024 sc1
  v_exp_f32 v126, v126
  v_cvt_pk_bf16_f32 v60, v124, v125
  v_exp_f32 v127, v127
  v_exp_f32 v96, v96
  v_cvt_pk_bf16_f32 v61, v126, v127
  v_exp_f32 v97, v97
  v_exp_f32 v98, v98
  v_mfma_f32_32x32x16_bf16 v[144:159], v[42:45], v[58:61], v[144:159]
  buffer_load_dwordx4 v[248:251], v13, s[12:15], 0 offen offset:16
  v_cvt_pk_bf16_f32 v54, v96, v97
  v_exp_f32 v99, v99
  v_exp_f32 v100, v100
  v_cvt_pk_bf16_f32 v55, v98, v99
  v_exp_f32 v101, v101
  v_mfma_f32_32x32x16_bf16 v[112:127], v[32:35], v[20:23], v[80:95]
  s_mov_b64 exec, s[38:39]
  ds_read_b128 v[38:41], v7 offset:56320
  ds_read_b128 v[42:45], v7 offset:56960
  s_mov_b64 exec, -1
  v_exp_f32 v102, v102
  v_cvt_pk_bf16_f32 v56, v100, v101
  v_exp_f32 v103, v103
  v_exp_f32 v104, v104
  v_mfma_f32_32x32x8_bf16 v[112:127], v[36:37], v[24:25], v[112:127]
  v_cvt_pk_bf16_f32 v57, v102, v103
  v_exp_f32 v105, v105
  v_exp_f32 v106, v106
  v_cvt_pk_bf16_f32 v58, v104, v105
  v_exp_f32 v107, v107
  v_exp_f32 v108, v108
  v_cvt_pk_bf16_f32 v59, v106, v107
  v_exp_f32 v109, v109
  v_mfma_f32_32x32x16_bf16 v[128:143], v[46:49], v[54:57], v[128:143]
  buffer_load_dwordx4 v[168:171], v2, s[8:11], s43 offen offset:2048 sc1
  v_exp_f32 v110, v110
  v_cvt_pk_bf16_f32 v60, v108, v109
  v_exp_f32 v111, v111
  v_exp_f32 v112, v112
  v_cvt_pk_bf16_f32 v61, v110, v111
  v_exp_f32 v113, v113
  v_exp_f32 v114, v114
  v_mfma_f32_32x32x16_bf16 v[128:143], v[50:53], v[58:61], v[128:143]
  s_waitcnt lgkmcnt(0)
  v_cvt_pk_bf16_f32 v54, v112, v113
  v_exp_f32 v115, v115
  v_exp_f32 v116, v116
  v_cvt_pk_bf16_f32 v55, v114, v115
  v_exp_f32 v117, v117
  v_mfma_f32_32x32x16_bf16 v[96:111], v[26:29], v[14:17], v[64:79]
  ds_read_b64 v[32:33], v4 offset:58880
  ds_read_b64 v[34:35], v4 offset:59136
  ds_read_b64 v[36:37], v4 offset:59904
  v_exp_f32 v118, v118
  v_cvt_pk_bf16_f32 v56, v116, v117
  v_exp_f32 v119, v119
  v_exp_f32 v120, v120
  v_mfma_f32_32x32x8_bf16 v[96:111], v[30:31], v[18:19], v[96:111]
  v_cvt_pk_bf16_f32 v57, v118, v119
  v_exp_f32 v121, v121
  v_exp_f32 v122, v122
  v_cvt_pk_bf16_f32 v58, v120, v121
  v_exp_f32 v123, v123
  v_exp_f32 v124, v124
  v_cvt_pk_bf16_f32 v59, v122, v123
  v_exp_f32 v125, v125
  v_mfma_f32_32x32x16_bf16 v[144:159], v[46:49], v[54:57], v[144:159]
  buffer_load_dwordx4 v[172:175], v2, s[8:11], s43 offen offset:3072 sc1
  v_exp_f32 v126, v126
  v_cvt_pk_bf16_f32 v60, v124, v125
  v_exp_f32 v127, v127
  v_exp_f32 v96, v96
  v_cvt_pk_bf16_f32 v61, v126, v127
  v_exp_f32 v97, v97
  v_exp_f32 v98, v98
  v_mfma_f32_32x32x16_bf16 v[144:159], v[50:53], v[58:61], v[144:159]
  buffer_load_dwordx2 v[252:253], v13, s[12:15], 0 offen offset:32
  v_cvt_pk_bf16_f32 v54, v96, v97
  v_exp_f32 v99, v99
  v_exp_f32 v100, v100
  v_cvt_pk_bf16_f32 v55, v98, v99
  v_exp_f32 v101, v101
  v_mfma_f32_32x32x16_bf16 v[112:127], v[26:29], v[20:23], v[80:95]
  s_mov_b64 exec, s[38:39]
  ds_read_b128 v[46:49], v7 offset:58880
  ds_read_b128 v[50:53], v7 offset:59520
  s_mov_b64 exec, -1
  v_exp_f32 v102, v102
  v_cvt_pk_bf16_f32 v56, v100, v101
  v_exp_f32 v103, v103
  v_exp_f32 v104, v104
  v_mfma_f32_32x32x8_bf16 v[112:127], v[30:31], v[24:25], v[112:127]
  v_cvt_pk_bf16_f32 v57, v102, v103
  v_exp_f32 v105, v105
  v_exp_f32 v106, v106
  v_cvt_pk_bf16_f32 v58, v104, v105
  v_exp_f32 v107, v107
  v_exp_f32 v108, v108
  v_cvt_pk_bf16_f32 v59, v106, v107
  v_exp_f32 v109, v109
  v_mfma_f32_32x32x16_bf16 v[128:143], v[38:41], v[54:57], v[128:143]
  s_add_u32 s43, s43, 4096
  buffer_load_dwordx4 v[176:179], v2, s[8:11], s43 offen offset:0 sc1
  v_exp_f32 v110, v110
  v_cvt_pk_bf16_f32 v60, v108, v109
  v_exp_f32 v111, v111
  v_exp_f32 v112, v112
  v_cvt_pk_bf16_f32 v61, v110, v111
  v_exp_f32 v113, v113
  v_exp_f32 v114, v114
  v_mfma_f32_32x32x16_bf16 v[128:143], v[42:45], v[58:61], v[128:143]
  s_waitcnt lgkmcnt(0)
  buffer_load_dwordx4 v[180:183], v2, s[8:11], s43 offen offset:1024 sc1
  v_cvt_pk_bf16_f32 v54, v112, v113
  v_exp_f32 v115, v115
  v_exp_f32 v116, v116
  v_cvt_pk_bf16_f32 v55, v114, v115
  v_exp_f32 v117, v117
  v_mfma_f32_32x32x16_bf16 v[96:111], v[32:35], v[14:17], v[64:79]
  ds_read_b64 v[26:27], v5 offset:0
  ds_read_b64 v[28:29], v5 offset:256
  ds_read_b64 v[30:31], v5 offset:1024
  v_exp_f32 v118, v118
  v_cvt_pk_bf16_f32 v56, v116, v117
  v_exp_f32 v119, v119
  v_exp_f32 v120, v120
  v_mfma_f32_32x32x8_bf16 v[96:111], v[36:37], v[18:19], v[96:111]
  v_cvt_pk_bf16_f32 v57, v118, v119
  v_exp_f32 v121, v121
  v_exp_f32 v122, v122
  v_cvt_pk_bf16_f32 v58, v120, v121
  v_exp_f32 v123, v123
  v_exp_f32 v124, v124
  v_cvt_pk_bf16_f32 v59, v122, v123
  v_exp_f32 v125, v125
  v_mfma_f32_32x32x16_bf16 v[144:159], v[38:41], v[54:57], v[144:159]
  buffer_load_dwordx4 v[184:187], v2, s[8:11], s43 offen offset:2048 sc1
  v_exp_f32 v126, v126
  v_cvt_pk_bf16_f32 v60, v124, v125
  v_exp_f32 v127, v127
  v_exp_f32 v96, v96
  v_cvt_pk_bf16_f32 v61, v126, v127
  v_exp_f32 v97, v97
  v_exp_f32 v98, v98
  v_mfma_f32_32x32x16_bf16 v[144:159], v[42:45], v[58:61], v[144:159]
  buffer_load_dword v254, v62, s[16:19], s60 offen offset:0 sc1
  v_cvt_pk_bf16_f32 v54, v96, v97
  v_exp_f32 v99, v99
  v_exp_f32 v100, v100
  v_cvt_pk_bf16_f32 v55, v98, v99
  v_exp_f32 v101, v101
  v_mfma_f32_32x32x16_bf16 v[112:127], v[32:35], v[20:23], v[80:95]
  s_mov_b64 exec, s[38:39]
  ds_read_b128 v[38:41], v8 offset:0
  ds_read_b128 v[42:45], v8 offset:640
  s_mov_b64 exec, -1
  v_exp_f32 v102, v102
  v_cvt_pk_bf16_f32 v56, v100, v101
  v_exp_f32 v103, v103
  v_exp_f32 v104, v104
  v_mfma_f32_32x32x8_bf16 v[112:127], v[36:37], v[24:25], v[112:127]
  v_cvt_pk_bf16_f32 v57, v102, v103
  v_exp_f32 v105, v105
  v_exp_f32 v106, v106
  v_cvt_pk_bf16_f32 v58, v104, v105
  v_exp_f32 v107, v107
  v_exp_f32 v108, v108
  v_cvt_pk_bf16_f32 v59, v106, v107
  v_exp_f32 v109, v109
  v_mfma_f32_32x32x16_bf16 v[128:143], v[46:49], v[54:57], v[128:143]
  buffer_load_dwordx4 v[188:191], v2, s[8:11], s43 offen offset:3072 sc1
  v_exp_f32 v110, v110
  v_cvt_pk_bf16_f32 v60, v108, v109
  v_exp_f32 v111, v111
  v_exp_f32 v112, v112
  v_cvt_pk_bf16_f32 v61, v110, v111
  v_exp_f32 v113, v113
  v_exp_f32 v114, v114
  v_mfma_f32_32x32x16_bf16 v[128:143], v[50:53], v[58:61], v[128:143]
  s_waitcnt lgkmcnt(0)
  s_add_u32 s43, s43, 4096
  buffer_load_dwordx4 v[192:195], v2, s[8:11], s43 offen offset:0 sc1
  v_cvt_pk_bf16_f32 v54, v112, v113
  v_exp_f32 v115, v115
  v_exp_f32 v116, v116
  v_cvt_pk_bf16_f32 v55, v114, v115
  v_exp_f32 v117, v117
  v_mfma_f32_32x32x16_bf16 v[96:111], v[26:29], v[14:17], v[64:79]
  ds_read_b64 v[32:33], v5 offset:2560
  ds_read_b64 v[34:35], v5 offset:2816
  ds_read_b64 v[36:37], v5 offset:3584
  v_exp_f32 v118, v118
  v_cvt_pk_bf16_f32 v56, v116, v117
  v_exp_f32 v119, v119
  v_exp_f32 v120, v120
  v_mfma_f32_32x32x8_bf16 v[96:111], v[30:31], v[18:19], v[96:111]
  v_cvt_pk_bf16_f32 v57, v118, v119
  v_exp_f32 v121, v121
  v_exp_f32 v122, v122
  v_cvt_pk_bf16_f32 v58, v120, v121
  v_exp_f32 v123, v123
  v_exp_f32 v124, v124
  v_cvt_pk_bf16_f32 v59, v122, v123
  v_exp_f32 v125, v125
  v_mfma_f32_32x32x16_bf16 v[144:159], v[46:49], v[54:57], v[144:159]
  buffer_load_dwordx4 v[196:199], v2, s[8:11], s43 offen offset:1024 sc1
  v_exp_f32 v126, v126
  v_cvt_pk_bf16_f32 v60, v124, v125
  v_exp_f32 v127, v127
  v_exp_f32 v96, v96
  v_cvt_pk_bf16_f32 v61, v126, v127
  v_exp_f32 v97, v97
  v_exp_f32 v98, v98
  v_mfma_f32_32x32x16_bf16 v[144:159], v[50:53], v[58:61], v[144:159]
  buffer_load_dword v254, v12, s[8:11], s62 offen offset:0 sc1
  v_cvt_pk_bf16_f32 v54, v96, v97
  v_exp_f32 v99, v99
  v_exp_f32 v100, v100
  v_cvt_pk_bf16_f32 v55, v98, v99
  v_exp_f32 v101, v101
  v_mfma_f32_32x32x16_bf16 v[112:127], v[26:29], v[20:23], v[80:95]
  s_mov_b64 exec, s[38:39]
  ds_read_b128 v[46:49], v8 offset:2560
  ds_read_b128 v[50:53], v8 offset:3200
  s_mov_b64 exec, -1
  v_exp_f32 v102, v102
  v_cvt_pk_bf16_f32 v56, v100, v101
  v_exp_f32 v103, v103
  v_exp_f32 v104, v104
  v_mfma_f32_32x32x8_bf16 v[112:127], v[30:31], v[24:25], v[112:127]
  v_cvt_pk_bf16_f32 v57, v102, v103
  v_exp_f32 v105, v105
  v_exp_f32 v106, v106
  v_cvt_pk_bf16_f32 v58, v104, v105
  v_exp_f32 v107, v107
  v_exp_f32 v108, v108
  v_cvt_pk_bf16_f32 v59, v106, v107
  v_exp_f32 v109, v109
  v_mfma_f32_32x32x16_bf16 v[128:143], v[38:41], v[54:57], v[128:143]
  buffer_load_dwordx4 v[200:203], v2, s[8:11], s43 offen offset:2048 sc1
  v_exp_f32 v110, v110
  v_cvt_pk_bf16_f32 v60, v108, v109
  v_exp_f32 v111, v111
  v_exp_f32 v112, v112
  v_cvt_pk_bf16_f32 v61, v110, v111
  v_exp_f32 v113, v113
  v_exp_f32 v114, v114
  v_mfma_f32_32x32x16_bf16 v[128:143], v[42:45], v[58:61], v[128:143]
  s_waitcnt lgkmcnt(0)
  v_cvt_pk_bf16_f32 v54, v112, v113
  v_exp_f32 v115, v115
  v_exp_f32 v116, v116
  v_cvt_pk_bf16_f32 v55, v114, v115
  v_exp_f32 v117, v117
  v_mfma_f32_32x32x16_bf16 v[96:111], v[32:35], v[14:17], v[64:79]
  ds_read_b64 v[26:27], v5 offset:5120
  ds_read_b64 v[28:29], v5 offset:5376
  ds_read_b64 v[30:31], v5 offset:6144
  v_exp_f32 v118, v118
  v_cvt_pk_bf16_f32 v56, v116, v117
  v_exp_f32 v119, v119
  v_exp_f32 v120, v120
  v_mfma_f32_32x32x8_bf16 v[96:111], v[36:37], v[18:19], v[96:111]
  v_cvt_pk_bf16_f32 v57, v118, v119
  v_exp_f32 v121, v121
  v_exp_f32 v122, v122
  v_cvt_pk_bf16_f32 v58, v120, v121
  v_exp_f32 v123, v123
  v_exp_f32 v124, v124
  v_cvt_pk_bf16_f32 v59, v122, v123
  v_exp_f32 v125, v125
  v_mfma_f32_32x32x16_bf16 v[144:159], v[38:41], v[54:57], v[144:159]
  buffer_load_dwordx4 v[204:207], v2, s[8:11], s43 offen offset:3072 sc1
  v_exp_f32 v126, v126
  v_cvt_pk_bf16_f32 v60, v124, v125
  v_exp_f32 v127, v127
  v_exp_f32 v96, v96
  v_cvt_pk_bf16_f32 v61, v126, v127
  v_exp_f32 v97, v97
  v_exp_f32 v98, v98
  v_mfma_f32_32x32x16_bf16 v[144:159], v[42:45], v[58:61], v[144:159]
  s_add_u32 s43, s43, 4096
  buffer_load_dwordx4 v[208:211], v2, s[8:11], s43 offen offset:0 sc1
  v_cvt_pk_bf16_f32 v54, v96, v97
  v_exp_f32 v99, v99
  v_exp_f32 v100, v100
  v_cvt_pk_bf16_f32 v55, v98, v99
  v_exp_f32 v101, v101
  v_mfma_f32_32x32x16_bf16 v[112:127], v[32:35], v[20:23], v[80:95]
  s_mov_b64 exec, s[38:39]
  ds_read_b128 v[38:41], v8 offset:5120
  ds_read_b128 v[42:45], v8 offset:5760
  s_mov_b64 exec, -1
  v_exp_f32 v102, v102
  v_cvt_pk_bf16_f32 v56, v100, v101
  v_exp_f32 v103, v103
  v_exp_f32 v104, v104
  v_mfma_f32_32x32x8_bf16 v[112:127], v[36:37], v[24:25], v[112:127]
  v_cvt_pk_bf16_f32 v57, v102, v103
  v_exp_f32 v105, v105
  v_exp_f32 v106, v106
  v_cvt_pk_bf16_f32 v58, v104, v105
  v_exp_f32 v107, v107
  v_exp_f32 v108, v108
  v_cvt_pk_bf16_f32 v59, v106, v107
  v_exp_f32 v109, v109
  v_mfma_f32_32x32x16_bf16 v[128:143], v[46:49], v[54:57], v[128:143]
  buffer_load_dwordx4 v[212:215], v2, s[8:11], s43 offen offset:1024 sc1
  v_exp_f32 v110, v110
  v_cvt_pk_bf16_f32 v60, v108, v109
  v_exp_f32 v111, v111
  v_exp_f32 v112, v112
  v_cvt_pk_bf16_f32 v61, v110, v111
  v_exp_f32 v113, v113
  v_exp_f32 v114, v114
  v_mfma_f32_32x32x16_bf16 v[128:143], v[50:53], v[58:61], v[128:143]
  s_waitcnt lgkmcnt(0)
  v_cvt_pk_bf16_f32 v54, v112, v113
  v_exp_f32 v115, v115
  v_exp_f32 v116, v116
  v_cvt_pk_bf16_f32 v55, v114, v115
  v_exp_f32 v117, v117
  v_mfma_f32_32x32x16_bf16 v[96:111], v[26:29], v[14:17], v[64:79]
  ds_read_b64 v[32:33], v5 offset:7680
  ds_read_b64 v[34:35], v5 offset:7936
  ds_read_b64 v[36:37], v5 offset:8704
  v_exp_f32 v118, v118
  v_cvt_pk_bf16_f32 v56, v116, v117
  v_exp_f32 v119, v119
  v_exp_f32 v120, v120
  v_mfma_f32_32x32x8_bf16 v[96:111], v[30:31], v[18:19], v[96:111]
  v_cvt_pk_bf16_f32 v57, v118, v119
  v_exp_f32 v121, v121
  v_exp_f32 v122, v122
  v_cvt_pk_bf16_f32 v58, v120, v121
  v_exp_f32 v123, v123
  v_exp_f32 v124, v124
  v_cvt_pk_bf16_f32 v59, v122, v123
  v_exp_f32 v125, v125
  v_mfma_f32_32x32x16_bf16 v[144:159], v[46:49], v[54:57], v[144:159]
  buffer_load_dwordx4 v[216:219], v2, s[8:11], s43 offen offset:2048 sc1
  v_exp_f32 v126, v126
  v_cvt_pk_bf16_f32 v60, v124, v125
  v_exp_f32 v127, v127
  v_exp_f32 v96, v96
  v_cvt_pk_bf16_f32 v61, v126, v127
  v_exp_f32 v97, v97
  v_exp_f32 v98, v98
  v_mfma_f32_32x32x16_bf16 v[144:159], v[50:53], v[58:61], v[144:159]
  v_cvt_pk_bf16_f32 v54, v96, v97
  v_exp_f32 v99, v99
  v_exp_f32 v100, v100
  v_cvt_pk_bf16_f32 v55, v98, v99
  v_exp_f32 v101, v101
  v_mfma_f32_32x32x16_bf16 v[112:127], v[26:29], v[20:23], v[80:95]
  s_mov_b64 exec, s[38:39]
  ds_read_b128 v[46:49], v8 offset:7680
  ds_read_b128 v[50:53], v8 offset:8320
  s_mov_b64 exec, -1
  v_exp_f32 v102, v102
  v_cvt_pk_bf16_f32 v56, v100, v101
  v_exp_f32 v103, v103
  v_exp_f32 v104, v104
  v_mfma_f32_32x32x8_bf16 v[112:127], v[30:31], v[24:25], v[112:127]
  v_cvt_pk_bf16_f32 v57, v102, v103
  v_exp_f32 v105, v105
  v_exp_f32 v106, v106
  v_cvt_pk_bf16_f32 v58, v104, v105
  v_exp_f32 v107, v107
  v_exp_f32 v108, v108
  v_cvt_pk_bf16_f32 v59, v106, v107
  v_exp_f32 v109, v109
  v_mfma_f32_32x32x16_bf16 v[128:143], v[38:41], v[54:57], v[128:143]
  buffer_load_dwordx4 v[220:223], v2, s[8:11], s43 offen offset:3072 sc1
  v_exp_f32 v110, v110
  v_cvt_pk_bf16_f32 v60, v108, v109
  v_exp_f32 v111, v111
  v_exp_f32 v112, v112
  v_cvt_pk_bf16_f32 v61, v110, v111
  v_exp_f32 v113, v113
  v_exp_f32 v114, v114
  v_mfma_f32_32x32x16_bf16 v[128:143], v[42:45], v[58:61], v[128:143]
  s_waitcnt lgkmcnt(0)
  v_cvt_pk_bf16_f32 v54, v112, v113
  v_exp_f32 v115, v115
  v_exp_f32 v116, v116
  v_cvt_pk_bf16_f32 v55, v114, v115
  v_exp_f32 v117, v117
  v_mfma_f32_32x32x16_bf16 v[96:111], v[32:35], v[14:17], v[64:79]
  ds_read_b64 v[26:27], v5 offset:10240
  ds_read_b64 v[28:29], v5 offset:10496
  ds_read_b64 v[30:31], v5 offset:11264
  v_exp_f32 v118, v118
  v_cvt_pk_bf16_f32 v56, v116, v117
  v_exp_f32 v119, v119
  v_exp_f32 v120, v120
  v_mfma_f32_32x32x8_bf16 v[96:111], v[36:37], v[18:19], v[96:111]
  v_cvt_pk_bf16_f32 v57, v118, v119
  v_exp_f32 v121, v121
  v_exp_f32 v122, v122
  v_cvt_pk_bf16_f32 v58, v120, v121
  v_exp_f32 v123, v123
  v_exp_f32 v124, v124
  v_cvt_pk_bf16_f32 v59, v122, v123
  v_exp_f32 v125, v125
  v_mfma_f32_32x32x16_bf16 v[144:159], v[38:41], v[54:57], v[144:159]
  s_add_u32 s43, s43, 4096
  buffer_load_dwordx4 v[224:227], v2, s[8:11], s43 offen offset:0 sc1
  v_exp_f32 v126, v126
  v_cvt_pk_bf16_f32 v60, v124, v125
  v_exp_f32 v127, v127
  v_exp_f32 v96, v96
  v_cvt_pk_bf16_f32 v61, v126, v127
  v_exp_f32 v97, v97
  v_exp_f32 v98, v98
  v_mfma_f32_32x32x16_bf16 v[144:159], v[42:45], v[58:61], v[144:159]
  v_cvt_pk_bf16_f32 v54, v96, v97
  v_exp_f32 v99, v99
  v_exp_f32 v100, v100
  v_cvt_pk_bf16_f32 v55, v98, v99
  v_exp_f32 v101, v101
  v_mfma_f32_32x32x16_bf16 v[112:127], v[32:35], v[20:23], v[80:95]
  s_mov_b64 exec, s[38:39]
  ds_read_b128 v[38:41], v8 offset:10240
  ds_read_b128 v[42:45], v8 offset:10880
  s_mov_b64 exec, -1
  v_exp_f32 v102, v102
  v_cvt_pk_bf16_f32 v56, v100, v101
  v_exp_f32 v103, v103
  v_exp_f32 v104, v104
  v_mfma_f32_32x32x8_bf16 v[112:127], v[36:37], v[24:25], v[112:127]
  v_cvt_pk_bf16_f32 v57, v102, v103
  v_exp_f32 v105, v105
  v_exp_f32 v106, v106
  v_cvt_pk_bf16_f32 v58, v104, v105
  v_exp_f32 v107, v107
  v_exp_f32 v108, v108
  v_cvt_pk_bf16_f32 v59, v106, v107
  v_exp_f32 v109, v109
  v_mfma_f32_32x32x16_bf16 v[128:143], v[46:49], v[54:57], v[128:143]
  buffer_load_dword v254, v63, s[8:11], s61 offen offset:0 sc1
  v_exp_f32 v110, v110
  v_cvt_pk_bf16_f32 v60, v108, v109
  v_exp_f32 v111, v111
  v_exp_f32 v112, v112
  v_cvt_pk_bf16_f32 v61, v110, v111
  v_exp_f32 v113, v113
  v_exp_f32 v114, v114
  v_mfma_f32_32x32x16_bf16 v[128:143], v[50:53], v[58:61], v[128:143]
  s_waitcnt lgkmcnt(0)
  v_cvt_pk_bf16_f32 v54, v112, v113
  v_exp_f32 v115, v115
  v_exp_f32 v116, v116
  v_cvt_pk_bf16_f32 v55, v114, v115
  v_exp_f32 v117, v117
  v_mfma_f32_32x32x16_bf16 v[96:111], v[26:29], v[14:17], v[64:79]
  ds_read_b64 v[32:33], v5 offset:12800
  ds_read_b64 v[34:35], v5 offset:13056
  ds_read_b64 v[36:37], v5 offset:13824
  v_exp_f32 v118, v118
  v_cvt_pk_bf16_f32 v56, v116, v117
  v_exp_f32 v119, v119
  v_exp_f32 v120, v120
  v_mfma_f32_32x32x8_bf16 v[96:111], v[30:31], v[18:19], v[96:111]
  v_cvt_pk_bf16_f32 v57, v118, v119
  v_exp_f32 v121, v121
  v_exp_f32 v122, v122
  v_cvt_pk_bf16_f32 v58, v120, v121
  v_exp_f32 v123, v123
  v_exp_f32 v124, v124
  v_cvt_pk_bf16_f32 v59, v122, v123
  v_exp_f32 v125, v125
  v_mfma_f32_32x32x16_bf16 v[144:159], v[46:49], v[54:57], v[144:159]
  buffer_load_dwordx4 v[228:231], v2, s[8:11], s43 offen offset:1024 sc1
  v_exp_f32 v126, v126
  v_cvt_pk_bf16_f32 v60, v124, v125
  v_exp_f32 v127, v127
  v_exp_f32 v96, v96
  v_cvt_pk_bf16_f32 v61, v126, v127
  v_exp_f32 v97, v97
  v_exp_f32 v98, v98
  v_mfma_f32_32x32x16_bf16 v[144:159], v[50:53], v[58:61], v[144:159]
  v_cvt_pk_bf16_f32 v54, v96, v97
  v_exp_f32 v99, v99
  v_exp_f32 v100, v100
  v_cvt_pk_bf16_f32 v55, v98, v99
  v_exp_f32 v101, v101
  v_mfma_f32_32x32x16_bf16 v[112:127], v[26:29], v[20:23], v[80:95]
  s_mov_b64 exec, s[38:39]
  ds_read_b128 v[46:49], v8 offset:12800
  ds_read_b128 v[50:53], v8 offset:13440
  s_mov_b64 exec, -1
  v_exp_f32 v102, v102
  v_cvt_pk_bf16_f32 v56, v100, v101
  v_exp_f32 v103, v103
  v_exp_f32 v104, v104
  v_mfma_f32_32x32x8_bf16 v[112:127], v[30:31], v[24:25], v[112:127]
  v_cvt_pk_bf16_f32 v57, v102, v103
  v_exp_f32 v105, v105
  v_exp_f32 v106, v106
  v_cvt_pk_bf16_f32 v58, v104, v105
  v_exp_f32 v107, v107
  v_exp_f32 v108, v108
  v_cvt_pk_bf16_f32 v59, v106, v107
  v_exp_f32 v109, v109
  v_mfma_f32_32x32x16_bf16 v[128:143], v[38:41], v[54:57], v[128:143]
  buffer_load_dwordx4 v[232:235], v2, s[8:11], s43 offen offset:2048 sc1
  v_exp_f32 v110, v110
  v_cvt_pk_bf16_f32 v60, v108, v109
  v_exp_f32 v111, v111
  v_exp_f32 v112, v112
  v_cvt_pk_bf16_f32 v61, v110, v111
  v_exp_f32 v113, v113
  v_exp_f32 v114, v114
  v_mfma_f32_32x32x16_bf16 v[128:143], v[42:45], v[58:61], v[128:143]
  s_waitcnt lgkmcnt(0)
  buffer_load_dwordx4 v[236:239], v2, s[8:11], s43 offen offset:3072 sc1
  v_cvt_pk_bf16_f32 v54, v112, v113
  v_exp_f32 v115, v115
  v_exp_f32 v116, v116
  v_cvt_pk_bf16_f32 v55, v114, v115
  v_exp_f32 v117, v117
  v_mfma_f32_32x32x16_bf16 v[96:111], v[32:35], v[14:17], v[64:79]
  ds_read_b64 v[26:27], v5 offset:15360
  ds_read_b64 v[28:29], v5 offset:15616
  ds_read_b64 v[30:31], v5 offset:16384
  v_exp_f32 v118, v118
  v_cvt_pk_bf16_f32 v56, v116, v117
  v_exp_f32 v119, v119
  v_exp_f32 v120, v120
  v_mfma_f32_32x32x8_bf16 v[96:111], v[36:37], v[18:19], v[96:111]
  v_cvt_pk_bf16_f32 v57, v118, v119
  v_exp_f32 v121, v121
  v_exp_f32 v122, v122
  v_cvt_pk_bf16_f32 v58, v120, v121
  v_exp_f32 v123, v123
  v_exp_f32 v124, v124
  v_cvt_pk_bf16_f32 v59, v122, v123
  v_exp_f32 v125, v125
  v_mfma_f32_32x32x16_bf16 v[144:159], v[38:41], v[54:57], v[144:159]
  s_add_u32 s43, s43, 4096
  buffer_load_dwordx4 v[240:243], v2, s[8:11], s43 offen offset:0 sc1
  v_exp_f32 v126, v126
  v_cvt_pk_bf16_f32 v60, v124, v125
  v_exp_f32 v127, v127
  v_exp_f32 v96, v96
  v_cvt_pk_bf16_f32 v61, v126, v127
  v_exp_f32 v97, v97
  v_exp_f32 v98, v98
  v_mfma_f32_32x32x16_bf16 v[144:159], v[42:45], v[58:61], v[144:159]
  v_cvt_pk_bf16_f32 v54, v96, v97
  v_exp_f32 v99, v99
  v_exp_f32 v100, v100
  v_cvt_pk_bf16_f32 v55, v98, v99
  v_exp_f32 v101, v101
  v_mfma_f32_32x32x16_bf16 v[112:127], v[32:35], v[20:23], v[80:95]
  s_mov_b64 exec, s[38:39]
  ds_read_b128 v[38:41], v8 offset:15360
  ds_read_b128 v[42:45], v8 offset:16000
  s_mov_b64 exec, -1
  v_exp_f32 v102, v102
  v_cvt_pk_bf16_f32 v56, v100, v101
  v_exp_f32 v103, v103
  v_exp_f32 v104, v104
  v_mfma_f32_32x32x8_bf16 v[112:127], v[36:37], v[24:25], v[112:127]
  v_cvt_pk_bf16_f32 v57, v102, v103
  v_exp_f32 v105, v105
  v_exp_f32 v106, v106
  v_cvt_pk_bf16_f32 v58, v104, v105
  v_exp_f32 v107, v107
  v_exp_f32 v108, v108
  v_cvt_pk_bf16_f32 v59, v106, v107
  v_exp_f32 v109, v109
  v_mfma_f32_32x32x16_bf16 v[128:143], v[46:49], v[54:57], v[128:143]
  s_add_u32 s58, s58, 4096
  buffer_load_dwordx4 a[8:11], v2, s[8:11], s58 offen offset:0 sc1
  v_exp_f32 v110, v110
  v_cvt_pk_bf16_f32 v60, v108, v109
  v_exp_f32 v111, v111
  v_exp_f32 v112, v112
  v_cvt_pk_bf16_f32 v61, v110, v111
  v_exp_f32 v113, v113
  v_exp_f32 v114, v114
  v_mfma_f32_32x32x16_bf16 v[128:143], v[50:53], v[58:61], v[128:143]
  s_waitcnt lgkmcnt(0)
  v_cvt_pk_bf16_f32 v54, v112, v113
  v_exp_f32 v115, v115
  v_exp_f32 v116, v116
  v_cvt_pk_bf16_f32 v55, v114, v115
  v_exp_f32 v117, v117
  v_mfma_f32_32x32x16_bf16 v[96:111], v[26:29], v[14:17], v[64:79]
  ds_read_b64 v[32:33], v5 offset:17920
  ds_read_b64 v[34:35], v5 offset:18176
  ds_read_b64 v[36:37], v5 offset:18944
  v_exp_f32 v118, v118
  v_cvt_pk_bf16_f32 v56, v116, v117
  v_exp_f32 v119, v119
  v_exp_f32 v120, v120
  v_mfma_f32_32x32x8_bf16 v[96:111], v[30:31], v[18:19], v[96:111]
  v_cvt_pk_bf16_f32 v57, v118, v119
  v_exp_f32 v121, v121
  v_exp_f32 v122, v122
  v_cvt_pk_bf16_f32 v58, v120, v121
  v_exp_f32 v123, v123
  v_exp_f32 v124, v124
  v_cvt_pk_bf16_f32 v59, v122, v123
  v_exp_f32 v125, v125
  v_mfma_f32_32x32x16_bf16 v[144:159], v[46:49], v[54:57], v[144:159]
  buffer_load_dwordx4 a[20:23], v2, s[8:11], s58 offen offset:1024 sc1
  v_exp_f32 v126, v126
  v_cvt_pk_bf16_f32 v60, v124, v125
  v_exp_f32 v127, v127
  v_exp_f32 v96, v96
  v_cvt_pk_bf16_f32 v61, v126, v127
  v_exp_f32 v97, v97
  v_exp_f32 v98, v98
  v_mfma_f32_32x32x16_bf16 v[144:159], v[50:53], v[58:61], v[144:159]
  v_cvt_pk_bf16_f32 v54, v96, v97
  v_exp_f32 v99, v99
  v_exp_f32 v100, v100
  v_cvt_pk_bf16_f32 v55, v98, v99
  v_exp_f32 v101, v101
  v_mfma_f32_32x32x16_bf16 v[112:127], v[26:29], v[20:23], v[80:95]
  s_mov_b64 exec, s[38:39]
  ds_read_b128 v[46:49], v8 offset:17920
  ds_read_b128 v[50:53], v8 offset:18560
  s_mov_b64 exec, -1
  v_exp_f32 v102, v102
  v_cvt_pk_bf16_f32 v56, v100, v101
  v_exp_f32 v103, v103
  v_exp_f32 v104, v104
  v_mfma_f32_32x32x8_bf16 v[112:127], v[30:31], v[24:25], v[112:127]
  v_cvt_pk_bf16_f32 v57, v102, v103
  v_exp_f32 v105, v105
  v_exp_f32 v106, v106
  v_cvt_pk_bf16_f32 v58, v104, v105
  v_exp_f32 v107, v107
  v_exp_f32 v108, v108
  v_cvt_pk_bf16_f32 v59, v106, v107
  v_exp_f32 v109, v109
  v_mfma_f32_32x32x16_bf16 v[128:143], v[38:41], v[54:57], v[128:143]
  buffer_load_dword v254, v63, s[8:11], s61 offen offset:2048 sc1
  v_exp_f32 v110, v110
  v_cvt_pk_bf16_f32 v60, v108, v109
  v_exp_f32 v111, v111
  v_exp_f32 v112, v112
  v_cvt_pk_bf16_f32 v61, v110, v111
  v_exp_f32 v113, v113
  v_exp_f32 v114, v114
  v_mfma_f32_32x32x16_bf16 v[128:143], v[42:45], v[58:61], v[128:143]
  s_waitcnt lgkmcnt(0)
  v_cvt_pk_bf16_f32 v54, v112, v113
  v_exp_f32 v115, v115
  v_exp_f32 v116, v116
  v_cvt_pk_bf16_f32 v55, v114, v115
  v_exp_f32 v117, v117
  v_mfma_f32_32x32x16_bf16 v[96:111], v[32:35], v[14:17], v[64:79]
  ds_read_b64 v[26:27], v5 offset:20480
  ds_read_b64 v[28:29], v5 offset:20736
  ds_read_b64 v[30:31], v5 offset:21504
  v_exp_f32 v118, v118
  v_cvt_pk_bf16_f32 v56, v116, v117
  v_exp_f32 v119, v119
  v_exp_f32 v120, v120
  v_mfma_f32_32x32x8_bf16 v[96:111], v[36:37], v[18:19], v[96:111]
  v_cvt_pk_bf16_f32 v57, v118, v119
  v_exp_f32 v121, v121
  v_exp_f32 v122, v122
  v_cvt_pk_bf16_f32 v58, v120, v121
  v_exp_f32 v123, v123
  v_exp_f32 v124, v124
  v_cvt_pk_bf16_f32 v59, v122, v123
  v_exp_f32 v125, v125
  v_mfma_f32_32x32x16_bf16 v[144:159], v[38:41], v[54:57], v[144:159]
  buffer_load_dwordx4 a[32:35], v2, s[8:11], s58 offen offset:2048 sc1
  v_exp_f32 v126, v126
  v_cvt_pk_bf16_f32 v60, v124, v125
  v_exp_f32 v127, v127
  v_exp_f32 v96, v96
  v_cvt_pk_bf16_f32 v61, v126, v127
  v_exp_f32 v97, v97
  v_exp_f32 v98, v98
  v_mfma_f32_32x32x16_bf16 v[144:159], v[42:45], v[58:61], v[144:159]
  v_cvt_pk_bf16_f32 v54, v96, v97
  v_exp_f32 v99, v99
  v_exp_f32 v100, v100
  v_cvt_pk_bf16_f32 v55, v98, v99
  v_exp_f32 v101, v101
  v_mfma_f32_32x32x16_bf16 v[112:127], v[32:35], v[20:23], v[80:95]
  s_mov_b64 exec, s[38:39]
  ds_read_b128 v[38:41], v8 offset:20480
  ds_read_b128 v[42:45], v8 offset:21120
  s_mov_b64 exec, -1
  v_exp_f32 v102, v102
  v_cvt_pk_bf16_f32 v56, v100, v101
  v_exp_f32 v103, v103
  v_exp_f32 v104, v104
  v_mfma_f32_32x32x8_bf16 v[112:127], v[36:37], v[24:25], v[112:127]
  v_cvt_pk_bf16_f32 v57, v102, v103
  v_exp_f32 v105, v105
  v_exp_f32 v106, v106
  v_cvt_pk_bf16_f32 v58, v104, v105
  v_exp_f32 v107, v107
  v_exp_f32 v108, v108
  v_cvt_pk_bf16_f32 v59, v106, v107
  v_exp_f32 v109, v109
  v_mfma_f32_32x32x16_bf16 v[128:143], v[46:49], v[54:57], v[128:143]
  buffer_load_dwordx4 a[44:47], v2, s[8:11], s58 offen offset:3072 sc1
  v_exp_f32 v110, v110
  v_cvt_pk_bf16_f32 v60, v108, v109
  v_exp_f32 v111, v111
  v_exp_f32 v112, v112
  v_cvt_pk_bf16_f32 v61, v110, v111
  v_exp_f32 v113, v113
  v_exp_f32 v114, v114
  v_mfma_f32_32x32x16_bf16 v[128:143], v[50:53], v[58:61], v[128:143]
  s_waitcnt lgkmcnt(0)
  s_add_u32 s58, s58, 4096
  buffer_load_dwordx4 a[56:59], v2, s[8:11], s58 offen offset:0 sc1
  v_cvt_pk_bf16_f32 v54, v112, v113
  v_exp_f32 v115, v115
  v_exp_f32 v116, v116
  v_cvt_pk_bf16_f32 v55, v114, v115
  v_exp_f32 v117, v117
  v_mfma_f32_32x32x16_bf16 v[96:111], v[26:29], v[14:17], v[64:79]
  ds_read_b64 v[32:33], v5 offset:23040
  ds_read_b64 v[34:35], v5 offset:23296
  ds_read_b64 v[36:37], v5 offset:24064
  v_exp_f32 v118, v118
  v_cvt_pk_bf16_f32 v56, v116, v117
  v_exp_f32 v119, v119
  v_exp_f32 v120, v120
  v_mfma_f32_32x32x8_bf16 v[96:111], v[30:31], v[18:19], v[96:111]
  v_cvt_pk_bf16_f32 v57, v118, v119
  v_exp_f32 v121, v121
  v_exp_f32 v122, v122
  v_cvt_pk_bf16_f32 v58, v120, v121
  v_exp_f32 v123, v123
  v_exp_f32 v124, v124
  v_cvt_pk_bf16_f32 v59, v122, v123
  v_exp_f32 v125, v125
  v_mfma_f32_32x32x16_bf16 v[144:159], v[46:49], v[54:57], v[144:159]
  s_lshl_b32 s34, s101, 13
  s_cmp_ge_u32 s34, L_mk_end-L_fin_begin
  s_cbranch_scc1 L_npf_1125
  s_getpc_b64 s[54:55]
L_pc_1124:
  s_add_u32 s54, s54, L_fin_begin-L_pc_1124
  s_addc_u32 s55, s55, 0
  v_lshl_add_u32 v255, v1, 7, s34
  v_min_u32 v255, L_mk_end-L_fin_begin-4, v255
  global_load_dword v255, v255, s[54:55]
L_npf_1125:
  v_exp_f32 v126, v126
  v_cvt_pk_bf16_f32 v60, v124, v125
  v_exp_f32 v127, v127
  v_exp_f32 v96, v96
  v_cvt_pk_bf16_f32 v61, v126, v127
  v_exp_f32 v97, v97
  v_exp_f32 v98, v98
  v_mfma_f32_32x32x16_bf16 v[144:159], v[50:53], v[58:61], v[144:159]
  v_cvt_pk_bf16_f32 v54, v96, v97
  v_exp_f32 v99, v99
  v_exp_f32 v100, v100
  v_cvt_pk_bf16_f32 v55, v98, v99
  v_exp_f32 v101, v101
  v_mfma_f32_32x32x16_bf16 v[112:127], v[26:29], v[20:23], v[80:95]
  s_mov_b64 exec, s[38:39]
  ds_read_b128 v[46:49], v8 offset:23040
  ds_read_b128 v[50:53], v8 offset:23680
  s_mov_b64 exec, -1
  v_exp_f32 v102, v102
  v_cvt_pk_bf16_f32 v56, v100, v101
  v_exp_f32 v103, v103
  v_exp_f32 v104, v104
  v_mfma_f32_32x32x8_bf16 v[112:127], v[30:31], v[24:25], v[112:127]
  v_cvt_pk_bf16_f32 v57, v102, v103
  v_exp_f32 v105, v105
  v_exp_f32 v106, v106
  v_cvt_pk_bf16_f32 v58, v104, v105
  v_exp_f32 v107, v107
  v_exp_f32 v108, v108
  v_cvt_pk_bf16_f32 v59, v106, v107
  v_exp_f32 v109, v109
  v_mfma_f32_32x32x16_bf16 v[128:143], v[38:41], v[54:57], v[128:143]
  v_exp_f32 v110, v110
  v_cvt_pk_bf16_f32 v60, v108, v109
  v_exp_f32 v111, v111
  v_exp_f32 v112, v112
  v_cvt_pk_bf16_f32 v61, v110, v111
  v_exp_f32 v113, v113
  v_exp_f32 v114, v114
  v_mfma_f32_32x32x16_bf16 v[128:143], v[42:45], v[58:61], v[128:143]
  s_waitcnt lgkmcnt(0)
  v_cvt_pk_bf16_f32 v54, v112, v113
  v_exp_f32 v115, v115
  v_exp_f32 v116, v116
  v_cvt_pk_bf16_f32 v55, v114, v115
  v_exp_f32 v117, v117
  v_mfma_f32_32x32x16_bf16 v[96:111], v[32:35], v[14:17], v[64:79]
  ds_read_b64 v[26:27], v5 offset:25600
  ds_read_b64 v[28:29], v5 offset:25856
  ds_read_b64 v[30:31], v5 offset:26624
  v_exp_f32 v118, v118
  v_cvt_pk_bf16_f32 v56, v116, v117
  v_exp_f32 v119, v119
  v_exp_f32 v120, v120
  v_mfma_f32_32x32x8_bf16 v[96:111], v[36:37], v[18:19], v[96:111]
  v_cvt_pk_bf16_f32 v57, v118, v119
  v_exp_f32 v121, v121
  v_exp_f32 v122, v122
  v_cvt_pk_bf16_f32 v58, v120, v121
  v_exp_f32 v123, v123
  v_exp_f32 v124, v124
  v_cvt_pk_bf16_f32 v59, v122, v123
  v_exp_f32 v125, v125
  v_mfma_f32_32x32x16_bf16 v[144:159], v[38:41], v[54:57], v[144:159]
  buffer_load_dwordx4 a[68:71], v2, s[8:11], s58 offen offset:1024 sc1
  v_exp_f32 v126, v126
  v_cvt_pk_bf16_f32 v60, v124, v125
  v_exp_f32 v127, v127
  v_exp_f32 v96, v96
  v_cvt_pk_bf16_f32 v61, v126, v127
  v_exp_f32 v97, v97
  v_exp_f32 v98, v98
  v_mfma_f32_32x32x16_bf16 v[144:159], v[42:45], v[58:61], v[144:159]
  buffer_load_dwordx4 a[80:83], v2, s[8:11], s58 offen offset:2048 sc1
  v_cvt_pk_bf16_f32 v54, v96, v97
  v_exp_f32 v99, v99
  v_exp_f32 v100, v100
  v_cvt_pk_bf16_f32 v55, v98, v99
  v_exp_f32 v101, v101
  v_mfma_f32_32x32x16_bf16 v[112:127], v[32:35], v[20:23], v[80:95]
  s_mov_b64 exec, s[38:39]
  ds_read_b128 v[38:41], v8 offset:25600
  ds_read_b128 v[42:45], v8 offset:26240
  s_mov_b64 exec, -1
  v_exp_f32 v102, v102
  v_cvt_pk_bf16_f32 v56, v100, v101
  v_exp_f32 v103, v103
  v_exp_f32 v104, v104
  v_mfma_f32_32x32x8_bf16 v[112:127], v[36:37], v[24:25], v[112:127]
  v_cvt_pk_bf16_f32 v57, v102, v103
  v_exp_f32 v105, v105
  v_exp_f32 v106, v106
  v_cvt_pk_bf16_f32 v58, v104, v105
  v_exp_f32 v107, v107
  v_exp_f32 v108, v108
  v_cvt_pk_bf16_f32 v59, v106, v107
  v_exp_f32 v109, v109
  v_mfma_f32_32x32x16_bf16 v[128:143], v[46:49], v[54:57], v[128:143]
  buffer_load_dwordx4 a[92:95], v2, s[8:11], s58 offen offset:3072 sc1
  v_exp_f32 v110, v110
  v_cvt_pk_bf16_f32 v60, v108, v109
  v_exp_f32 v111, v111
  v_exp_f32 v112, v112
  v_cvt_pk_bf16_f32 v61, v110, v111
  v_exp_f32 v113, v113
  v_exp_f32 v114, v114
  v_mfma_f32_32x32x16_bf16 v[128:143], v[50:53], v[58:61], v[128:143]
  s_waitcnt lgkmcnt(0)
  v_cvt_pk_bf16_f32 v54, v112, v113
  v_exp_f32 v115, v115
  v_exp_f32 v116, v116
  v_cvt_pk_bf16_f32 v55, v114, v115
  v_exp_f32 v117, v117
  v_mfma_f32_32x32x16_bf16 v[96:111], v[26:29], v[14:17], v[64:79]
  ds_read_b64 v[32:33], v5 offset:28160
  ds_read_b64 v[34:35], v5 offset:28416
  ds_read_b64 v[36:37], v5 offset:29184
  v_exp_f32 v118, v118
  v_cvt_pk_bf16_f32 v56, v116, v117
  v_exp_f32 v119, v119
  v_exp_f32 v120, v120
  v_mfma_f32_32x32x8_bf16 v[96:111], v[30:31], v[18:19], v[96:111]
  v_cvt_pk_bf16_f32 v57, v118, v119
  v_exp_f32 v121, v121
  v_exp_f32 v122, v122
  v_cvt_pk_bf16_f32 v58, v120, v121
  v_exp_f32 v123, v123
  v_exp_f32 v124, v124
  v_cvt_pk_bf16_f32 v59, v122, v123
  v_exp_f32 v125, v125
  v_mfma_f32_32x32x16_bf16 v[144:159], v[46:49], v[54:57], v[144:159]
  s_add_u32 s61, s61, 4096
  buffer_load_dword v254, v63, s[8:11], s61 offen offset:0 sc1
  v_exp_f32 v126, v126
  v_cvt_pk_bf16_f32 v60, v124, v125
  v_exp_f32 v127, v127
  v_exp_f32 v96, v96
  v_cvt_pk_bf16_f32 v61, v126, v127
  v_exp_f32 v97, v97
  v_exp_f32 v98, v98
  v_mfma_f32_32x32x16_bf16 v[144:159], v[50:53], v[58:61], v[144:159]
  v_cvt_pk_bf16_f32 v54, v96, v97
  v_exp_f32 v99, v99
  v_exp_f32 v100, v100
  v_cvt_pk_bf16_f32 v55, v98, v99
  v_exp_f32 v101, v101
  v_mfma_f32_32x32x16_bf16 v[112:127], v[26:29], v[20:23], v[80:95]
  s_mov_b64 exec, s[38:39]
  ds_read_b128 v[46:49], v8 offset:28160
  ds_read_b128 v[50:53], v8 offset:28800
  s_mov_b64 exec, -1
  v_exp_f32 v102, v102
  v_cvt_pk_bf16_f32 v56, v100, v101
  v_exp_f32 v103, v103
  v_exp_f32 v104, v104
  v_mfma_f32_32x32x8_bf16 v[112:127], v[30:31], v[24:25], v[112:127]
  v_cvt_pk_bf16_f32 v57, v102, v103
  v_exp_f32 v105, v105
  v_exp_f32 v106, v106
  v_cvt_pk_bf16_f32 v58, v104, v105
  v_exp_f32 v107, v107
  v_exp_f32 v108, v108
  v_cvt_pk_bf16_f32 v59, v106, v107
  v_exp_f32 v109, v109
  v_mfma_f32_32x32x16_bf16 v[128:143], v[38:41], v[54:57], v[128:143]
  v_exp_f32 v110, v110
  v_cvt_pk_bf16_f32 v60, v108, v109
  v_exp_f32 v111, v111
  v_exp_f32 v112, v112
  v_cvt_pk_bf16_f32 v61, v110, v111
  v_exp_f32 v113, v113
  v_exp_f32 v114, v114
  v_mfma_f32_32x32x16_bf16 v[128:143], v[42:45], v[58:61], v[128:143]
  s_waitcnt lgkmcnt(0)
  v_cvt_pk_bf16_f32 v54, v112, v113
  v_exp_f32 v115, v115
  v_exp_f32 v116, v116
  v_cvt_pk_bf16_f32 v55, v114, v115
  v_exp_f32 v117, v117
  v_mfma_f32_32x32x16_bf16 v[96:111], v[32:35], v[14:17], v[64:79]
  ds_read_b64 v[26:27], v5 offset:30720
  ds_read_b64 v[28:29], v5 offset:30976
  ds_read_b64 v[30:31], v5 offset:31744
  v_exp_f32 v118, v118
  v_cvt_pk_bf16_f32 v56, v116, v117
  v_exp_f32 v119, v119
  v_exp_f32 v120, v120
  v_mfma_f32_32x32x8_bf16 v[96:111], v[36:37], v[18:19], v[96:111]
  v_cvt_pk_bf16_f32 v57, v118, v119
  v_exp_f32 v121, v121
  v_exp_f32 v122, v122
  v_cvt_pk_bf16_f32 v58, v120, v121
  v_exp_f32 v123, v123
  v_exp_f32 v124, v124
  v_cvt_pk_bf16_f32 v59, v122, v123
  v_exp_f32 v125, v125
  v_mfma_f32_32x32x16_bf16 v[144:159], v[38:41], v[54:57], v[144:159]
  s_add_u32 s58, s58, 4096
  buffer_load_dwordx4 a[104:107], v2, s[8:11], s58 offen offset:0 sc1
  v_exp_f32 v126, v126
  v_cvt_pk_bf16_f32 v60, v124, v125
  v_exp_f32 v127, v127
  v_exp_f32 v96, v96
  v_cvt_pk_bf16_f32 v61, v126, v127
  v_exp_f32 v97, v97
  v_exp_f32 v98, v98
  v_mfma_f32_32x32x16_bf16 v[144:159], v[42:45], v[58:61], v[144:159]
  buffer_load_dwordx4 a[116:119], v2, s[8:11], s58 offen offset:1024 sc1
  v_cvt_pk_bf16_f32 v54, v96, v97
  v_exp_f32 v99, v99
  v_exp_f32 v100, v100
  v_cvt_pk_bf16_f32 v55, v98, v99
  v_exp_f32 v101, v101
  v_mfma_f32_32x32x16_bf16 v[112:127], v[32:35], v[20:23], v[80:95]
  s_mov_b64 exec, s[38:39]
  ds_read_b128 v[38:41], v8 offset:30720
  ds_read_b128 v[42:45], v8 offset:31360
  s_mov_b64 exec, -1
  v_exp_f32 v102, v102
  v_cvt_pk_bf16_f32 v56, v100, v101
  v_exp_f32 v103, v103
  v_exp_f32 v104, v104
  v_mfma_f32_32x32x8_bf16 v[112:127], v[36:37], v[24:25], v[112:127]
  v_cvt_pk_bf16_f32 v57, v102, v103
  v_exp_f32 v105, v105
  v_exp_f32 v106, v106
  v_cvt_pk_bf16_f32 v58, v104, v105
  v_exp_f32 v107, v107
  v_exp_f32 v108, v108
  v_cvt_pk_bf16_f32 v59, v106, v107
  v_exp_f32 v109, v109
  v_mfma_f32_32x32x16_bf16 v[128:143], v[46:49], v[54:57], v[128:143]
  buffer_load_dwordx4 a[128:131], v2, s[8:11], s58 offen offset:2048 sc1
  v_exp_f32 v110, v110
  v_cvt_pk_bf16_f32 v60, v108, v109
  v_exp_f32 v111, v111
  v_exp_f32 v112, v112
  v_cvt_pk_bf16_f32 v61, v110, v111
  v_exp_f32 v113, v113
  v_exp_f32 v114, v114
  v_mfma_f32_32x32x16_bf16 v[128:143], v[50:53], v[58:61], v[128:143]
  s_waitcnt lgkmcnt(0)
  v_cvt_pk_bf16_f32 v54, v112, v113
  v_exp_f32 v115, v115
  v_exp_f32 v116, v116
  v_cvt_pk_bf16_f32 v55, v114, v115
  v_exp_f32 v117, v117
  v_mfma_f32_32x32x16_bf16 v[96:111], v[26:29], v[14:17], v[64:79]
  ds_read_b64 v[32:33], v5 offset:33280
  ds_read_b64 v[34:35], v5 offset:33536
  ds_read_b64 v[36:37], v5 offset:34304
  v_exp_f32 v118, v118
  v_cvt_pk_bf16_f32 v56, v116, v117
  v_exp_f32 v119, v119
  v_exp_f32 v120, v120
  v_mfma_f32_32x32x8_bf16 v[96:111], v[30:31], v[18:19], v[96:111]
  v_cvt_pk_bf16_f32 v57, v118, v119
  v_exp_f32 v121, v121
  v_exp_f32 v122, v122
  v_cvt_pk_bf16_f32 v58, v120, v121
  v_exp_f32 v123, v123
  v_exp_f32 v124, v124
  v_cvt_pk_bf16_f32 v59, v122, v123
  v_exp_f32 v125, v125
  v_mfma_f32_32x32x16_bf16 v[144:159], v[46:49], v[54:57], v[144:159]
  buffer_load_dwordx4 a[140:143], v2, s[8:11], s58 offen offset:3072 sc1
  v_exp_f32 v126, v126
  v_cvt_pk_bf16_f32 v60, v124, v125
  v_exp_f32 v127, v127
  v_exp_f32 v96, v96
  v_cvt_pk_bf16_f32 v61, v126, v127
  v_exp_f32 v97, v97
  v_exp_f32 v98, v98
  v_mfma_f32_32x32x16_bf16 v[144:159], v[50:53], v[58:61], v[144:159]
  v_cvt_pk_bf16_f32 v54, v96, v97
  v_exp_f32 v99, v99
  v_exp_f32 v100, v100
  v_cvt_pk_bf16_f32 v55, v98, v99
  v_exp_f32 v101, v101
  v_mfma_f32_32x32x16_bf16 v[112:127], v[26:29], v[20:23], v[80:95]
  s_mov_b64 exec, s[38:39]
  ds_read_b128 v[46:49], v8 offset:33280
  ds_read_b128 v[50:53], v8 offset:33920
  s_mov_b64 exec, -1
  v_exp_f32 v102, v102
  v_cvt_pk_bf16_f32 v56, v100, v101
  v_exp_f32 v103, v103
  v_exp_f32 v104, v104
  v_mfma_f32_32x32x8_bf16 v[112:127], v[30:31], v[24:25], v[112:127]
  v_cvt_pk_bf16_f32 v57, v102, v103
  v_exp_f32 v105, v105
  v_exp_f32 v106, v106
  v_cvt_pk_bf16_f32 v58, v104, v105
  v_exp_f32 v107, v107
  v_exp_f32 v108, v108
  v_cvt_pk_bf16_f32 v59, v106, v107
  v_exp_f32 v109, v109
  v_mfma_f32_32x32x16_bf16 v[128:143], v[38:41], v[54:57], v[128:143]
  s_add_u32 s58, s58, 4096
  buffer_load_dwordx4 a[152:155], v2, s[8:11], s58 offen offset:0 sc1
  v_exp_f32 v110, v110
  v_cvt_pk_bf16_f32 v60, v108, v109
  v_exp_f32 v111, v111
  v_exp_f32 v112, v112
  v_cvt_pk_bf16_f32 v61, v110, v111
  v_exp_f32 v113, v113
  v_exp_f32 v114, v114
  v_mfma_f32_32x32x16_bf16 v[128:143], v[42:45], v[58:61], v[128:143]
  s_waitcnt lgkmcnt(0)
  buffer_load_dwordx4 a[164:167], v2, s[8:11], s58 offen offset:1024 sc1
  v_cvt_pk_bf16_f32 v54, v112, v113
  v_exp_f32 v115, v115
  v_exp_f32 v116, v116
  v_cvt_pk_bf16_f32 v55, v114, v115
  v_exp_f32 v117, v117
  v_mfma_f32_32x32x16_bf16 v[96:111], v[32:35], v[14:17], v[64:79]
  ds_read_b64 v[26:27], v5 offset:35840
  ds_read_b64 v[28:29], v5 offset:36096
  ds_read_b64 v[30:31], v5 offset:36864
  v_exp_f32 v118, v118
  v_cvt_pk_bf16_f32 v56, v116, v117
  v_exp_f32 v119, v119
  v_exp_f32 v120, v120
  v_mfma_f32_32x32x8_bf16 v[96:111], v[36:37], v[18:19], v[96:111]
  v_cvt_pk_bf16_f32 v57, v118, v119
  v_exp_f32 v121, v121
  v_exp_f32 v122, v122
  v_cvt_pk_bf16_f32 v58, v120, v121
  v_exp_f32 v123, v123
  v_exp_f32 v124, v124
  v_cvt_pk_bf16_f32 v59, v122, v123
  v_exp_f32 v125, v125
  v_mfma_f32_32x32x16_bf16 v[144:159], v[38:41], v[54:57], v[144:159]
  buffer_load_dwordx4 a[176:179], v2, s[8:11], s58 offen offset:2048 sc1
  v_exp_f32 v126, v126
  v_cvt_pk_bf16_f32 v60, v124, v125
  v_exp_f32 v127, v127
  v_exp_f32 v96, v96
  v_cvt_pk_bf16_f32 v61, v126, v127
  v_exp_f32 v97, v97
  v_exp_f32 v98, v98
  v_mfma_f32_32x32x16_bf16 v[144:159], v[42:45], v[58:61], v[144:159]
  v_cvt_pk_bf16_f32 v54, v96, v97
  v_exp_f32 v99, v99
  v_exp_f32 v100, v100
  v_cvt_pk_bf16_f32 v55, v98, v99
  v_exp_f32 v101, v101
  v_mfma_f32_32x32x16_bf16 v[112:127], v[32:35], v[20:23], v[80:95]
  s_mov_b64 exec, s[38:39]
  ds_read_b128 v[38:41], v8 offset:35840
  ds_read_b128 v[42:45], v8 offset:36480
  s_mov_b64 exec, -1
  v_exp_f32 v102, v102
  v_cvt_pk_bf16_f32 v56, v100, v101
  v_exp_f32 v103, v103
  v_exp_f32 v104, v104
  v_mfma_f32_32x32x8_bf16 v[112:127], v[36:37], v[24:25], v[112:127]
  v_cvt_pk_bf16_f32 v57, v102, v103
  v_exp_f32 v105, v105
  v_exp_f32 v106, v106
  v_cvt_pk_bf16_f32 v58, v104, v105
  v_exp_f32 v107, v107
  v_exp_f32 v108, v108
  v_cvt_pk_bf16_f32 v59, v106, v107
  v_exp_f32 v109, v109
  v_mfma_f32_32x32x16_bf16 v[128:143], v[46:49], v[54:57], v[128:143]
  buffer_load_dwordx4 a[188:191], v2, s[8:11], s58 offen offset:3072 sc1
  v_exp_f32 v110, v110
  v_cvt_pk_bf16_f32 v60, v108, v109
  v_exp_f32 v111, v111
  v_exp_f32 v112, v112
  v_cvt_pk_bf16_f32 v61, v110, v111
  v_exp_f32 v113, v113
  v_exp_f32 v114, v114
  v_mfma_f32_32x32x16_bf16 v[128:143], v[50:53], v[58:61], v[128:143]
  s_waitcnt lgkmcnt(0)
  v_cvt_pk_bf16_f32 v54, v112, v113
  v_exp_f32 v115, v115
  v_exp_f32 v116, v116
  v_cvt_pk_bf16_f32 v55, v114, v115
  v_exp_f32 v117, v117
  v_mfma_f32_32x32x16_bf16 v[96:111], v[26:29], v[14:17], v[64:79]
  ds_read_b64 v[32:33], v5 offset:38400
  ds_read_b64 v[34:35], v5 offset:38656
  ds_read_b64 v[36:37], v5 offset:39424
  v_exp_f32 v118, v118
  v_cvt_pk_bf16_f32 v56, v116, v117
  v_exp_f32 v119, v119
  v_exp_f32 v120, v120
  v_mfma_f32_32x32x8_bf16 v[96:111], v[30:31], v[18:19], v[96:111]
  v_cvt_pk_bf16_f32 v57, v118, v119
  v_exp_f32 v121, v121
  v_exp_f32 v122, v122
  v_cvt_pk_bf16_f32 v58, v120, v121
  v_exp_f32 v123, v123
  v_exp_f32 v124, v124
  v_cvt_pk_bf16_f32 v59, v122, v123
  v_exp_f32 v125, v125
  v_mfma_f32_32x32x16_bf16 v[144:159], v[46:49], v[54:57], v[144:159]
  s_add_u32 s58, s58, 4096
  buffer_load_dwordx4 a[200:203], v2, s[8:11], s58 offen offset:0 sc1
  v_exp_f32 v126, v126
  v_cvt_pk_bf16_f32 v60, v124, v125
  v_exp_f32 v127, v127
  v_exp_f32 v96, v96
  v_cvt_pk_bf16_f32 v61, v126, v127
  v_exp_f32 v97, v97
  v_exp_f32 v98, v98
  v_mfma_f32_32x32x16_bf16 v[144:159], v[50:53], v[58:61], v[144:159]
  buffer_load_dwordx4 a[212:215], v2, s[8:11], s58 offen offset:1024 sc1
  v_cvt_pk_bf16_f32 v54, v96, v97
  v_exp_f32 v99, v99
  v_exp_f32 v100, v100
  v_cvt_pk_bf16_f32 v55, v98, v99
  v_exp_f32 v101, v101
  v_mfma_f32_32x32x16_bf16 v[112:127], v[26:29], v[20:23], v[80:95]
  s_mov_b64 exec, s[38:39]
  ds_read_b128 v[46:49], v8 offset:38400
  ds_read_b128 v[50:53], v8 offset:39040
  s_mov_b64 exec, -1
  v_exp_f32 v102, v102
  v_cvt_pk_bf16_f32 v56, v100, v101
  v_exp_f32 v103, v103
  v_exp_f32 v104, v104
  v_mfma_f32_32x32x8_bf16 v[112:127], v[30:31], v[24:25], v[112:127]
  v_cvt_pk_bf16_f32 v57, v102, v103
  v_exp_f32 v105, v105
  v_exp_f32 v106, v106
  v_cvt_pk_bf16_f32 v58, v104, v105
  v_exp_f32 v107, v107
  v_exp_f32 v108, v108
  v_cvt_pk_bf16_f32 v59, v106, v107
  v_exp_f32 v109, v109
  v_mfma_f32_32x32x16_bf16 v[128:143], v[38:41], v[54:57], v[128:143]
  buffer_load_dwordx4 a[224:227], v2, s[8:11], s58 offen offset:2048 sc1
  v_exp_f32 v110, v110
  v_cvt_pk_bf16_f32 v60, v108, v109
  v_exp_f32 v111, v111
  v_exp_f32 v112, v112
  v_cvt_pk_bf16_f32 v61, v110, v111
  v_exp_f32 v113, v113
  v_exp_f32 v114, v114
  v_mfma_f32_32x32x16_bf16 v[128:143], v[42:45], v[58:61], v[128:143]
  s_waitcnt lgkmcnt(0)
  v_cvt_pk_bf16_f32 v54, v112, v113
  v_exp_f32 v115, v115
  v_exp_f32 v116, v116
  v_cvt_pk_bf16_f32 v55, v114, v115
  v_exp_f32 v117, v117
  v_mfma_f32_32x32x16_bf16 v[96:111], v[32:35], v[14:17], v[64:79]
  v_exp_f32 v118, v118
  v_cvt_pk_bf16_f32 v56, v116, v117
  v_exp_f32 v119, v119
  v_exp_f32 v120, v120
  v_mfma_f32_32x32x8_bf16 v[96:111], v[36:37], v[18:19], v[96:111]
  v_cvt_pk_bf16_f32 v57, v118, v119
  v_exp_f32 v121, v121
  v_exp_f32 v122, v122
  v_cvt_pk_bf16_f32 v58, v120, v121
  v_exp_f32 v123, v123
  v_exp_f32 v124, v124
  v_cvt_pk_bf16_f32 v59, v122, v123
  v_exp_f32 v125, v125
  v_mfma_f32_32x32x16_bf16 v[144:159], v[38:41], v[54:57], v[144:159]
  buffer_load_dwordx4 a[236:239], v2, s[8:11], s58 offen offset:3072 sc1
  v_exp_f32 v126, v126
  v_cvt_pk_bf16_f32 v60, v124, v125
  v_exp_f32 v127, v127
  v_exp_f32 v96, v96
  v_cvt_pk_bf16_f32 v61, v126, v127
  v_exp_f32 v97, v97
  v_exp_f32 v98, v98
  v_mfma_f32_32x32x16_bf16 v[144:159], v[42:45], v[58:61], v[144:159]
  v_cvt_pk_bf16_f32 v54, v96, v97
  v_exp_f32 v99, v99
  v_exp_f32 v100, v100
  v_cvt_pk_bf16_f32 v55, v98, v99
  v_exp_f32 v101, v101
  v_mfma_f32_32x32x16_bf16 v[112:127], v[32:35], v[20:23], v[80:95]
  v_exp_f32 v102, v102
  v_cvt_pk_bf16_f32 v56, v100, v101
  v_exp_f32 v103, v103
  v_exp_f32 v104, v104
  v_mfma_f32_32x32x8_bf16 v[112:127], v[36:37], v[24:25], v[112:127]
  v_cvt_pk_bf16_f32 v57, v102, v103
  v_exp_f32 v105, v105
  v_exp_f32 v106, v106
  v_cvt_pk_bf16_f32 v58, v104, v105
  v_exp_f32 v107, v107
  v_exp_f32 v108, v108
  v_cvt_pk_bf16_f32 v59, v106, v107
  v_exp_f32 v109, v109
  v_mfma_f32_32x32x16_bf16 v[128:143], v[46:49], v[54:57], v[128:143]
  v_exp_f32 v110, v110
  v_cvt_pk_bf16_f32 v60, v108, v109
  v_exp_f32 v111, v111
  v_exp_f32 v112, v112
  v_cvt_pk_bf16_f32 v61, v110, v111
  v_exp_f32 v113, v113
  v_exp_f32 v114, v114
  v_mfma_f32_32x32x16_bf16 v[128:143], v[50:53], v[58:61], v[128:143]
  s_waitcnt lgkmcnt(0)
  v_cvt_pk_bf16_f32 v54, v112, v113
  v_exp_f32 v115, v115
  v_exp_f32 v116, v116
  v_cvt_pk_bf16_f32 v55, v114, v115
  v_exp_f32 v117, v117
  v_exp_f32 v118, v118
  v_cvt_pk_bf16_f32 v56, v116, v117
  v_exp_f32 v119, v119
  v_exp_f32 v120, v120
  v_cvt_pk_bf16_f32 v57, v118, v119
  v_exp_f32 v121, v121
  v_exp_f32 v122, v122
  v_cvt_pk_bf16_f32 v58, v120, v121
  v_exp_f32 v123, v123
  v_exp_f32 v124, v124
  v_cvt_pk_bf16_f32 v59, v122, v123
  v_exp_f32 v125, v125
  v_mfma_f32_32x32x16_bf16 v[144:159], v[46:49], v[54:57], v[144:159]
  v_exp_f32 v126, v126
  v_cvt_pk_bf16_f32 v60, v124, v125
  v_exp_f32 v127, v127
  s_nop 0
  v_cvt_pk_bf16_f32 v61, v126, v127
  s_nop 1
L_fin0_2124:
L_fin_begin:
  v_mfma_f32_32x32x16_bf16 v[144:159], v[50:53], v[58:61], v[144:159]
  v_bfe_u32 v9, v1, 4, 1
  v_mul_u32_u24 v9, 1280, v9
  v_and_b32 v10, 15, v1
  v_lshl_add_u32 v9, v10, 4, v9
  v_lshrrev_b32 v10, 5, v1
  v_lshl_add_u32 v10, v10, 8, v9
  v_rcp_f32 v11, v140
  s_mov_b32 s36, 0x5f800000
  s_mov_b32 s33, s52
  s_nop 5
  s_and_b32 s34, s50, 1
  v_add_f32 v96, v140, v156
  s_lshl_b32 s35, s34, 9
  s_add_u32 s60, s35, s33
  v_cmp_nlt_f32 vcc, v96, s36
  s_lshl_b32 s34, s34, 3
  s_add_u32 s61, s34, s33
  s_add_u32 s62, s60, 2560
  s_add_u32 s63, s61, 2560
  s_cbranch_vccnz L_fb_2125
L_fin_2126:
  v_rcp_f32 v12, v156
  s_waitcnt vmcnt(45)
  v_mul_f32 v128, v128, v11
  v_mul_f32 v129, v129, v11
  v_mul_f32 v130, v130, v11
  v_mul_f32 v131, v131, v11
  v_mul_f32 v132, v132, v11
  v_mul_f32 v133, v133, v11
  v_mul_f32 v134, v134, v11
  v_mul_f32 v135, v135, v11
  v_mul_f32 v136, v136, v11
  v_mul_f32 v137, v137, v11
  v_mul_f32 v138, v138, v11
  v_mul_f32 v139, v139, v11
  v_cvt_pk_bf16_f32 v128, v128, v129
  v_cvt_pk_bf16_f32 v129, v130, v131
  v_cvt_pk_bf16_f32 v130, v132, v133
  v_cvt_pk_bf16_f32 v131, v134, v135
  v_cvt_pk_bf16_f32 v132, v136, v137
  v_cvt_pk_bf16_f32 v133, v138, v139
  v_mul_f32 v144, v144, v12
  v_mul_f32 v145, v145, v12
  v_mul_f32 v146, v146, v12
  v_mul_f32 v147, v147, v12
  v_mul_f32 v148, v148, v12
  v_mul_f32 v149, v149, v12
  v_mul_f32 v150, v150, v12
  v_mul_f32 v151, v151, v12
  v_mul_f32 v152, v152, v12
  v_mul_f32 v153, v153, v12
  v_mul_f32 v154, v154, v12
  v_mul_f32 v155, v155, v12
  v_cvt_pk_bf16_f32 v144, v144, v145
  v_cvt_pk_bf16_f32 v145, v146, v147
  v_cvt_pk_bf16_f32 v146, v148, v149
  v_cvt_pk_bf16_f32 v147, v150, v151
  v_cvt_pk_bf16_f32 v148, v152, v153
  v_cvt_pk_bf16_f32 v149, v154, v155
  buffer_store_dwordx4 v[128:131], v10, s[8:11], s60 offen sc0 sc1
  buffer_store_dwordx4 v[144:147], v10, s[8:11], s62 offen sc0 sc1
  s_mov_b32 exec_hi, 0
  buffer_store_dwordx2 v[132:133], v9, s[8:11], s61 offen offset:1024 sc0 sc1
  buffer_store_dwordx2 v[148:149], v9, s[8:11], s63 offen offset:1024 sc0 sc1
  s_mov_b64 exec, -1
  v_mov_b32 v156, 0x3f803f80
  v_mov_b32 v157, 0x3f803f80
  v_mov_b32 v158, 0x3f803f80
  v_mov_b32 v159, 0x3f803f80
  s_and_b32 s40, s27, 3
  s_lshr_b32 s41, s27, 2
  s_lshl_b32 s42, s26, 2
  s_add_u32 s42, s42, s40
  s_lshl_b32 s42, s42, 2
  s_lshl_b32 s36, s51, 2
  s_add_u32 s36, s36, s28
  s_lshl_b32 s36, s36, 3
  s_add_u32 s36, s36, s26
  s_lshl_b32 s36, s36, 5
  s_add_u32 s36, s36, s40
  s_lshl_b32 s36, s36, 2
  s_add_u32 s43, s36, 32571392
  s_add_u32 s36, s42, s28
  s_lshl_b32 s36, s36, 8
  s_add_u32 s44, s36, 32571392
  v_mfma_f32_16x16x32_bf16 v[136:139], a[0:3], v[156:159], 0
  v_mfma_f32_16x16x32_bf16 v[140:143], a[4:7], v[156:159], 0
  v_mfma_f32_16x16x32_bf16 v[136:139], a[12:15], v[156:159], v[136:139]
  v_mfma_f32_16x16x32_bf16 v[140:143], a[16:19], v[156:159], v[140:143]
  v_mfma_f32_16x16x32_bf16 v[136:139], a[24:27], v[156:159], v[136:139]
  v_mfma_f32_16x16x32_bf16 v[140:143], a[28:31], v[156:159], v[140:143]
  v_mfma_f32_16x16x32_bf16 v[136:139], a[36:39], v[156:159], v[136:139]
  v_mfma_f32_16x16x32_bf16 v[140:143], a[40:43], v[156:159], v[140:143]
  v_mfma_f32_16x16x32_bf16 v[136:139], a[48:51], v[156:159], v[136:139]
  v_mfma_f32_16x16x32_bf16 v[140:143], a[52:55], v[156:159], v[140:143]
  v_mfma_f32_16x16x32_bf16 v[136:139], a[60:63], v[156:159], v[136:139]
  v_mfma_f32_16x16x32_bf16 v[140:143], a[64:67], v[156:159], v[140:143]
  v_mfma_f32_16x16x32_bf16 v[136:139], a[72:75], v[156:159], v[136:139]
  v_mfma_f32_16x16x32_bf16 v[140:143], a[76:79], v[156:159], v[140:143]
  v_mfma_f32_16x16x32_bf16 v[136:139], a[84:87], v[156:159], v[136:139]
  v_mfma_f32_16x16x32_bf16 v[140:143], a[88:91], v[156:159], v[140:143]
  v_mfma_f32_16x16x32_bf16 v[136:139], a[96:99], v[156:159], v[136:139]
  v_mfma_f32_16x16x32_bf16 v[140:143], a[100:103], v[156:159], v[140:143]
  v_mfma_f32_16x16x32_bf16 v[136:139], a[108:111], v[156:159], v[136:139]
  v_mfma_f32_16x16x32_bf16 v[140:143], a[112:115], v[156:159], v[140:143]
  v_mfma_f32_16x16x32_bf16 v[136:139], a[120:123], v[156:159], v[136:139]
  v_mfma_f32_16x16x32_bf16 v[140:143], a[124:127], v[156:159], v[140:143]
  v_mfma_f32_16x16x32_bf16 v[136:139], a[132:135], v[156:159], v[136:139]
  v_mfma_f32_16x16x32_bf16 v[140:143], a[136:139], v[156:159], v[140:143]
  v_mfma_f32_16x16x32_bf16 v[136:139], a[144:147], v[156:159], v[136:139]
  v_mfma_f32_16x16x32_bf16 v[140:143], a[148:151], v[156:159], v[140:143]
  v_mfma_f32_16x16x32_bf16 v[136:139], a[156:159], v[156:159], v[136:139]
  v_mfma_f32_16x16x32_bf16 v[140:143], a[160:163], v[156:159], v[140:143]
  v_mfma_f32_16x16x32_bf16 v[136:139], a[168:171], v[156:159], v[136:139]
  v_mfma_f32_16x16x32_bf16 v[140:143], a[172:175], v[156:159], v[140:143]
  v_mfma_f32_16x16x32_bf16 v[136:139], a[180:183], v[156:159], v[136:139]
  v_mfma_f32_16x16x32_bf16 v[140:143], a[184:187], v[156:159], v[140:143]
  v_mfma_f32_16x16x32_bf16 v[136:139], a[192:195], v[156:159], v[136:139]
  v_mfma_f32_16x16x32_bf16 v[140:143], a[196:199], v[156:159], v[140:143]
  v_mfma_f32_16x16x32_bf16 v[136:139], a[204:207], v[156:159], v[136:139]
  v_mfma_f32_16x16x32_bf16 v[140:143], a[208:211], v[156:159], v[140:143]
  v_mfma_f32_16x16x32_bf16 v[136:139], a[216:219], v[156:159], v[136:139]
  v_mfma_f32_16x16x32_bf16 v[140:143], a[220:223], v[156:159], v[140:143]
  v_mfma_f32_16x16x32_bf16 v[136:139], a[228:231], v[156:159], v[136:139]
  v_mfma_f32_16x16x32_bf16 v[140:143], a[232:235], v[156:159], v[140:143]
  v_mov_b32 v11, s100
  v_mov_b32 v12, 0
  s_mov_b64 exec, 1
  s_waitcnt vmcnt(0)
  buffer_store_dword v11, v12, s[8:11], s43 offen sc0 sc1
  s_mov_b64 exec, -1
  s_mul_i32 s35, s28, 2228224
  s_add_u32 s33, s28, 0
  s_and_b32 s33, s33, 3
  s_add_u32 s33, s33, s42
  s_mul_i32 s33, s33, 1280
  s_add_u32 s60, s33, s35
  s_add_u32 s33, s28, 1
  s_and_b32 s33, s33, 3
  s_add_u32 s33, s33, s42
  s_mul_i32 s33, s33, 1280
  s_add_u32 s61, s33, s35
  s_add_u32 s33, s28, 2
  s_and_b32 s33, s33, 3
  s_add_u32 s33, s33, s42
  s_mul_i32 s33, s33, 1280
  s_add_u32 s62, s33, s35
  s_add_u32 s33, s28, 3
  s_and_b32 s33, s33, 3
  s_add_u32 s33, s33, s42
  s_mul_i32 s33, s33, 1280
  s_add_u32 s63, s33, s35
  v_lshrrev_b32 v9, 4, v1
  s_mov_b32 s33, 162560
  s_mov_b32 s34, 786432
  v_add_u32 v10, 0, v9
  v_mul_u32_u24 v10, 205, v10
  v_lshrrev_b32 v10, 10, v10
  v_mad_u32_u24 v128, v10, s33, v2
  v_lshrrev_b32 v10, 1, v10
  v_mad_u32_u24 v128, v10, s34, v128
  v_add_u32 v10, 4, v9
  v_mul_u32_u24 v10, 205, v10
  v_lshrrev_b32 v10, 10, v10
  v_mad_u32_u24 v129, v10, s33, v2
  v_lshrrev_b32 v10, 1, v10
  v_mad_u32_u24 v129, v10, s34, v129
  v_add_u32 v10, 8, v9
  v_mul_u32_u24 v10, 205, v10
  v_lshrrev_b32 v10, 10, v10
  v_mad_u32_u24 v130, v10, s33, v2
  v_lshrrev_b32 v10, 1, v10
  v_mad_u32_u24 v130, v10, s34, v130
  v_add_u32 v10, 12, v9
  v_mul_u32_u24 v10, 205, v10
  v_lshrrev_b32 v10, 10, v10
  v_mad_u32_u24 v131, v10, s33, v2
  v_lshrrev_b32 v10, 1, v10
  v_mad_u32_u24 v131, v10, s34, v131
  v_add_u32 v10, 16, v9
  v_mul_u32_u24 v10, 205, v10
  v_lshrrev_b32 v10, 10, v10
  v_mad_u32_u24 v132, v10, s33, v2
  v_lshrrev_b32 v10, 1, v10
  v_mad_u32_u24 v132, v10, s34, v132
  v_add_u32 v132, 4096, v132
  s_add_u32 s33, s28, 1
  s_and_b32 s33, s33, 3
  s_mul_i32 s33, s33, 15360
  s_add_u32 s33, s33, 0
  v_add_u32 v3, s33, v2
  s_add_u32 s33, s28, 2
  s_and_b32 s33, s33, 3
  s_mul_i32 s33, s33, 15360
  s_add_u32 s33, s33, 5120
  v_add_u32 v4, s33, v2
  s_add_u32 s33, s28, 3
  s_and_b32 s33, s33, 3
  s_mul_i32 s33, s33, 15360
  s_add_u32 s33, s33, 10240
  v_add_u32 v5, s33, v2
  s_mul_i32 s33, s28, 15360
  v_add_u32 v6, s33, v2
  v_mfma_f32_16x16x32_bf16 v[152:155], a[8:11], v[156:159], 0
  v_mfma_f32_16x16x32_bf16 v[152:155], a[20:23], v[156:159], v[152:155]
  v_mfma_f32_16x16x32_bf16 v[152:155], a[32:35], v[156:159], v[152:155]
  v_mfma_f32_16x16x32_bf16 v[152:155], a[44:47], v[156:159], v[152:155]
  v_mfma_f32_16x16x32_bf16 v[152:155], a[56:59], v[156:159], v[152:155]
  v_mfma_f32_16x16x32_bf16 v[152:155], a[68:71], v[156:159], v[152:155]
  v_mfma_f32_16x16x32_bf16 v[152:155], a[80:83], v[156:159], v[152:155]
  v_mfma_f32_16x16x32_bf16 v[152:155], a[92:95], v[156:159], v[152:155]
  v_mfma_f32_16x16x32_bf16 v[152:155], a[104:107], v[156:159], v[152:155]
  v_mfma_f32_16x16x32_bf16 v[152:155], a[116:119], v[156:159], v[152:155]
  v_mfma_f32_16x16x32_bf16 v[152:155], a[128:131], v[156:159], v[152:155]
  v_mfma_f32_16x16x32_bf16 v[152:155], a[140:143], v[156:159], v[152:155]
  v_mfma_f32_16x16x32_bf16 v[152:155], a[152:155], v[156:159], v[152:155]
  v_mfma_f32_16x16x32_bf16 v[152:155], a[164:167], v[156:159], v[152:155]
  v_mfma_f32_16x16x32_bf16 v[152:155], a[176:179], v[156:159], v[152:155]
  v_mfma_f32_16x16x32_bf16 v[152:155], a[188:191], v[156:159], v[152:155]
  v_mfma_f32_16x16x32_bf16 v[152:155], a[200:203], v[156:159], v[152:155]
  v_mfma_f32_16x16x32_bf16 v[152:155], a[212:215], v[156:159], v[152:155]
  v_mfma_f32_16x16x32_bf16 v[152:155], a[224:227], v[156:159], v[152:155]
  v_mfma_f32_16x16x32_bf16 v[152:155], a[236:239], v[156:159], v[152:155]
  s_barrier
  v_and_b32 v12, 7, v1
  s_mov_b32 s31, 200000
  v_and_b32 v11, 3, v1
  v_and_b32 v12, 4, v1
  v_lshlrev_b32 v12, 5, v12
  v_lshl_add_u32 v12, v11, 2, v12
L_poll_2127:
  buffer_load_dword v11, v12, s[8:11], s44 offen sc1
  s_sub_u32 s31, s31, 1
  s_waitcnt vmcnt(0)
  v_cmp_ne_u32 vcc, s100, v11
  s_cbranch_scc1 L_pout_2128
  s_cbranch_vccnz L_poll_2127
L_pout_2128:
  buffer_load_dwordx4 v[14:17], v128, s[8:11], s61 offen offset:0 sc1
  buffer_load_dwordx4 v[18:21], v129, s[8:11], s61 offen offset:1024 sc1
  buffer_load_dwordx4 v[22:25], v130, s[8:11], s61 offen offset:2048 sc1
  buffer_load_dwordx4 v[26:29], v131, s[8:11], s61 offen offset:3072 sc1
  buffer_load_dwordx4 v[30:33], v132, s[8:11], s61 offen offset:0 sc1
  buffer_load_dwordx4 v[34:37], v128, s[8:11], s62 offen offset:0 sc1
  v_and_b32 v9, 15, v1
  v_lshrrev_b32 v10, 5, v1
  v_mul_u32_u24 v10, 1280, v10
  v_lshl_add_u32 v125, v9, 4, v10
  v_bfe_u32 v10, v1, 4, 1
  v_lshl_add_u32 v124, v10, 9, v125
  v_lshl_add_u32 v125, v10, 3, v125
  v_lshlrev_b32 v126, 4, v9
  s_add_u32 s33, s42, s28
  s_mul_i32 s34, s33, 20480
  s_mul_i32 s35, s41, 2560
  s_add_u32 s45, s34, s35
  s_lshl_b32 s34, s33, 10
  s_mul_i32 s35, s41, 136
  s_and_b32 s35, s35, 0x308
  s_add_u32 s34, s34, s35
  s_add_u32 s46, s34, 31457280
  s_lshl_b32 s33, s33, 3
  s_add_u32 s33, s33, s41
  s_lshl_b32 s33, s33, 2
  s_add_u32 s43, s33, 32510976
  s_waitcnt vmcnt(5)
  v_mfma_f32_16x16x32_bf16 v[64:67], a[240:243], v[14:17], 0
  buffer_load_dwordx4 v[38:41], v129, s[8:11], s62 offen offset:1024 sc1
  v_mfma_f32_16x16x32_bf16 v[68:71], a[244:247], v[14:17], 0
  v_mfma_f32_16x16x32_bf16 v[72:75], a[248:251], v[14:17], 0
  v_mfma_f32_16x16x32_bf16 v[76:79], a[252:255], v[14:17], 0
  v_mfma_f32_16x16x32_bf16 v[80:83], v[160:163], v[14:17], 0
  s_waitcnt vmcnt(5)
  v_mfma_f32_16x16x32_bf16 v[64:67], v[164:167], v[18:21], v[64:67]
  buffer_load_dwordx4 v[42:45], v130, s[8:11], s62 offen offset:2048 sc1
  v_mfma_f32_16x16x32_bf16 v[68:71], v[168:171], v[18:21], v[68:71]
  v_mfma_f32_16x16x32_bf16 v[72:75], v[172:175], v[18:21], v[72:75]
  v_mfma_f32_16x16x32_bf16 v[76:79], v[176:179], v[18:21], v[76:79]
  v_mfma_f32_16x16x32_bf16 v[80:83], v[180:183], v[18:21], v[80:83]
  s_waitcnt vmcnt(5)
  v_mfma_f32_16x16x32_bf16 v[64:67], v[184:187], v[22:25], v[64:67]
  buffer_load_dwordx4 v[46:49], v131, s[8:11], s62 offen offset:3072 sc1
  v_mfma_f32_16x16x32_bf16 v[68:71], v[188:191], v[22:25], v[68:71]
  v_mfma_f32_16x16x32_bf16 v[72:75], v[192:195], v[22:25], v[72:75]
  v_mfma_f32_16x16x32_bf16 v[76:79], v[196:199], v[22:25], v[76:79]
  v_mfma_f32_16x16x32_bf16 v[80:83], v[200:203], v[22:25], v[80:83]
  s_waitcnt vmcnt(5)
  v_mfma_f32_16x16x32_bf16 v[64:67], v[204:207], v[26:29], v[64:67]
  buffer_load_dwordx4 v[50:53], v132, s[8:11], s62 offen offset:0 sc1
  v_mfma_f32_16x16x32_bf16 v[68:71], v[208:211], v[26:29], v[68:71]
  v_mfma_f32_16x16x32_bf16 v[72:75], v[212:215], v[26:29], v[72:75]
  v_mfma_f32_16x16x32_bf16 v[76:79], v[216:219], v[26:29], v[76:79]
  v_mfma_f32_16x16x32_bf16 v[80:83], v[220:223], v[26:29], v[80:83]
  s_waitcnt vmcnt(5)
  v_mfma_f32_16x16x32_bf16 v[64:67], v[224:227], v[30:33], v[64:67]
  buffer_load_dwordx4 v[54:57], v128, s[8:11], s63 offen offset:0 sc1
  v_mfma_f32_16x16x32_bf16 v[68:71], v[228:231], v[30:33], v[68:71]
  v_mfma_f32_16x16x32_bf16 v[72:75], v[232:235], v[30:33], v[72:75]
  v_mfma_f32_16x16x32_bf16 v[76:79], v[236:239], v[30:33], v[76:79]
  v_mfma_f32_16x16x32_bf16 v[80:83], v[240:243], v[30:33], v[80:83]
  s_waitcnt vmcnt(5)
  v_mfma_f32_16x16x32_bf16 v[84:87], a[240:243], v[34:37], 0
  buffer_load_dwordx4 v[58:61], v129, s[8:11], s63 offen offset:1024 sc1
  v_mfma_f32_16x16x32_bf16 v[88:91], a[244:247], v[34:37], 0
  v_mfma_f32_16x16x32_bf16 v[92:95], a[248:251], v[34:37], 0
  v_mfma_f32_16x16x32_bf16 v[96:99], a[252:255], v[34:37], 0
  v_mfma_f32_16x16x32_bf16 v[100:103], v[160:163], v[34:37], 0
  s_waitcnt vmcnt(5)
  v_mfma_f32_16x16x32_bf16 v[84:87], v[164:167], v[38:41], v[84:87]
  buffer_load_dwordx4 v[14:17], v130, s[8:11], s63 offen offset:2048 sc1
  v_mfma_f32_16x16x32_bf16 v[88:91], v[168:171], v[38:41], v[88:91]
  v_mfma_f32_16x16x32_bf16 v[92:95], v[172:175], v[38:41], v[92:95]
  v_mfma_f32_16x16x32_bf16 v[96:99], v[176:179], v[38:41], v[96:99]
  v_mfma_f32_16x16x32_bf16 v[100:103], v[180:183], v[38:41], v[100:103]
  s_waitcnt vmcnt(5)
  v_mfma_f32_16x16x32_bf16 v[84:87], v[184:187], v[42:45], v[84:87]
  buffer_load_dwordx4 v[18:21], v131, s[8:11], s63 offen offset:3072 sc1
  ds_write_b128 v3, v[64:67] offset:0
  v_mfma_f32_16x16x32_bf16 v[88:91], v[188:191], v[42:45], v[88:91]
  ds_write_b128 v3, v[68:71] offset:1024
  v_mfma_f32_16x16x32_bf16 v[92:95], v[192:195], v[42:45], v[92:95]
  ds_write_b128 v3, v[72:75] offset:2048
  v_mfma_f32_16x16x32_bf16 v[96:99], v[196:199], v[42:45], v[96:99]
  ds_write_b128 v3, v[76:79] offset:3072
  v_mfma_f32_16x16x32_bf16 v[100:103], v[200:203], v[42:45], v[100:103]
  ds_write_b128 v3, v[80:83] offset:4096
  s_waitcnt vmcnt(5)
  v_mfma_f32_16x16x32_bf16 v[84:87], v[204:207], v[46:49], v[84:87]
  buffer_load_dwordx4 v[22:25], v132, s[8:11], s63 offen offset:0 sc1
  v_mfma_f32_16x16x32_bf16 v[88:91], v[208:211], v[46:49], v[88:91]
  v_mfma_f32_16x16x32_bf16 v[92:95], v[212:215], v[46:49], v[92:95]
  v_mfma_f32_16x16x32_bf16 v[96:99], v[216:219], v[46:49], v[96:99]
  v_mfma_f32_16x16x32_bf16 v[100:103], v[220:223], v[46:49], v[100:103]
  s_waitcnt vmcnt(5)
  v_mfma_f32_16x16x32_bf16 v[84:87], v[224:227], v[50:53], v[84:87]
  buffer_load_dwordx4 v[26:29], v128, s[8:11], s60 offen offset:0 sc1
  v_mfma_f32_16x16x32_bf16 v[88:91], v[228:231], v[50:53], v[88:91]
  v_mfma_f32_16x16x32_bf16 v[92:95], v[232:235], v[50:53], v[92:95]
  v_mfma_f32_16x16x32_bf16 v[96:99], v[236:239], v[50:53], v[96:99]
  v_mfma_f32_16x16x32_bf16 v[100:103], v[240:243], v[50:53], v[100:103]
  s_waitcnt vmcnt(5)
  v_mfma_f32_16x16x32_bf16 v[104:107], a[240:243], v[54:57], 0
  v_lshlrev_b32 v64, 16, v244
  v_and_b32 v65, 0xffff0000, v244
  buffer_load_dwordx4 v[30:33], v129, s[8:11], s60 offen offset:1024 sc1
  v_mfma_f32_16x16x32_bf16 v[108:111], a[244:247], v[54:57], 0
  v_lshlrev_b32 v66, 16, v245
  v_and_b32 v67, 0xffff0000, v245
  v_mfma_f32_16x16x32_bf16 v[112:115], a[248:251], v[54:57], 0
  v_lshlrev_b32 v68, 16, v246
  v_and_b32 v69, 0xffff0000, v246
  v_mfma_f32_16x16x32_bf16 v[116:119], a[252:255], v[54:57], 0
  v_lshlrev_b32 v70, 16, v247
  v_and_b32 v71, 0xffff0000, v247
  v_mfma_f32_16x16x32_bf16 v[120:123], v[160:163], v[54:57], 0
  v_lshlrev_b32 v72, 16, v248
  v_and_b32 v73, 0xffff0000, v248
  s_waitcnt vmcnt(5)
  v_mfma_f32_16x16x32_bf16 v[104:107], v[164:167], v[58:61], v[104:107]
  v_lshlrev_b32 v74, 16, v249
  v_and_b32 v75, 0xffff0000, v249
  buffer_load_dwordx4 v[34:37], v130, s[8:11], s60 offen offset:2048 sc1
  v_mfma_f32_16x16x32_bf16 v[108:111], v[168:171], v[58:61], v[108:111]
  v_lshlrev_b32 v76, 16, v250
  v_and_b32 v77, 0xffff0000, v250
  v_mfma_f32_16x16x32_bf16 v[112:115], v[172:175], v[58:61], v[112:115]
  v_lshlrev_b32 v78, 16, v251
  v_and_b32 v79, 0xffff0000, v251
  v_mfma_f32_16x16x32_bf16 v[116:119], v[176:179], v[58:61], v[116:119]
  v_lshlrev_b32 v80, 16, v252
  v_and_b32 v81, 0xffff0000, v252
  v_mfma_f32_16x16x32_bf16 v[120:123], v[180:183], v[58:61], v[120:123]
  v_lshlrev_b32 v82, 16, v253
  v_and_b32 v83, 0xffff0000, v253
  s_waitcnt vmcnt(5)
  v_mfma_f32_16x16x32_bf16 v[104:107], v[184:187], v[14:17], v[104:107]
  buffer_load_dwordx4 v[38:41], v131, s[8:11], s60 offen offset:3072 sc1
  ds_write_b128 v4, v[84:87] offset:0
  v_mfma_f32_16x16x32_bf16 v[108:111], v[188:191], v[14:17], v[108:111]
  ds_write_b128 v4, v[88:91] offset:1024
  v_mfma_f32_16x16x32_bf16 v[112:115], v[192:195], v[14:17], v[112:115]
  ds_write_b128 v4, v[92:95] offset:2048
  v_mfma_f32_16x16x32_bf16 v[116:119], v[196:199], v[14:17], v[116:119]
  ds_write_b128 v4, v[96:99] offset:3072
  v_mfma_f32_16x16x32_bf16 v[120:123], v[200:203], v[14:17], v[120:123]
  ds_write_b128 v4, v[100:103] offset:4096
  s_waitcnt vmcnt(5)
  v_mfma_f32_16x16x32_bf16 v[104:107], v[204:207], v[18:21], v[104:107]
  buffer_load_dwordx4 v[42:45], v132, s[8:11], s60 offen offset:0 sc1
  v_mfma_f32_16x16x32_bf16 v[108:111], v[208:211], v[18:21], v[108:111]
  v_mfma_f32_16x16x32_bf16 v[112:115], v[212:215], v[18:21], v[112:115]
  v_mfma_f32_16x16x32_bf16 v[116:119], v[216:219], v[18:21], v[116:119]
  v_mfma_f32_16x16x32_bf16 v[120:123], v[220:223], v[18:21], v[120:123]
  s_waitcnt vmcnt(5)
  v_mfma_f32_16x16x32_bf16 v[104:107], v[224:227], v[22:25], v[104:107]
  v_mfma_f32_16x16x32_bf16 v[108:111], v[228:231], v[22:25], v[108:111]
  v_mfma_f32_16x16x32_bf16 v[112:115], v[232:235], v[22:25], v[112:115]
  v_mfma_f32_16x16x32_bf16 v[116:119], v[236:239], v[22:25], v[116:119]
  v_mfma_f32_16x16x32_bf16 v[120:123], v[240:243], v[22:25], v[120:123]
  s_waitcnt vmcnt(4)
  v_mfma_f32_16x16x32_bf16 v[64:67], a[240:243], v[26:29], v[64:67]
  v_mfma_f32_16x16x32_bf16 v[68:71], a[244:247], v[26:29], v[68:71]
  v_mfma_f32_16x16x32_bf16 v[72:75], a[248:251], v[26:29], v[72:75]
  v_mfma_f32_16x16x32_bf16 v[76:79], a[252:255], v[26:29], v[76:79]
  v_mfma_f32_16x16x32_bf16 v[80:83], v[160:163], v[26:29], v[80:83]
  s_waitcnt vmcnt(3)
  v_mfma_f32_16x16x32_bf16 v[64:67], v[164:167], v[30:33], v[64:67]
  v_mfma_f32_16x16x32_bf16 v[68:71], v[168:171], v[30:33], v[68:71]
  v_mfma_f32_16x16x32_bf16 v[72:75], v[172:175], v[30:33], v[72:75]
  v_mfma_f32_16x16x32_bf16 v[76:79], v[176:179], v[30:33], v[76:79]
  v_mfma_f32_16x16x32_bf16 v[80:83], v[180:183], v[30:33], v[80:83]
  s_waitcnt vmcnt(2)
  v_mfma_f32_16x16x32_bf16 v[64:67], v[184:187], v[34:37], v[64:67]
  ds_write_b128 v5, v[104:107] offset:0
  v_mfma_f32_16x16x32_bf16 v[68:71], v[188:191], v[34:37], v[68:71]
  ds_write_b128 v5, v[108:111] offset:1024
  v_mfma_f32_16x16x32_bf16 v[72:75], v[192:195], v[34:37], v[72:75]
  ds_write_b128 v5, v[112:115] offset:2048
  v_mfma_f32_16x16x32_bf16 v[76:79], v[196:199], v[34:37], v[76:79]
  ds_write_b128 v5, v[116:119] offset:3072
  v_mfma_f32_16x16x32_bf16 v[80:83], v[200:203], v[34:37], v[80:83]
  ds_write_b128 v5, v[120:123] offset:4096
  s_waitcnt vmcnt(1)
  v_mfma_f32_16x16x32_bf16 v[64:67], v[204:207], v[38:41], v[64:67]
  v_mfma_f32_16x16x32_bf16 v[68:71], v[208:211], v[38:41], v[68:71]
  v_mfma_f32_16x16x32_bf16 v[72:75], v[212:215], v[38:41], v[72:75]
  v_mfma_f32_16x16x32_bf16 v[76:79], v[216:219], v[38:41], v[76:79]
  v_mfma_f32_16x16x32_bf16 v[80:83], v[220:223], v[38:41], v[80:83]
  s_waitcnt lgkmcnt(0)
  s_barrier
  s_waitcnt vmcnt(0)
  v_mfma_f32_16x16x32_bf16 v[64:67], v[224:227], v[42:45], v[64:67]
  ds_read_b128 v[160:163], v6 offset:0
  ds_read_b128 v[164:167], v6 offset:1024
  ds_read_b128 v[168:171], v6 offset:2048
  v_mfma_f32_16x16x32_bf16 v[68:71], v[228:231], v[42:45], v[68:71]
  ds_read_b128 v[172:175], v6 offset:3072
  ds_read_b128 v[176:179], v6 offset:4096
  ds_read_b128 v[180:183], v6 offset:5120
  v_mfma_f32_16x16x32_bf16 v[72:75], v[232:235], v[42:45], v[72:75]
  ds_read_b128 v[184:187], v6 offset:6144
  ds_read_b128 v[188:191], v6 offset:7168
  ds_read_b128 v[192:195], v6 offset:8192
  v_mfma_f32_16x16x32_bf16 v[76:79], v[236:239], v[42:45], v[76:79]
  ds_read_b128 v[196:199], v6 offset:9216
  ds_read_b128 v[200:203], v6 offset:10240
  ds_read_b128 v[204:207], v6 offset:11264
  v_mfma_f32_16x16x32_bf16 v[80:83], v[240:243], v[42:45], v[80:83]
  ds_read_b128 v[208:211], v6 offset:12288
  ds_read_b128 v[212:215], v6 offset:13312
  ds_read_b128 v[216:219], v6 offset:14336
  s_waitcnt lgkmcnt(5)
  v_pk_add_f32 v[160:161], v[160:161], v[180:181]
  v_pk_add_f32 v[162:163], v[162:163], v[182:183]
  v_pk_add_f32 v[164:165], v[164:165], v[184:185]
  v_pk_add_f32 v[166:167], v[166:167], v[186:187]
  v_pk_add_f32 v[168:169], v[168:169], v[188:189]
  v_pk_add_f32 v[170:171], v[170:171], v[190:191]
  v_pk_add_f32 v[172:173], v[172:173], v[192:193]
  v_pk_add_f32 v[174:175], v[174:175], v[194:195]
  v_pk_add_f32 v[176:177], v[176:177], v[196:197]
  v_pk_add_f32 v[178:179], v[178:179], v[198:199]
  s_waitcnt lgkmcnt(0)
  v_pk_add_f32 v[64:65], v[64:65], v[200:201]
  v_pk_add_f32 v[66:67], v[66:67], v[202:203]
  v_pk_add_f32 v[68:69], v[68:69], v[204:205]
  v_pk_add_f32 v[70:71], v[70:71], v[206:207]
  v_pk_add_f32 v[72:73], v[72:73], v[208:209]
  v_pk_add_f32 v[74:75], v[74:75], v[210:211]
  v_pk_add_f32 v[76:77], v[76:77], v[212:213]
  v_pk_add_f32 v[78:79], v[78:79], v[214:215]
  v_pk_add_f32 v[80:81], v[80:81], v[216:217]
  v_pk_add_f32 v[82:83], v[82:83], v[218:219]
  v_pk_add_f32 v[64:65], v[64:65], v[160:161]
  v_pk_add_f32 v[66:67], v[66:67], v[162:163]
  v_pk_add_f32 v[68:69], v[68:69], v[164:165]
  v_pk_add_f32 v[70:71], v[70:71], v[166:167]
  v_pk_add_f32 v[72:73], v[72:73], v[168:169]
  v_pk_add_f32 v[74:75], v[74:75], v[170:171]
  v_pk_add_f32 v[76:77], v[76:77], v[172:173]
  v_pk_add_f32 v[78:79], v[78:79], v[174:175]
  v_pk_add_f32 v[80:81], v[80:81], v[176:177]
  v_pk_add_f32 v[82:83], v[82:83], v[178:179]
  v_cvt_pk_bf16_f32 v244, v64, v65
  v_cvt_pk_bf16_f32 v245, v66, v67
  v_cvt_pk_bf16_f32 v246, v68, v69
  v_cvt_pk_bf16_f32 v247, v70, v71
  v_cvt_pk_bf16_f32 v248, v72, v73
  v_cvt_pk_bf16_f32 v249, v74, v75
  v_cvt_pk_bf16_f32 v250, v76, v77
  v_cvt_pk_bf16_f32 v251, v78, v79
  v_cvt_pk_bf16_f32 v252, v80, v81
  v_cvt_pk_bf16_f32 v253, v82, v83
  s_cmp_eq_u32 s30, 0
  s_cbranch_scc1 L_wt_2129
  buffer_store_dwordx4 v[244:247], v124, s[16:19], s45 offen
  buffer_store_dwordx4 v[248:251], v124, s[16:19], s45 offen offset:256
  buffer_store_dwordx2 v[252:253], v125, s[16:19], s45 offen offset:1024
L_wj_2130:
  v_pk_add_f32 v[14:15], v[64:65], v[66:67]
  v_pk_mul_f32 v[16:17], v[64:65], v[64:65]
  v_pk_fma_f32 v[16:17], v[66:67], v[66:67], v[16:17]
  v_pk_add_f32 v[14:15], v[14:15], v[68:69]
  v_pk_fma_f32 v[16:17], v[68:69], v[68:69], v[16:17]
  v_pk_add_f32 v[14:15], v[14:15], v[70:71]
  v_pk_fma_f32 v[16:17], v[70:71], v[70:71], v[16:17]
  v_pk_add_f32 v[14:15], v[14:15], v[72:73]
  v_pk_fma_f32 v[16:17], v[72:73], v[72:73], v[16:17]
  v_pk_add_f32 v[14:15], v[14:15], v[74:75]
  v_pk_fma_f32 v[16:17], v[74:75], v[74:75], v[16:17]
  v_pk_add_f32 v[14:15], v[14:15], v[76:77]
  v_pk_fma_f32 v[16:17], v[76:77], v[76:77], v[16:17]
  v_pk_add_f32 v[14:15], v[14:15], v[78:79]
  v_pk_fma_f32 v[16:17], v[78:79], v[78:79], v[16:17]
  v_pk_add_f32 v[14:15], v[14:15], v[80:81]
  v_pk_fma_f32 v[16:17], v[80:81], v[80:81], v[16:17]
  v_pk_add_f32 v[14:15], v[14:15], v[82:83]
  v_pk_fma_f32 v[16:17], v[82:83], v[82:83], v[16:17]
  v_add_f32 v14, v14, v15
  v_add_f32 v15, v16, v17
  v_mov_b32 v16, v14
  v_mov_b32 v17, v15
  s_nop 1
  v_permlane32_swap_b32 v16, v14
  v_permlane32_swap_b32 v17, v15
  s_nop 1
  v_pk_add_f32 v[14:15], v[14:15], v[16:17]
  v_mov_b32 v16, v14
  v_mov_b32 v17, v15
  s_nop 1
  v_permlane16_swap_b32 v16, v14
  v_permlane16_swap_b32 v17, v15
  s_nop 1
  v_pk_add_f32 v[14:15], v[14:15], v[16:17]
  s_mov_b64 exec, 0xffff
  s_cmp_eq_u32 s30, 0
  s_cbranch_scc1 L_wt_2131
  buffer_store_dwordx2 v[14:15], v126, s[8:11], s46 offen
L_wj_2132:
  s_mov_b64 exec, -1
  s_bfe_u32 s51, s27, 0x10001
  s_lshl_b32 s33, s26, 1
  s_add_u32 s51, s51, s33
  s_lshl_b32 s50, s41, 1
  s_and_b32 s33, s27, 1
  s_add_u32 s50, s50, s33
  s_lshl_b32 s50, s50, 2
  s_add_u32 s50, s50, s28
  s_lshl_b32 s33, s51, 8
  s_lshl_b32 s34, s28, 6
  s_add_u32 s33, s33, s34
  s_add_u32 s44, s33, 32510976
  s_mul_i32 s48, s28, 40960
  s_add_u32 s49, s48, 20480
  s_mul_i32 s33, s51, 163840
  v_mov_b32 v11, s100
  v_mov_b32 v12, 0
  s_mov_b64 exec, 1
  s_waitcnt vmcnt(0)
  s_cmp_eq_u32 s30, 0
  s_cbranch_scc1 L_wt_2133
  buffer_store_dword v11, v12, s[8:11], s43 offen
L_wj_2134:
  s_mov_b64 exec, -1
  s_add_u32 s45, s48, s33
  s_add_u32 s46, s49, s33
  s_mul_i32 s47, s41, 245760
  s_mul_i32 s33, s28, 61440
  s_add_u32 s47, s47, s33
  s_add_u32 s47, s47, 28311552
  s_add_u32 s52, s47, 57344
  v_add_u32 v92, 0, v2
  v_add_u32 v93, 61440, v2
  v_add_u32 v94, 122880, v2
  v_and_b32 v9, 15, v1
  v_lshrrev_b32 v10, 4, v1
  v_add_u32 v8, 4096, v2
  v_mul_u32_u24 v95, 49152, v10
  v_lshl_add_u32 v95, v9, 4, v95
  s_barrier
  v_and_b32 v12, 15, v1
  s_mov_b32 s31, 200000
  v_lshlrev_b32 v12, 2, v12
L_poll_2135:
  buffer_load_dword v11, v12, s[8:11], s44 offen sc1
  s_sub_u32 s31, s31, 1
  s_waitcnt vmcnt(0)
  v_cmp_ne_u32 vcc, s100, v11
  s_cbranch_scc1 L_pout_2136
  s_cbranch_vccnz L_poll_2135
L_pout_2136:
  s_mov_b32 m0, s48
  s_nop 0
  buffer_load_dwordx4 v2, s[16:19], s45 offen offset:0 sc1 lds
  buffer_load_dwordx4 v2, s[16:19], s45 offen offset:1024 sc1 lds
  s_mov_b32 m0, s49
  s_nop 0
  buffer_load_dwordx4 v2, s[16:19], s46 offen offset:0 sc1 lds
  buffer_load_dwordx4 v2, s[16:19], s46 offen offset:1024 sc1 lds
  s_mov_b32 m0, s48
  s_nop 0
  buffer_load_dwordx4 v2, s[16:19], s45 offen offset:2048 sc1 lds
  buffer_load_dwordx4 v2, s[16:19], s45 offen offset:3072 sc1 lds
  s_add_u32 s45, s45, 4096
  s_add_u32 s48, s48, 4096
  s_mov_b32 m0, s49
  s_nop 0
  buffer_load_dwordx4 v2, s[16:19], s46 offen offset:2048 sc1 lds
  buffer_load_dwordx4 v2, s[16:19], s46 offen offset:3072 sc1 lds
  s_add_u32 s46, s46, 4096
  s_add_u32 s49, s49, 4096
  s_mov_b32 m0, s48
  s_nop 0
  buffer_load_dwordx4 v2, s[16:19], s45 offen offset:0 sc1 lds
  buffer_load_dwordx4 v2, s[16:19], s45 offen offset:1024 sc1 lds
  s_mov_b32 m0, s49
  s_nop 0
  buffer_load_dwordx4 v2, s[16:19], s46 offen offset:0 sc1 lds
  buffer_load_dwordx4 v2, s[16:19], s46 offen offset:1024 sc1 lds
  s_lshl_b32 s33, s51, 13
  s_add_u32 s33, s33, 31457280
  s_waitcnt vmcnt(8)
  s_barrier
  ds_read_b128 v[14:17], v92 offset:0
  ds_read_b128 v[18:21], v92 offset:20480
  ds_read_b128 v[22:25], v92 offset:40960
  ds_read_b128 v[26:29], v93 offset:0
  ds_read_b128 v[30:33], v93 offset:20480
  ds_read_b128 v[34:37], v93 offset:40960
  ds_read_b128 v[38:41], v94 offset:0
  ds_read_b128 v[42:45], v94 offset:20480
  v_and_b32 v9, 7, v1
  v_lshlrev_b32 v9, 12, v9
  s_lshl_b32 s36, s28, 3
  s_add_u32 s36, s36, s26
  s_lshl_b32 s36, s36, 7
  s_add_u32 s36, s36, 32571392
  s_waitcnt lgkmcnt(0)
  v_mfma_f32_16x16x32_bf16 v[160:163], a[0:3], v[14:17], 0
  ds_read_b128 v[46:49], v92 offset:1024
  v_mfma_f32_16x16x32_bf16 v[164:167], a[4:7], v[14:17], 0
  ds_read_b128 v[50:53], v92 offset:21504
  v_mfma_f32_16x16x32_bf16 v[168:171], a[8:11], v[14:17], 0
  ds_read_b128 v[54:57], v92 offset:41984
  v_mfma_f32_16x16x32_bf16 v[172:175], a[0:3], v[18:21], 0
  ds_read_b128 v[58:61], v93 offset:1024
  v_mfma_f32_16x16x32_bf16 v[176:179], a[4:7], v[18:21], 0
  ds_read_b128 v[62:65], v93 offset:21504
  v_mfma_f32_16x16x32_bf16 v[180:183], a[8:11], v[18:21], 0
  ds_read_b128 v[66:69], v93 offset:41984
  v_mfma_f32_16x16x32_bf16 v[184:187], a[0:3], v[22:25], 0
  ds_read_b128 v[70:73], v94 offset:1024
  v_mfma_f32_16x16x32_bf16 v[188:191], a[4:7], v[22:25], 0
  ds_read_b128 v[74:77], v94 offset:21504
  v_mfma_f32_16x16x32_bf16 v[192:195], a[8:11], v[22:25], 0
  s_mov_b32 m0, s48
  s_nop 0
  buffer_load_dwordx4 v2, s[16:19], s45 offen offset:2048 sc1 lds
  v_mfma_f32_16x16x32_bf16 v[196:199], a[0:3], v[26:29], 0
  v_mfma_f32_16x16x32_bf16 v[200:203], a[4:7], v[26:29], 0
  v_mfma_f32_16x16x32_bf16 v[204:207], a[8:11], v[26:29], 0
  v_mfma_f32_16x16x32_bf16 v[208:211], a[0:3], v[30:33], 0
  buffer_load_dwordx4 v2, s[16:19], s45 offen offset:3072 sc1 lds
  s_add_u32 s45, s45, 4096
  s_add_u32 s48, s48, 4096
  v_mfma_f32_16x16x32_bf16 v[212:215], a[4:7], v[30:33], 0
  v_mfma_f32_16x16x32_bf16 v[216:219], a[8:11], v[30:33], 0
  v_mfma_f32_16x16x32_bf16 v[220:223], a[0:3], v[34:37], 0
  v_mfma_f32_16x16x32_bf16 v[224:227], a[4:7], v[34:37], 0
  s_mov_b32 m0, s49
  s_nop 0
  buffer_load_dwordx4 v2, s[16:19], s46 offen offset:2048 sc1 lds
  v_mfma_f32_16x16x32_bf16 v[228:231], a[8:11], v[34:37], 0
  v_mfma_f32_16x16x32_bf16 v[232:235], a[0:3], v[38:41], 0
  v_mfma_f32_16x16x32_bf16 v[236:239], a[4:7], v[38:41], 0
  v_mfma_f32_16x16x32_bf16 v[240:243], a[8:11], v[38:41], 0
  buffer_load_dwordx4 v2, s[16:19], s46 offen offset:3072 sc1 lds
  s_add_u32 s46, s46, 4096
  s_add_u32 s49, s49, 4096
  v_mfma_f32_16x16x32_bf16 v[80:83], a[0:3], v[42:45], 0
  v_mfma_f32_16x16x32_bf16 v[84:87], a[4:7], v[42:45], 0
  v_mfma_f32_16x16x32_bf16 v[88:91], a[8:11], v[42:45], 0
  s_waitcnt lgkmcnt(0)
  v_mfma_f32_16x16x32_bf16 v[160:163], a[12:15], v[46:49], v[160:163]
  v_mfma_f32_16x16x32_bf16 v[164:167], a[16:19], v[46:49], v[164:167]
  s_waitcnt vmcnt(4)
  s_barrier
  v_mfma_f32_16x16x32_bf16 v[168:171], a[20:23], v[46:49], v[168:171]
  ds_read_b128 v[14:17], v92 offset:2048
  v_mfma_f32_16x16x32_bf16 v[172:175], a[12:15], v[50:53], v[172:175]
  ds_read_b128 v[18:21], v92 offset:22528
  v_mfma_f32_16x16x32_bf16 v[176:179], a[16:19], v[50:53], v[176:179]
  ds_read_b128 v[22:25], v92 offset:43008
  v_mfma_f32_16x16x32_bf16 v[180:183], a[20:23], v[50:53], v[180:183]
  ds_read_b128 v[26:29], v93 offset:2048
  v_mfma_f32_16x16x32_bf16 v[184:187], a[12:15], v[54:57], v[184:187]
  ds_read_b128 v[30:33], v93 offset:22528
  v_mfma_f32_16x16x32_bf16 v[188:191], a[16:19], v[54:57], v[188:191]
  ds_read_b128 v[34:37], v93 offset:43008
  v_mfma_f32_16x16x32_bf16 v[192:195], a[20:23], v[54:57], v[192:195]
  ds_read_b128 v[38:41], v94 offset:2048
  v_mfma_f32_16x16x32_bf16 v[196:199], a[12:15], v[58:61], v[196:199]
  ds_read_b128 v[42:45], v94 offset:22528
  v_mfma_f32_16x16x32_bf16 v[200:203], a[16:19], v[58:61], v[200:203]
  s_mov_b32 m0, s48
  s_nop 0
  buffer_load_dwordx4 v2, s[16:19], s45 offen offset:0 sc1 lds
  v_mfma_f32_16x16x32_bf16 v[204:207], a[20:23], v[58:61], v[204:207]
  v_mfma_f32_16x16x32_bf16 v[208:211], a[12:15], v[62:65], v[208:211]
  v_mfma_f32_16x16x32_bf16 v[212:215], a[16:19], v[62:65], v[212:215]
  v_mfma_f32_16x16x32_bf16 v[216:219], a[20:23], v[62:65], v[216:219]
  buffer_load_dwordx4 v2, s[16:19], s45 offen offset:1024 sc1 lds
  v_mfma_f32_16x16x32_bf16 v[220:223], a[12:15], v[66:69], v[220:223]
  v_mfma_f32_16x16x32_bf16 v[224:227], a[16:19], v[66:69], v[224:227]
  v_mfma_f32_16x16x32_bf16 v[228:231], a[20:23], v[66:69], v[228:231]
  s_mov_b32 m0, s49
  s_nop 0
  buffer_load_dwordx4 v2, s[16:19], s46 offen offset:0 sc1 lds
  v_mfma_f32_16x16x32_bf16 v[232:235], a[12:15], v[70:73], v[232:235]
  v_mfma_f32_16x16x32_bf16 v[236:239], a[16:19], v[70:73], v[236:239]
  v_mfma_f32_16x16x32_bf16 v[240:243], a[20:23], v[70:73], v[240:243]
  v_mfma_f32_16x16x32_bf16 v[80:83], a[12:15], v[74:77], v[80:83]
  buffer_load_dwordx4 v2, s[16:19], s46 offen offset:1024 sc1 lds
  v_mfma_f32_16x16x32_bf16 v[84:87], a[16:19], v[74:77], v[84:87]
  v_mfma_f32_16x16x32_bf16 v[88:91], a[20:23], v[74:77], v[88:91]
  s_waitcnt lgkmcnt(0)
  v_mfma_f32_16x16x32_bf16 v[160:163], a[24:27], v[14:17], v[160:163]
  ds_read_b128 v[46:49], v92 offset:3072
  v_mfma_f32_16x16x32_bf16 v[164:167], a[28:31], v[14:17], v[164:167]
  ds_read_b128 v[50:53], v92 offset:23552
  v_mfma_f32_16x16x32_bf16 v[168:171], a[32:35], v[14:17], v[168:171]
  ds_read_b128 v[54:57], v92 offset:44032
  v_mfma_f32_16x16x32_bf16 v[172:175], a[24:27], v[18:21], v[172:175]
  ds_read_b128 v[58:61], v93 offset:3072
  v_mfma_f32_16x16x32_bf16 v[176:179], a[28:31], v[18:21], v[176:179]
  ds_read_b128 v[62:65], v93 offset:23552
  v_mfma_f32_16x16x32_bf16 v[180:183], a[32:35], v[18:21], v[180:183]
  ds_read_b128 v[66:69], v93 offset:44032
  v_mfma_f32_16x16x32_bf16 v[184:187], a[24:27], v[22:25], v[184:187]
  ds_read_b128 v[70:73], v94 offset:3072
  v_mfma_f32_16x16x32_bf16 v[188:191], a[28:31], v[22:25], v[188:191]
  ds_read_b128 v[74:77], v94 offset:23552
  v_mfma_f32_16x16x32_bf16 v[192:195], a[32:35], v[22:25], v[192:195]
  s_mov_b32 m0, s48
  s_nop 0
  buffer_load_dwordx4 v2, s[16:19], s45 offen offset:2048 sc1 lds
  v_mfma_f32_16x16x32_bf16 v[196:199], a[24:27], v[26:29], v[196:199]
  v_mfma_f32_16x16x32_bf16 v[200:203], a[28:31], v[26:29], v[200:203]
  v_mfma_f32_16x16x32_bf16 v[204:207], a[32:35], v[26:29], v[204:207]
  v_mfma_f32_16x16x32_bf16 v[208:211], a[24:27], v[30:33], v[208:211]
  buffer_load_dwordx4 v2, s[16:19], s45 offen offset:3072 sc1 lds
  s_add_u32 s45, s45, 4096
  s_add_u32 s48, s48, 4096
  v_mfma_f32_16x16x32_bf16 v[212:215], a[28:31], v[30:33], v[212:215]
  v_mfma_f32_16x16x32_bf16 v[216:219], a[32:35], v[30:33], v[216:219]
  v_mfma_f32_16x16x32_bf16 v[220:223], a[24:27], v[34:37], v[220:223]
  v_mfma_f32_16x16x32_bf16 v[224:227], a[28:31], v[34:37], v[224:227]
  s_mov_b32 m0, s49
  s_nop 0
  buffer_load_dwordx4 v2, s[16:19], s46 offen offset:2048 sc1 lds
  v_mfma_f32_16x16x32_bf16 v[228:231], a[32:35], v[34:37], v[228:231]
  v_mfma_f32_16x16x32_bf16 v[232:235], a[24:27], v[38:41], v[232:235]
  v_mfma_f32_16x16x32_bf16 v[236:239], a[28:31], v[38:41], v[236:239]
  v_mfma_f32_16x16x32_bf16 v[240:243], a[32:35], v[38:41], v[240:243]
  buffer_load_dwordx4 v2, s[16:19], s46 offen offset:3072 sc1 lds
  s_add_u32 s46, s46, 4096
  s_add_u32 s49, s49, 4096
  v_mfma_f32_16x16x32_bf16 v[80:83], a[24:27], v[42:45], v[80:83]
  v_mfma_f32_16x16x32_bf16 v[84:87], a[28:31], v[42:45], v[84:87]
  v_mfma_f32_16x16x32_bf16 v[88:91], a[32:35], v[42:45], v[88:91]
  s_waitcnt lgkmcnt(0)
  v_mfma_f32_16x16x32_bf16 v[160:163], a[36:39], v[46:49], v[160:163]
  ds_read_b128 v[14:17], v92 offset:4096
  v_mfma_f32_16x16x32_bf16 v[164:167], a[40:43], v[46:49], v[164:167]
  ds_read_b128 v[18:21], v92 offset:24576
  v_mfma_f32_16x16x32_bf16 v[168:171], a[44:47], v[46:49], v[168:171]
  ds_read_b128 v[22:25], v92 offset:45056
  v_mfma_f32_16x16x32_bf16 v[172:175], a[36:39], v[50:53], v[172:175]
  ds_read_b128 v[26:29], v93 offset:4096
  v_mfma_f32_16x16x32_bf16 v[176:179], a[40:43], v[50:53], v[176:179]
  ds_read_b128 v[30:33], v93 offset:24576
  v_mfma_f32_16x16x32_bf16 v[180:183], a[44:47], v[50:53], v[180:183]
  ds_read_b128 v[34:37], v93 offset:45056
  v_mfma_f32_16x16x32_bf16 v[184:187], a[36:39], v[54:57], v[184:187]
  ds_read_b128 v[38:41], v94 offset:4096
  v_mfma_f32_16x16x32_bf16 v[188:191], a[40:43], v[54:57], v[188:191]
  ds_read_b128 v[42:45], v94 offset:24576
  v_mfma_f32_16x16x32_bf16 v[192:195], a[44:47], v[54:57], v[192:195]
  s_mov_b32 m0, s48
  s_nop 0
  buffer_load_dwordx4 v2, s[16:19], s45 offen offset:0 sc1 lds
  v_mfma_f32_16x16x32_bf16 v[196:199], a[36:39], v[58:61], v[196:199]
  v_mfma_f32_16x16x32_bf16 v[200:203], a[40:43], v[58:61], v[200:203]
  v_mfma_f32_16x16x32_bf16 v[204:207], a[44:47], v[58:61], v[204:207]
  v_mfma_f32_16x16x32_bf16 v[208:211], a[36:39], v[62:65], v[208:211]
  buffer_load_dwordx4 v2, s[16:19], s45 offen offset:1024 sc1 lds
  v_mfma_f32_16x16x32_bf16 v[212:215], a[40:43], v[62:65], v[212:215]
  v_mfma_f32_16x16x32_bf16 v[216:219], a[44:47], v[62:65], v[216:219]
  v_mfma_f32_16x16x32_bf16 v[220:223], a[36:39], v[66:69], v[220:223]
  v_mfma_f32_16x16x32_bf16 v[224:227], a[40:43], v[66:69], v[224:227]
  s_mov_b32 m0, s49
  s_nop 0
  buffer_load_dwordx4 v2, s[16:19], s46 offen offset:0 sc1 lds
  v_mfma_f32_16x16x32_bf16 v[228:231], a[44:47], v[66:69], v[228:231]
  v_mfma_f32_16x16x32_bf16 v[232:235], a[36:39], v[70:73], v[232:235]
  v_mfma_f32_16x16x32_bf16 v[236:239], a[40:43], v[70:73], v[236:239]
  v_mfma_f32_16x16x32_bf16 v[240:243], a[44:47], v[70:73], v[240:243]
  buffer_load_dwordx4 v2, s[16:19], s46 offen offset:1024 sc1 lds
  v_mfma_f32_16x16x32_bf16 v[80:83], a[36:39], v[74:77], v[80:83]
  v_mfma_f32_16x16x32_bf16 v[84:87], a[40:43], v[74:77], v[84:87]
  v_mfma_f32_16x16x32_bf16 v[88:91], a[44:47], v[74:77], v[88:91]
  s_waitcnt lgkmcnt(0)
  v_mfma_f32_16x16x32_bf16 v[160:163], a[48:51], v[14:17], v[160:163]
  ds_read_b128 v[46:49], v92 offset:5120
  v_mfma_f32_16x16x32_bf16 v[164:167], a[52:55], v[14:17], v[164:167]
  ds_read_b128 v[50:53], v92 offset:25600
  v_mfma_f32_16x16x32_bf16 v[168:171], a[56:59], v[14:17], v[168:171]
  ds_read_b128 v[54:57], v92 offset:46080
  v_mfma_f32_16x16x32_bf16 v[172:175], a[48:51], v[18:21], v[172:175]
  ds_read_b128 v[58:61], v93 offset:5120
  v_mfma_f32_16x16x32_bf16 v[176:179], a[52:55], v[18:21], v[176:179]
  ds_read_b128 v[62:65], v93 offset:25600
  v_mfma_f32_16x16x32_bf16 v[180:183], a[56:59], v[18:21], v[180:183]
  ds_read_b128 v[66:69], v93 offset:46080
  v_mfma_f32_16x16x32_bf16 v[184:187], a[48:51], v[22:25], v[184:187]
  ds_read_b128 v[70:73], v94 offset:5120
  v_mfma_f32_16x16x32_bf16 v[188:191], a[52:55], v[22:25], v[188:191]
  ds_read_b128 v[74:77], v94 offset:25600
  v_mfma_f32_16x16x32_bf16 v[192:195], a[56:59], v[22:25], v[192:195]
  s_mov_b32 m0, s48
  s_nop 0
  buffer_load_dwordx4 v2, s[16:19], s45 offen offset:2048 sc1 lds
  v_mfma_f32_16x16x32_bf16 v[196:199], a[48:51], v[26:29], v[196:199]
  v_mfma_f32_16x16x32_bf16 v[200:203], a[52:55], v[26:29], v[200:203]
  v_mfma_f32_16x16x32_bf16 v[204:207], a[56:59], v[26:29], v[204:207]
  v_mfma_f32_16x16x32_bf16 v[208:211], a[48:51], v[30:33], v[208:211]
  buffer_load_dwordx4 v2, s[16:19], s45 offen offset:3072 sc1 lds
  s_add_u32 s45, s45, 4096
  s_add_u32 s48, s48, 4096
  v_mfma_f32_16x16x32_bf16 v[212:215], a[52:55], v[30:33], v[212:215]
  v_mfma_f32_16x16x32_bf16 v[216:219], a[56:59], v[30:33], v[216:219]
  v_mfma_f32_16x16x32_bf16 v[220:223], a[48:51], v[34:37], v[220:223]
  v_mfma_f32_16x16x32_bf16 v[224:227], a[52:55], v[34:37], v[224:227]
  s_mov_b32 m0, s49
  s_nop 0
  buffer_load_dwordx4 v2, s[16:19], s46 offen offset:2048 sc1 lds
  v_mfma_f32_16x16x32_bf16 v[228:231], a[56:59], v[34:37], v[228:231]
  v_mfma_f32_16x16x32_bf16 v[232:235], a[48:51], v[38:41], v[232:235]
  v_mfma_f32_16x16x32_bf16 v[236:239], a[52:55], v[38:41], v[236:239]
  v_mfma_f32_16x16x32_bf16 v[240:243], a[56:59], v[38:41], v[240:243]
  buffer_load_dwordx4 v2, s[16:19], s46 offen offset:3072 sc1 lds
  s_add_u32 s46, s46, 4096
  s_add_u32 s49, s49, 4096
  v_mfma_f32_16x16x32_bf16 v[80:83], a[48:51], v[42:45], v[80:83]
  v_mfma_f32_16x16x32_bf16 v[84:87], a[52:55], v[42:45], v[84:87]
  v_mfma_f32_16x16x32_bf16 v[88:91], a[56:59], v[42:45], v[88:91]
  s_waitcnt lgkmcnt(0)
  v_mfma_f32_16x16x32_bf16 v[160:163], a[60:63], v[46:49], v[160:163]
  v_mfma_f32_16x16x32_bf16 v[164:167], a[64:67], v[46:49], v[164:167]
  s_waitcnt vmcnt(8)
  s_barrier
  v_mfma_f32_16x16x32_bf16 v[168:171], a[68:71], v[46:49], v[168:171]
  ds_read_b128 v[14:17], v92 offset:6144
  v_mfma_f32_16x16x32_bf16 v[172:175], a[60:63], v[50:53], v[172:175]
  ds_read_b128 v[18:21], v92 offset:26624
  v_mfma_f32_16x16x32_bf16 v[176:179], a[64:67], v[50:53], v[176:179]
  ds_read_b128 v[22:25], v92 offset:47104
  v_mfma_f32_16x16x32_bf16 v[180:183], a[68:71], v[50:53], v[180:183]
  ds_read_b128 v[26:29], v93 offset:6144
  v_mfma_f32_16x16x32_bf16 v[184:187], a[60:63], v[54:57], v[184:187]
  ds_read_b128 v[30:33], v93 offset:26624
  v_mfma_f32_16x16x32_bf16 v[188:191], a[64:67], v[54:57], v[188:191]
  ds_read_b128 v[34:37], v93 offset:47104
  v_mfma_f32_16x16x32_bf16 v[192:195], a[68:71], v[54:57], v[192:195]
  ds_read_b128 v[38:41], v94 offset:6144
  v_mfma_f32_16x16x32_bf16 v[196:199], a[60:63], v[58:61], v[196:199]
  ds_read_b128 v[42:45], v94 offset:26624
  v_mfma_f32_16x16x32_bf16 v[200:203], a[64:67], v[58:61], v[200:203]
  s_mov_b32 m0, s48
  s_nop 0
  buffer_load_dwordx4 v2, s[16:19], s45 offen offset:0 sc1 lds
  v_mfma_f32_16x16x32_bf16 v[204:207], a[68:71], v[58:61], v[204:207]
  v_mfma_f32_16x16x32_bf16 v[208:211], a[60:63], v[62:65], v[208:211]
  v_mfma_f32_16x16x32_bf16 v[212:215], a[64:67], v[62:65], v[212:215]
  v_mfma_f32_16x16x32_bf16 v[216:219], a[68:71], v[62:65], v[216:219]
  buffer_load_dwordx4 v2, s[16:19], s45 offen offset:1024 sc1 lds
  v_mfma_f32_16x16x32_bf16 v[220:223], a[60:63], v[66:69], v[220:223]
  v_mfma_f32_16x16x32_bf16 v[224:227], a[64:67], v[66:69], v[224:227]
  v_mfma_f32_16x16x32_bf16 v[228:231], a[68:71], v[66:69], v[228:231]
  s_mov_b32 m0, s49
  s_nop 0
  buffer_load_dwordx4 v2, s[16:19], s46 offen offset:0 sc1 lds
  v_mfma_f32_16x16x32_bf16 v[232:235], a[60:63], v[70:73], v[232:235]
  v_mfma_f32_16x16x32_bf16 v[236:239], a[64:67], v[70:73], v[236:239]
  v_mfma_f32_16x16x32_bf16 v[240:243], a[68:71], v[70:73], v[240:243]
  v_mfma_f32_16x16x32_bf16 v[80:83], a[60:63], v[74:77], v[80:83]
  buffer_load_dwordx4 v2, s[16:19], s46 offen offset:1024 sc1 lds
  v_mfma_f32_16x16x32_bf16 v[84:87], a[64:67], v[74:77], v[84:87]
  v_mfma_f32_16x16x32_bf16 v[88:91], a[68:71], v[74:77], v[88:91]
  s_waitcnt lgkmcnt(0)
  v_mfma_f32_16x16x32_bf16 v[160:163], a[72:75], v[14:17], v[160:163]
  ds_read_b128 v[46:49], v92 offset:7168
  v_mfma_f32_16x16x32_bf16 v[164:167], a[76:79], v[14:17], v[164:167]
  ds_read_b128 v[50:53], v92 offset:27648
  v_mfma_f32_16x16x32_bf16 v[168:171], a[80:83], v[14:17], v[168:171]
  ds_read_b128 v[54:57], v92 offset:48128
  v_mfma_f32_16x16x32_bf16 v[172:175], a[72:75], v[18:21], v[172:175]
  ds_read_b128 v[58:61], v93 offset:7168
  v_mfma_f32_16x16x32_bf16 v[176:179], a[76:79], v[18:21], v[176:179]
  ds_read_b128 v[62:65], v93 offset:27648
  v_mfma_f32_16x16x32_bf16 v[180:183], a[80:83], v[18:21], v[180:183]
  ds_read_b128 v[66:69], v93 offset:48128
  v_mfma_f32_16x16x32_bf16 v[184:187], a[72:75], v[22:25], v[184:187]
  ds_read_b128 v[70:73], v94 offset:7168
  v_mfma_f32_16x16x32_bf16 v[188:191], a[76:79], v[22:25], v[188:191]
  ds_read_b128 v[74:77], v94 offset:27648
  v_mfma_f32_16x16x32_bf16 v[192:195], a[80:83], v[22:25], v[192:195]
  buffer_load_dwordx4 v[128:131], v9, s[8:11], s36 offen sc1
  v_mfma_f32_16x16x32_bf16 v[196:199], a[72:75], v[26:29], v[196:199]
  v_mfma_f32_16x16x32_bf16 v[200:203], a[76:79], v[26:29], v[200:203]
  v_mfma_f32_16x16x32_bf16 v[204:207], a[80:83], v[26:29], v[204:207]
  v_mfma_f32_16x16x32_bf16 v[208:211], a[72:75], v[30:33], v[208:211]
  s_mov_b32 m0, s48
  s_nop 0
  buffer_load_dwordx4 v2, s[16:19], s45 offen offset:2048 sc1 lds
  v_mfma_f32_16x16x32_bf16 v[212:215], a[76:79], v[30:33], v[212:215]
  v_mfma_f32_16x16x32_bf16 v[216:219], a[80:83], v[30:33], v[216:219]
  v_mfma_f32_16x16x32_bf16 v[220:223], a[72:75], v[34:37], v[220:223]
  buffer_load_dwordx4 v2, s[16:19], s45 offen offset:3072 sc1 lds
  s_add_u32 s45, s45, 4096
  s_add_u32 s48, s48, 4096
  v_mfma_f32_16x16x32_bf16 v[224:227], a[76:79], v[34:37], v[224:227]
  v_mfma_f32_16x16x32_bf16 v[228:231], a[80:83], v[34:37], v[228:231]
  v_mfma_f32_16x16x32_bf16 v[232:235], a[72:75], v[38:41], v[232:235]
  s_mov_b32 m0, s49
  s_nop 0
  buffer_load_dwordx4 v2, s[16:19], s46 offen offset:2048 sc1 lds
  v_mfma_f32_16x16x32_bf16 v[236:239], a[76:79], v[38:41], v[236:239]
  v_mfma_f32_16x16x32_bf16 v[240:243], a[80:83], v[38:41], v[240:243]
  v_mfma_f32_16x16x32_bf16 v[80:83], a[72:75], v[42:45], v[80:83]
  buffer_load_dwordx4 v2, s[16:19], s46 offen offset:3072 sc1 lds
  s_add_u32 s46, s46, 4096
  s_add_u32 s49, s49, 4096
  v_mfma_f32_16x16x32_bf16 v[84:87], a[76:79], v[42:45], v[84:87]
  v_mfma_f32_16x16x32_bf16 v[88:91], a[80:83], v[42:45], v[88:91]
  s_waitcnt lgkmcnt(0)
  v_mfma_f32_16x16x32_bf16 v[160:163], a[84:87], v[46:49], v[160:163]
  ds_read_b128 v[14:17], v92 offset:8192
  v_mfma_f32_16x16x32_bf16 v[164:167], a[88:91], v[46:49], v[164:167]
  ds_read_b128 v[18:21], v92 offset:28672
  v_mfma_f32_16x16x32_bf16 v[168:171], a[92:95], v[46:49], v[168:171]
  ds_read_b128 v[22:25], v92 offset:49152
  v_mfma_f32_16x16x32_bf16 v[172:175], a[84:87], v[50:53], v[172:175]
  ds_read_b128 v[26:29], v93 offset:8192
  v_mfma_f32_16x16x32_bf16 v[176:179], a[88:91], v[50:53], v[176:179]
  ds_read_b128 v[30:33], v93 offset:28672
  v_mfma_f32_16x16x32_bf16 v[180:183], a[92:95], v[50:53], v[180:183]
  ds_read_b128 v[34:37], v93 offset:49152
  v_mfma_f32_16x16x32_bf16 v[184:187], a[84:87], v[54:57], v[184:187]
  ds_read_b128 v[38:41], v94 offset:8192
  v_mfma_f32_16x16x32_bf16 v[188:191], a[88:91], v[54:57], v[188:191]
  ds_read_b128 v[42:45], v94 offset:28672
  v_mfma_f32_16x16x32_bf16 v[192:195], a[92:95], v[54:57], v[192:195]
  buffer_load_dwordx4 v[96:99], v2, s[8:11], s33 offen offset:0 sc1
  v_mfma_f32_16x16x32_bf16 v[196:199], a[84:87], v[58:61], v[196:199]
  v_mfma_f32_16x16x32_bf16 v[200:203], a[88:91], v[58:61], v[200:203]
  buffer_load_dwordx4 v[100:103], v2, s[8:11], s33 offen offset:1024 sc1
  v_mfma_f32_16x16x32_bf16 v[204:207], a[92:95], v[58:61], v[204:207]
  v_mfma_f32_16x16x32_bf16 v[208:211], a[84:87], v[62:65], v[208:211]
  buffer_load_dwordx4 v[104:107], v2, s[8:11], s33 offen offset:2048 sc1
  v_mfma_f32_16x16x32_bf16 v[212:215], a[88:91], v[62:65], v[212:215]
  v_mfma_f32_16x16x32_bf16 v[216:219], a[92:95], v[62:65], v[216:219]
  buffer_load_dwordx4 v[108:111], v2, s[8:11], s33 offen offset:3072 sc1
  v_mfma_f32_16x16x32_bf16 v[220:223], a[84:87], v[66:69], v[220:223]
  v_mfma_f32_16x16x32_bf16 v[224:227], a[88:91], v[66:69], v[224:227]
  buffer_load_dwordx4 v[112:115], v8, s[8:11], s33 offen offset:0 sc1
  v_mfma_f32_16x16x32_bf16 v[228:231], a[92:95], v[66:69], v[228:231]
  v_mfma_f32_16x16x32_bf16 v[232:235], a[84:87], v[70:73], v[232:235]
  buffer_load_dwordx4 v[116:119], v8, s[8:11], s33 offen offset:1024 sc1
  v_mfma_f32_16x16x32_bf16 v[236:239], a[88:91], v[70:73], v[236:239]
  v_mfma_f32_16x16x32_bf16 v[240:243], a[92:95], v[70:73], v[240:243]
  buffer_load_dwordx4 v[120:123], v8, s[8:11], s33 offen offset:2048 sc1
  v_mfma_f32_16x16x32_bf16 v[80:83], a[84:87], v[74:77], v[80:83]
  v_mfma_f32_16x16x32_bf16 v[84:87], a[88:91], v[74:77], v[84:87]
  buffer_load_dwordx4 v[124:127], v8, s[8:11], s33 offen offset:3072 sc1
  v_mfma_f32_16x16x32_bf16 v[88:91], a[92:95], v[74:77], v[88:91]
  s_waitcnt lgkmcnt(0)
  v_mfma_f32_16x16x32_bf16 v[160:163], a[96:99], v[14:17], v[160:163]
  ds_read_b128 v[46:49], v92 offset:9216
  v_mfma_f32_16x16x32_bf16 v[164:167], a[100:103], v[14:17], v[164:167]
  ds_read_b128 v[50:53], v92 offset:29696
  v_mfma_f32_16x16x32_bf16 v[168:171], a[104:107], v[14:17], v[168:171]
  ds_read_b128 v[54:57], v92 offset:50176
  v_mfma_f32_16x16x32_bf16 v[172:175], a[96:99], v[18:21], v[172:175]
  ds_read_b128 v[58:61], v93 offset:9216
  v_mfma_f32_16x16x32_bf16 v[176:179], a[100:103], v[18:21], v[176:179]
  ds_read_b128 v[62:65], v93 offset:29696
  v_mfma_f32_16x16x32_bf16 v[180:183], a[104:107], v[18:21], v[180:183]
  ds_read_b128 v[66:69], v93 offset:50176
  v_mfma_f32_16x16x32_bf16 v[184:187], a[96:99], v[22:25], v[184:187]
  ds_read_b128 v[70:73], v94 offset:9216
  v_mfma_f32_16x16x32_bf16 v[188:191], a[100:103], v[22:25], v[188:191]
  ds_read_b128 v[74:77], v94 offset:29696
  v_mfma_f32_16x16x32_bf16 v[192:195], a[104:107], v[22:25], v[192:195]
  buffer_load_dwordx4 a[240:243], v2, s[8:11], s52 offen offset:1024 sc1
  v_mfma_f32_16x16x32_bf16 v[196:199], a[96:99], v[26:29], v[196:199]
  v_mfma_f32_16x16x32_bf16 v[200:203], a[100:103], v[26:29], v[200:203]
  v_mfma_f32_16x16x32_bf16 v[204:207], a[104:107], v[26:29], v[204:207]
  v_mfma_f32_16x16x32_bf16 v[208:211], a[96:99], v[30:33], v[208:211]
  buffer_load_dwordx4 a[244:247], v2, s[8:11], s52 offen offset:2048 sc1
  v_mfma_f32_16x16x32_bf16 v[212:215], a[100:103], v[30:33], v[212:215]
  v_mfma_f32_16x16x32_bf16 v[216:219], a[104:107], v[30:33], v[216:219]
  v_mfma_f32_16x16x32_bf16 v[220:223], a[96:99], v[34:37], v[220:223]
  buffer_load_dwordx4 a[248:251], v2, s[8:11], s52 offen offset:3072 sc1
  v_mfma_f32_16x16x32_bf16 v[224:227], a[100:103], v[34:37], v[224:227]
  v_mfma_f32_16x16x32_bf16 v[228:231], a[104:107], v[34:37], v[228:231]
  v_mfma_f32_16x16x32_bf16 v[232:235], a[96:99], v[38:41], v[232:235]
  buffer_load_dwordx4 a[0:3], v2, s[8:11], s47 offen offset:0 sc1
  v_mfma_f32_16x16x32_bf16 v[236:239], a[100:103], v[38:41], v[236:239]
  v_mfma_f32_16x16x32_bf16 v[240:243], a[104:107], v[38:41], v[240:243]
  v_mfma_f32_16x16x32_bf16 v[80:83], a[96:99], v[42:45], v[80:83]
  buffer_load_dwordx4 a[4:7], v2, s[8:11], s47 offen offset:1024 sc1
  v_mfma_f32_16x16x32_bf16 v[84:87], a[100:103], v[42:45], v[84:87]
  v_mfma_f32_16x16x32_bf16 v[88:91], a[104:107], v[42:45], v[88:91]
  s_waitcnt lgkmcnt(0)
  v_mfma_f32_16x16x32_bf16 v[160:163], a[108:111], v[46:49], v[160:163]
  ds_read_b128 v[14:17], v92 offset:10240
  v_mfma_f32_16x16x32_bf16 v[164:167], a[112:115], v[46:49], v[164:167]
  ds_read_b128 v[18:21], v92 offset:30720
  v_mfma_f32_16x16x32_bf16 v[168:171], a[116:119], v[46:49], v[168:171]
  ds_read_b128 v[22:25], v92 offset:51200
  v_mfma_f32_16x16x32_bf16 v[172:175], a[108:111], v[50:53], v[172:175]
  ds_read_b128 v[26:29], v93 offset:10240
  v_mfma_f32_16x16x32_bf16 v[176:179], a[112:115], v[50:53], v[176:179]
  ds_read_b128 v[30:33], v93 offset:30720
  v_mfma_f32_16x16x32_bf16 v[180:183], a[116:119], v[50:53], v[180:183]
  ds_read_b128 v[34:37], v93 offset:51200
  v_mfma_f32_16x16x32_bf16 v[184:187], a[108:111], v[54:57], v[184:187]
  ds_read_b128 v[38:41], v94 offset:10240
  v_mfma_f32_16x16x32_bf16 v[188:191], a[112:115], v[54:57], v[188:191]
  ds_read_b128 v[42:45], v94 offset:30720
  v_mfma_f32_16x16x32_bf16 v[192:195], a[116:119], v[54:57], v[192:195]
  buffer_load_dwordx4 a[8:11], v2, s[8:11], s47 offen offset:2048 sc1
  v_mfma_f32_16x16x32_bf16 v[196:199], a[108:111], v[58:61], v[196:199]
  v_mfma_f32_16x16x32_bf16 v[200:203], a[112:115], v[58:61], v[200:203]
  v_mfma_f32_16x16x32_bf16 v[204:207], a[116:119], v[58:61], v[204:207]
  v_mfma_f32_16x16x32_bf16 v[208:211], a[108:111], v[62:65], v[208:211]
  buffer_load_dwordx4 a[12:15], v2, s[8:11], s47 offen offset:3072 sc1
  s_add_u32 s47, s47, 4096
  v_mfma_f32_16x16x32_bf16 v[212:215], a[112:115], v[62:65], v[212:215]
  v_mfma_f32_16x16x32_bf16 v[216:219], a[116:119], v[62:65], v[216:219]
  v_mfma_f32_16x16x32_bf16 v[220:223], a[108:111], v[66:69], v[220:223]
  buffer_load_dwordx4 a[16:19], v2, s[8:11], s47 offen offset:0 sc1
  v_mfma_f32_16x16x32_bf16 v[224:227], a[112:115], v[66:69], v[224:227]
  v_mfma_f32_16x16x32_bf16 v[228:231], a[116:119], v[66:69], v[228:231]
  v_mfma_f32_16x16x32_bf16 v[232:235], a[108:111], v[70:73], v[232:235]
  buffer_load_dwordx4 a[20:23], v2, s[8:11], s47 offen offset:1024 sc1
  v_mfma_f32_16x16x32_bf16 v[236:239], a[112:115], v[70:73], v[236:239]
  v_mfma_f32_16x16x32_bf16 v[240:243], a[116:119], v[70:73], v[240:243]
  v_mfma_f32_16x16x32_bf16 v[80:83], a[108:111], v[74:77], v[80:83]
  buffer_load_dwordx4 a[24:27], v2, s[8:11], s47 offen offset:2048 sc1
  v_mfma_f32_16x16x32_bf16 v[84:87], a[112:115], v[74:77], v[84:87]
  v_mfma_f32_16x16x32_bf16 v[88:91], a[116:119], v[74:77], v[88:91]
  s_waitcnt lgkmcnt(0)
  v_mfma_f32_16x16x32_bf16 v[160:163], a[120:123], v[14:17], v[160:163]
  ds_read_b128 v[46:49], v92 offset:11264
  v_mfma_f32_16x16x32_bf16 v[164:167], a[124:127], v[14:17], v[164:167]
  ds_read_b128 v[50:53], v92 offset:31744
  v_mfma_f32_16x16x32_bf16 v[168:171], a[128:131], v[14:17], v[168:171]
  ds_read_b128 v[54:57], v92 offset:52224
  v_mfma_f32_16x16x32_bf16 v[172:175], a[120:123], v[18:21], v[172:175]
  ds_read_b128 v[58:61], v93 offset:11264
  v_mfma_f32_16x16x32_bf16 v[176:179], a[124:127], v[18:21], v[176:179]
  ds_read_b128 v[62:65], v93 offset:31744
  v_mfma_f32_16x16x32_bf16 v[180:183], a[128:131], v[18:21], v[180:183]
  ds_read_b128 v[66:69], v93 offset:52224
  v_mfma_f32_16x16x32_bf16 v[184:187], a[120:123], v[22:25], v[184:187]
  ds_read_b128 v[70:73], v94 offset:11264
  v_mfma_f32_16x16x32_bf16 v[188:191], a[124:127], v[22:25], v[188:191]
  ds_read_b128 v[74:77], v94 offset:31744
  v_mfma_f32_16x16x32_bf16 v[192:195], a[128:131], v[22:25], v[192:195]
  buffer_load_dwordx4 a[28:31], v2, s[8:11], s47 offen offset:3072 sc1
  s_add_u32 s47, s47, 4096
  v_mfma_f32_16x16x32_bf16 v[196:199], a[120:123], v[26:29], v[196:199]
  v_mfma_f32_16x16x32_bf16 v[200:203], a[124:127], v[26:29], v[200:203]
  v_mfma_f32_16x16x32_bf16 v[204:207], a[128:131], v[26:29], v[204:207]
  v_mfma_f32_16x16x32_bf16 v[208:211], a[120:123], v[30:33], v[208:211]
  buffer_load_dwordx4 a[32:35], v2, s[8:11], s47 offen offset:0 sc1
  v_mfma_f32_16x16x32_bf16 v[212:215], a[124:127], v[30:33], v[212:215]
  v_mfma_f32_16x16x32_bf16 v[216:219], a[128:131], v[30:33], v[216:219]
  v_mfma_f32_16x16x32_bf16 v[220:223], a[120:123], v[34:37], v[220:223]
  buffer_load_dwordx4 a[36:39], v2, s[8:11], s47 offen offset:1024 sc1
  v_mfma_f32_16x16x32_bf16 v[224:227], a[124:127], v[34:37], v[224:227]
  v_mfma_f32_16x16x32_bf16 v[228:231], a[128:131], v[34:37], v[228:231]
  v_mfma_f32_16x16x32_bf16 v[232:235], a[120:123], v[38:41], v[232:235]
  buffer_load_dwordx4 a[40:43], v2, s[8:11], s47 offen offset:2048 sc1
  v_mfma_f32_16x16x32_bf16 v[236:239], a[124:127], v[38:41], v[236:239]
  v_mfma_f32_16x16x32_bf16 v[240:243], a[128:131], v[38:41], v[240:243]
  v_mfma_f32_16x16x32_bf16 v[80:83], a[120:123], v[42:45], v[80:83]
  buffer_load_dwordx4 a[44:47], v2, s[8:11], s47 offen offset:3072 sc1
  s_add_u32 s47, s47, 4096
  v_mfma_f32_16x16x32_bf16 v[84:87], a[124:127], v[42:45], v[84:87]
  v_mfma_f32_16x16x32_bf16 v[88:91], a[128:131], v[42:45], v[88:91]
  s_waitcnt lgkmcnt(0)
  v_mfma_f32_16x16x32_bf16 v[160:163], a[132:135], v[46:49], v[160:163]
  v_mfma_f32_16x16x32_bf16 v[164:167], a[136:139], v[46:49], v[164:167]
  s_waitcnt vmcnt(23)
  v_xor_b32 v128, s100, v128
  v_xor_b32 v129, s100, v129
  v_xor_b32 v130, s100, v130
  v_xor_b32 v131, s100, v131
  v_or3_b32 v128, v128, v129, v130
  v_or_b32 v128, v128, v131
  v_cmp_ne_u32 vcc, 0, v128
  s_cbranch_vccnz L_pck_2139
L_pout_2138:
  s_barrier
  v_mfma_f32_16x16x32_bf16 v[168:171], a[140:143], v[46:49], v[168:171]
  ds_read_b128 v[14:17], v92 offset:12288
  v_mfma_f32_16x16x32_bf16 v[172:175], a[132:135], v[50:53], v[172:175]
  ds_read_b128 v[18:21], v92 offset:32768
  v_mfma_f32_16x16x32_bf16 v[176:179], a[136:139], v[50:53], v[176:179]
  ds_read_b128 v[22:25], v92 offset:53248
  v_mfma_f32_16x16x32_bf16 v[180:183], a[140:143], v[50:53], v[180:183]
  ds_read_b128 v[26:29], v93 offset:12288
  v_mfma_f32_16x16x32_bf16 v[184:187], a[132:135], v[54:57], v[184:187]
  ds_read_b128 v[30:33], v93 offset:32768
  v_mfma_f32_16x16x32_bf16 v[188:191], a[136:139], v[54:57], v[188:191]
  ds_read_b128 v[34:37], v93 offset:53248
  v_mfma_f32_16x16x32_bf16 v[192:195], a[140:143], v[54:57], v[192:195]
  ds_read_b128 v[38:41], v94 offset:12288
  v_mfma_f32_16x16x32_bf16 v[196:199], a[132:135], v[58:61], v[196:199]
  ds_read_b128 v[42:45], v94 offset:32768
  v_mfma_f32_16x16x32_bf16 v[200:203], a[136:139], v[58:61], v[200:203]
  buffer_load_dwordx4 a[48:51], v2, s[8:11], s47 offen offset:0 sc1
  v_mfma_f32_16x16x32_bf16 v[204:207], a[140:143], v[58:61], v[204:207]
  v_mfma_f32_16x16x32_bf16 v[208:211], a[132:135], v[62:65], v[208:211]
  v_mfma_f32_16x16x32_bf16 v[212:215], a[136:139], v[62:65], v[212:215]
  buffer_load_dwordx4 a[52:55], v2, s[8:11], s47 offen offset:1024 sc1
  v_mfma_f32_16x16x32_bf16 v[216:219], a[140:143], v[62:65], v[216:219]
  v_mfma_f32_16x16x32_bf16 v[220:223], a[132:135], v[66:69], v[220:223]
  v_mfma_f32_16x16x32_bf16 v[224:227], a[136:139], v[66:69], v[224:227]
  buffer_load_dwordx4 a[56:59], v2, s[8:11], s47 offen offset:2048 sc1
  v_mfma_f32_16x16x32_bf16 v[228:231], a[140:143], v[66:69], v[228:231]
  v_mfma_f32_16x16x32_bf16 v[232:235], a[132:135], v[70:73], v[232:235]
  v_mfma_f32_16x16x32_bf16 v[236:239], a[136:139], v[70:73], v[236:239]
  buffer_load_dwordx4 a[60:63], v2, s[8:11], s47 offen offset:3072 sc1
  s_add_u32 s47, s47, 4096
  v_mfma_f32_16x16x32_bf16 v[240:243], a[140:143], v[70:73], v[240:243]
  v_mfma_f32_16x16x32_bf16 v[80:83], a[132:135], v[74:77], v[80:83]
  v_mfma_f32_16x16x32_bf16 v[84:87], a[136:139], v[74:77], v[84:87]
  buffer_load_dwordx4 a[64:67], v2, s[8:11], s47 offen offset:0 sc1
  v_mfma_f32_16x16x32_bf16 v[88:91], a[140:143], v[74:77], v[88:91]
  s_waitcnt lgkmcnt(0)
  s_waitcnt vmcnt(20)
  v_mfma_f32_16x16x32_bf16 v[160:163], a[144:147], v[14:17], v[160:163]
  ds_read_b128 v[46:49], v92 offset:13312
  v_mfma_f32_16x16x32_bf16 v[164:167], a[148:151], v[14:17], v[164:167]
  ds_read_b128 v[50:53], v92 offset:33792
  v_mfma_f32_16x16x32_bf16 v[168:171], a[152:155], v[14:17], v[168:171]
  ds_read_b128 v[54:57], v92 offset:54272
  v_mfma_f32_16x16x32_bf16 v[172:175], a[144:147], v[18:21], v[172:175]
  ds_read_b128 v[58:61], v93 offset:13312
  v_mfma_f32_16x16x32_bf16 v[176:179], a[148:151], v[18:21], v[176:179]
  ds_read_b128 v[62:65], v93 offset:33792
  v_mfma_f32_16x16x32_bf16 v[180:183], a[152:155], v[18:21], v[180:183]
  ds_read_b128 v[66:69], v93 offset:54272
  v_mfma_f32_16x16x32_bf16 v[184:187], a[144:147], v[22:25], v[184:187]
  ds_read_b128 v[70:73], v94 offset:13312
  v_mfma_f32_16x16x32_bf16 v[188:191], a[148:151], v[22:25], v[188:191]
  ds_read_b128 v[74:77], v94 offset:33792
  v_mfma_f32_16x16x32_bf16 v[192:195], a[152:155], v[22:25], v[192:195]
  buffer_load_dwordx4 a[68:71], v2, s[8:11], s47 offen offset:1024 sc1
  v_mfma_f32_16x16x32_bf16 v[196:199], a[144:147], v[26:29], v[196:199]
  v_add_f32 v96, v96, v98
  v_mfma_f32_16x16x32_bf16 v[200:203], a[148:151], v[26:29], v[200:203]
  v_add_f32 v97, v97, v99
  v_mfma_f32_16x16x32_bf16 v[204:207], a[152:155], v[26:29], v[204:207]
  v_add_f32 v100, v100, v102
  v_mfma_f32_16x16x32_bf16 v[208:211], a[144:147], v[30:33], v[208:211]
  buffer_load_dwordx4 a[72:75], v2, s[8:11], s47 offen offset:2048 sc1
  v_mfma_f32_16x16x32_bf16 v[212:215], a[148:151], v[30:33], v[212:215]
  v_add_f32 v101, v101, v103
  v_mfma_f32_16x16x32_bf16 v[216:219], a[152:155], v[30:33], v[216:219]
  v_add_f32 v104, v104, v106
  v_mfma_f32_16x16x32_bf16 v[220:223], a[144:147], v[34:37], v[220:223]
  buffer_load_dwordx4 a[76:79], v2, s[8:11], s47 offen offset:3072 sc1
  s_add_u32 s47, s47, 4096
  v_mfma_f32_16x16x32_bf16 v[224:227], a[148:151], v[34:37], v[224:227]
  v_add_f32 v105, v105, v107
  v_mfma_f32_16x16x32_bf16 v[228:231], a[152:155], v[34:37], v[228:231]
  v_add_f32 v108, v108, v110
  v_mfma_f32_16x16x32_bf16 v[232:235], a[144:147], v[38:41], v[232:235]
  buffer_load_dwordx4 a[80:83], v2, s[8:11], s47 offen offset:0 sc1
  v_mfma_f32_16x16x32_bf16 v[236:239], a[148:151], v[38:41], v[236:239]
  v_add_f32 v109, v109, v111
  v_mfma_f32_16x16x32_bf16 v[240:243], a[152:155], v[38:41], v[240:243]
  v_add_f32 v112, v112, v114
  v_mfma_f32_16x16x32_bf16 v[80:83], a[144:147], v[42:45], v[80:83]
  buffer_load_dwordx4 a[84:87], v2, s[8:11], s47 offen offset:1024 sc1
  v_mfma_f32_16x16x32_bf16 v[84:87], a[148:151], v[42:45], v[84:87]
  v_add_f32 v113, v113, v115
  v_mfma_f32_16x16x32_bf16 v[88:91], a[152:155], v[42:45], v[88:91]
  v_add_f32 v116, v116, v118
  s_waitcnt lgkmcnt(0)
  v_mfma_f32_16x16x32_bf16 v[160:163], a[156:159], v[46:49], v[160:163]
  ds_read_b128 v[14:17], v92 offset:14336
  v_mfma_f32_16x16x32_bf16 v[164:167], a[160:163], v[46:49], v[164:167]
  ds_read_b128 v[18:21], v92 offset:34816
  v_mfma_f32_16x16x32_bf16 v[168:171], a[164:167], v[46:49], v[168:171]
  ds_read_b128 v[22:25], v92 offset:55296
  v_mfma_f32_16x16x32_bf16 v[172:175], a[156:159], v[50:53], v[172:175]
  ds_read_b128 v[26:29], v93 offset:14336
  v_mfma_f32_16x16x32_bf16 v[176:179], a[160:163], v[50:53], v[176:179]
  ds_read_b128 v[30:33], v93 offset:34816
  v_mfma_f32_16x16x32_bf16 v[180:183], a[164:167], v[50:53], v[180:183]
  ds_read_b128 v[34:37], v93 offset:55296
  v_mfma_f32_16x16x32_bf16 v[184:187], a[156:159], v[54:57], v[184:187]
  ds_read_b128 v[38:41], v94 offset:14336
  v_mfma_f32_16x16x32_bf16 v[188:191], a[160:163], v[54:57], v[188:191]
  ds_read_b128 v[42:45], v94 offset:34816
  v_mfma_f32_16x16x32_bf16 v[192:195], a[164:167], v[54:57], v[192:195]
  buffer_load_dwordx4 a[88:91], v2, s[8:11], s47 offen offset:2048 sc1
  v_mfma_f32_16x16x32_bf16 v[196:199], a[156:159], v[58:61], v[196:199]
  v_add_f32 v117, v117, v119
  v_mfma_f32_16x16x32_bf16 v[200:203], a[160:163], v[58:61], v[200:203]
  v_add_f32 v120, v120, v122
  v_mfma_f32_16x16x32_bf16 v[204:207], a[164:167], v[58:61], v[204:207]
  v_add_f32 v121, v121, v123
  v_mfma_f32_16x16x32_bf16 v[208:211], a[156:159], v[62:65], v[208:211]
  buffer_load_dwordx4 a[92:95], v2, s[8:11], s47 offen offset:3072 sc1
  s_add_u32 s47, s47, 4096
  v_mfma_f32_16x16x32_bf16 v[212:215], a[160:163], v[62:65], v[212:215]
  v_add_f32 v124, v124, v126
  v_mfma_f32_16x16x32_bf16 v[216:219], a[164:167], v[62:65], v[216:219]
  v_add_f32 v125, v125, v127
  v_mfma_f32_16x16x32_bf16 v[220:223], a[156:159], v[66:69], v[220:223]
  buffer_load_dwordx4 a[96:99], v2, s[8:11], s47 offen offset:0 sc1
  v_mfma_f32_16x16x32_bf16 v[224:227], a[160:163], v[66:69], v[224:227]
  s_nop 1
  v_permlane32_swap_b32 v96, v112
  v_mfma_f32_16x16x32_bf16 v[228:231], a[164:167], v[66:69], v[228:231]
  v_permlane32_swap_b32 v97, v113
  v_mfma_f32_16x16x32_bf16 v[232:235], a[156:159], v[70:73], v[232:235]
  buffer_load_dwordx4 a[100:103], v2, s[8:11], s47 offen offset:1024 sc1
  v_mfma_f32_16x16x32_bf16 v[236:239], a[160:163], v[70:73], v[236:239]
  v_permlane32_swap_b32 v100, v116
  v_mfma_f32_16x16x32_bf16 v[240:243], a[164:167], v[70:73], v[240:243]
  v_permlane32_swap_b32 v101, v117
  v_mfma_f32_16x16x32_bf16 v[80:83], a[156:159], v[74:77], v[80:83]
  buffer_load_dwordx4 a[104:107], v2, s[8:11], s47 offen offset:2048 sc1
  v_mfma_f32_16x16x32_bf16 v[84:87], a[160:163], v[74:77], v[84:87]
  v_permlane32_swap_b32 v104, v120
  v_mfma_f32_16x16x32_bf16 v[88:91], a[164:167], v[74:77], v[88:91]
  v_permlane32_swap_b32 v105, v121
  s_waitcnt lgkmcnt(0)
  v_mfma_f32_16x16x32_bf16 v[160:163], a[168:171], v[14:17], v[160:163]
  ds_read_b128 v[46:49], v92 offset:15360
  v_mfma_f32_16x16x32_bf16 v[164:167], a[172:175], v[14:17], v[164:167]
  ds_read_b128 v[50:53], v92 offset:35840
  v_mfma_f32_16x16x32_bf16 v[168:171], a[176:179], v[14:17], v[168:171]
  ds_read_b128 v[54:57], v92 offset:56320
  v_mfma_f32_16x16x32_bf16 v[172:175], a[168:171], v[18:21], v[172:175]
  ds_read_b128 v[58:61], v93 offset:15360
  v_mfma_f32_16x16x32_bf16 v[176:179], a[172:175], v[18:21], v[176:179]
  ds_read_b128 v[62:65], v93 offset:35840
  v_mfma_f32_16x16x32_bf16 v[180:183], a[176:179], v[18:21], v[180:183]
  ds_read_b128 v[66:69], v93 offset:56320
  v_mfma_f32_16x16x32_bf16 v[184:187], a[168:171], v[22:25], v[184:187]
  ds_read_b128 v[70:73], v94 offset:15360
  v_mfma_f32_16x16x32_bf16 v[188:191], a[172:175], v[22:25], v[188:191]
  ds_read_b128 v[74:77], v94 offset:35840
  v_mfma_f32_16x16x32_bf16 v[192:195], a[176:179], v[22:25], v[192:195]
  buffer_load_dwordx4 a[108:111], v2, s[8:11], s47 offen offset:3072 sc1
  s_add_u32 s47, s47, 4096
  v_mfma_f32_16x16x32_bf16 v[196:199], a[168:171], v[26:29], v[196:199]
  v_permlane32_swap_b32 v108, v124
  v_mfma_f32_16x16x32_bf16 v[200:203], a[172:175], v[26:29], v[200:203]
  v_permlane32_swap_b32 v109, v125
  v_mfma_f32_16x16x32_bf16 v[204:207], a[176:179], v[26:29], v[204:207]
  s_nop 1
  v_add_f32 v96, v96, v112
  v_mfma_f32_16x16x32_bf16 v[208:211], a[168:171], v[30:33], v[208:211]
  buffer_load_dwordx4 a[112:115], v2, s[8:11], s47 offen offset:0 sc1
  v_mfma_f32_16x16x32_bf16 v[212:215], a[172:175], v[30:33], v[212:215]
  v_add_f32 v97, v97, v113
  v_mfma_f32_16x16x32_bf16 v[216:219], a[176:179], v[30:33], v[216:219]
  v_add_f32 v100, v100, v116
  v_mfma_f32_16x16x32_bf16 v[220:223], a[168:171], v[34:37], v[220:223]
  buffer_load_dwordx4 a[116:119], v2, s[8:11], s47 offen offset:1024 sc1
  v_mfma_f32_16x16x32_bf16 v[224:227], a[172:175], v[34:37], v[224:227]
  v_add_f32 v101, v101, v117
  v_mfma_f32_16x16x32_bf16 v[228:231], a[176:179], v[34:37], v[228:231]
  v_add_f32 v104, v104, v120
  v_mfma_f32_16x16x32_bf16 v[232:235], a[168:171], v[38:41], v[232:235]
  buffer_load_dwordx4 a[120:123], v2, s[8:11], s47 offen offset:2048 sc1
  v_mfma_f32_16x16x32_bf16 v[236:239], a[172:175], v[38:41], v[236:239]
  v_add_f32 v105, v105, v121
  v_mfma_f32_16x16x32_bf16 v[240:243], a[176:179], v[38:41], v[240:243]
  v_add_f32 v108, v108, v124
  v_mfma_f32_16x16x32_bf16 v[80:83], a[168:171], v[42:45], v[80:83]
  buffer_load_dwordx4 a[124:127], v2, s[8:11], s47 offen offset:3072 sc1
  s_add_u32 s47, s47, 4096
  v_mfma_f32_16x16x32_bf16 v[84:87], a[172:175], v[42:45], v[84:87]
  v_add_f32 v109, v109, v125
  v_mfma_f32_16x16x32_bf16 v[88:91], a[176:179], v[42:45], v[88:91]
  s_nop 1
  v_permlane16_swap_b32 v96, v104
  s_waitcnt lgkmcnt(0)
  v_mfma_f32_16x16x32_bf16 v[160:163], a[180:183], v[46:49], v[160:163]
  ds_read_b128 v[14:17], v92 offset:16384
  v_mfma_f32_16x16x32_bf16 v[164:167], a[184:187], v[46:49], v[164:167]
  ds_read_b128 v[18:21], v92 offset:36864
  v_mfma_f32_16x16x32_bf16 v[168:171], a[188:191], v[46:49], v[168:171]
  ds_read_b128 v[22:25], v92 offset:57344
  v_mfma_f32_16x16x32_bf16 v[172:175], a[180:183], v[50:53], v[172:175]
  ds_read_b128 v[26:29], v93 offset:16384
  v_mfma_f32_16x16x32_bf16 v[176:179], a[184:187], v[50:53], v[176:179]
  ds_read_b128 v[30:33], v93 offset:36864
  v_mfma_f32_16x16x32_bf16 v[180:183], a[188:191], v[50:53], v[180:183]
  ds_read_b128 v[34:37], v93 offset:57344
  v_mfma_f32_16x16x32_bf16 v[184:187], a[180:183], v[54:57], v[184:187]
  ds_read_b128 v[38:41], v94 offset:16384
  v_mfma_f32_16x16x32_bf16 v[188:191], a[184:187], v[54:57], v[188:191]
  ds_read_b128 v[42:45], v94 offset:36864
  v_mfma_f32_16x16x32_bf16 v[192:195], a[188:191], v[54:57], v[192:195]
  buffer_load_dwordx4 a[128:131], v2, s[8:11], s47 offen offset:0 sc1
  v_mfma_f32_16x16x32_bf16 v[196:199], a[180:183], v[58:61], v[196:199]
  v_permlane16_swap_b32 v97, v105
  v_mfma_f32_16x16x32_bf16 v[200:203], a[184:187], v[58:61], v[200:203]
  v_permlane16_swap_b32 v100, v108
  v_mfma_f32_16x16x32_bf16 v[204:207], a[188:191], v[58:61], v[204:207]
  v_permlane16_swap_b32 v101, v109
  v_mfma_f32_16x16x32_bf16 v[208:211], a[180:183], v[62:65], v[208:211]
  buffer_load_dwordx4 a[132:135], v2, s[8:11], s47 offen offset:1024 sc1
  v_mfma_f32_16x16x32_bf16 v[212:215], a[184:187], v[62:65], v[212:215]
  s_nop 1
  v_add_f32 v96, v96, v104
  v_mfma_f32_16x16x32_bf16 v[216:219], a[188:191], v[62:65], v[216:219]
  v_add_f32 v97, v97, v105
  v_mfma_f32_16x16x32_bf16 v[220:223], a[180:183], v[66:69], v[220:223]
  buffer_load_dwordx4 a[136:139], v2, s[8:11], s47 offen offset:2048 sc1
  v_mfma_f32_16x16x32_bf16 v[224:227], a[184:187], v[66:69], v[224:227]
  v_add_f32 v100, v100, v108
  v_mfma_f32_16x16x32_bf16 v[228:231], a[188:191], v[66:69], v[228:231]
  v_add_f32 v101, v101, v109
  v_mfma_f32_16x16x32_bf16 v[232:235], a[180:183], v[70:73], v[232:235]
  buffer_load_dwordx4 a[140:143], v2, s[8:11], s47 offen offset:3072 sc1
  s_add_u32 s47, s47, 4096
  v_mfma_f32_16x16x32_bf16 v[236:239], a[184:187], v[70:73], v[236:239]
  v_mul_f32 v96, 0xbacccccd, v96
  v_mfma_f32_16x16x32_bf16 v[240:243], a[188:191], v[70:73], v[240:243]
  v_mul_f32 v97, 0x3acccccd, v97
  v_mfma_f32_16x16x32_bf16 v[80:83], a[180:183], v[74:77], v[80:83]
  buffer_load_dwordx4 a[144:147], v2, s[8:11], s47 offen offset:0 sc1
  v_mfma_f32_16x16x32_bf16 v[84:87], a[184:187], v[74:77], v[84:87]
  v_fma_f32 v97, -v96, v96, v97
  v_mfma_f32_16x16x32_bf16 v[88:91], a[188:191], v[74:77], v[88:91]
  v_max_f32 v97, 0, v97
  s_waitcnt lgkmcnt(0)
  v_mfma_f32_16x16x32_bf16 v[160:163], a[192:195], v[14:17], v[160:163]
  ds_read_b128 v[46:49], v92 offset:17408
  v_mfma_f32_16x16x32_bf16 v[164:167], a[196:199], v[14:17], v[164:167]
  ds_read_b128 v[50:53], v92 offset:37888
  v_mfma_f32_16x16x32_bf16 v[168:171], a[200:203], v[14:17], v[168:171]
  ds_read_b128 v[54:57], v92 offset:58368
  v_mfma_f32_16x16x32_bf16 v[172:175], a[192:195], v[18:21], v[172:175]
  ds_read_b128 v[58:61], v93 offset:17408
  v_mfma_f32_16x16x32_bf16 v[176:179], a[196:199], v[18:21], v[176:179]
  ds_read_b128 v[62:65], v93 offset:37888
  v_mfma_f32_16x16x32_bf16 v[180:183], a[200:203], v[18:21], v[180:183]
  ds_read_b128 v[66:69], v93 offset:58368
  v_mfma_f32_16x16x32_bf16 v[184:187], a[192:195], v[22:25], v[184:187]
  ds_read_b128 v[70:73], v94 offset:17408
  v_mfma_f32_16x16x32_bf16 v[188:191], a[196:199], v[22:25], v[188:191]
  ds_read_b128 v[74:77], v94 offset:37888
  v_mfma_f32_16x16x32_bf16 v[192:195], a[200:203], v[22:25], v[192:195]
  buffer_load_dwordx4 a[148:151], v2, s[8:11], s47 offen offset:1024 sc1
  v_mfma_f32_16x16x32_bf16 v[196:199], a[192:195], v[26:29], v[196:199]
  v_add_f32 v97, 0x3727c5ac, v97
  v_mfma_f32_16x16x32_bf16 v[200:203], a[196:199], v[26:29], v[200:203]
  v_rcp_f32 v97, v97
  v_mfma_f32_16x16x32_bf16 v[204:207], a[200:203], v[26:29], v[204:207]
  v_mul_f32 v100, 0xbacccccd, v100
  v_mfma_f32_16x16x32_bf16 v[208:211], a[192:195], v[30:33], v[208:211]
  buffer_load_dwordx4 a[152:155], v2, s[8:11], s47 offen offset:2048 sc1
  v_mfma_f32_16x16x32_bf16 v[212:215], a[196:199], v[30:33], v[212:215]
  v_mul_f32 v101, 0x3acccccd, v101
  v_mfma_f32_16x16x32_bf16 v[216:219], a[200:203], v[30:33], v[216:219]
  v_fma_f32 v101, -v100, v100, v101
  v_mfma_f32_16x16x32_bf16 v[220:223], a[192:195], v[34:37], v[220:223]
  buffer_load_dwordx4 a[156:159], v2, s[8:11], s47 offen offset:3072 sc1
  s_add_u32 s47, s47, 4096
  v_mfma_f32_16x16x32_bf16 v[224:227], a[196:199], v[34:37], v[224:227]
  v_max_f32 v101, 0, v101
  v_mfma_f32_16x16x32_bf16 v[228:231], a[200:203], v[34:37], v[228:231]
  v_add_f32 v101, 0x3727c5ac, v101
  v_mfma_f32_16x16x32_bf16 v[232:235], a[192:195], v[38:41], v[232:235]
  buffer_load_dwordx4 a[160:163], v2, s[8:11], s47 offen offset:0 sc1
  v_mfma_f32_16x16x32_bf16 v[236:239], a[196:199], v[38:41], v[236:239]
  v_rcp_f32 v101, v101
  v_mfma_f32_16x16x32_bf16 v[240:243], a[200:203], v[38:41], v[240:243]
  s_nop 0
  v_mov_b32 v104, v96
  v_mfma_f32_16x16x32_bf16 v[80:83], a[192:195], v[42:45], v[80:83]
  buffer_load_dwordx4 a[164:167], v2, s[8:11], s47 offen offset:1024 sc1
  v_mfma_f32_16x16x32_bf16 v[84:87], a[196:199], v[42:45], v[84:87]
  v_mov_b32 v108, v96
  v_mfma_f32_16x16x32_bf16 v[88:91], a[200:203], v[42:45], v[88:91]
  v_mov_b32 v105, v97
  s_waitcnt lgkmcnt(0)
  v_mfma_f32_16x16x32_bf16 v[160:163], a[204:207], v[46:49], v[160:163]
  ds_read_b128 v[14:17], v92 offset:18432
  v_mfma_f32_16x16x32_bf16 v[164:167], a[208:211], v[46:49], v[164:167]
  ds_read_b128 v[18:21], v92 offset:38912
  v_mfma_f32_16x16x32_bf16 v[168:171], a[212:215], v[46:49], v[168:171]
  ds_read_b128 v[22:25], v92 offset:59392
  v_mfma_f32_16x16x32_bf16 v[172:175], a[204:207], v[50:53], v[172:175]
  ds_read_b128 v[26:29], v93 offset:18432
  v_mfma_f32_16x16x32_bf16 v[176:179], a[208:211], v[50:53], v[176:179]
  ds_read_b128 v[30:33], v93 offset:38912
  v_mfma_f32_16x16x32_bf16 v[180:183], a[212:215], v[50:53], v[180:183]
  ds_read_b128 v[34:37], v93 offset:59392
  v_mfma_f32_16x16x32_bf16 v[184:187], a[204:207], v[54:57], v[184:187]
  ds_read_b128 v[38:41], v94 offset:18432
  v_mfma_f32_16x16x32_bf16 v[188:191], a[208:211], v[54:57], v[188:191]
  ds_read_b128 v[42:45], v94 offset:38912
  v_mfma_f32_16x16x32_bf16 v[192:195], a[212:215], v[54:57], v[192:195]
  buffer_load_dwordx4 a[168:171], v2, s[8:11], s47 offen offset:2048 sc1
  v_mfma_f32_16x16x32_bf16 v[196:199], a[204:207], v[58:61], v[196:199]
  v_mov_b32 v109, v97
  v_mfma_f32_16x16x32_bf16 v[200:203], a[208:211], v[58:61], v[200:203]
  v_mov_b32 v106, v100
  v_mfma_f32_16x16x32_bf16 v[204:207], a[212:215], v[58:61], v[204:207]
  v_mov_b32 v110, v100
  v_mfma_f32_16x16x32_bf16 v[208:211], a[204:207], v[62:65], v[208:211]
  buffer_load_dwordx4 a[172:175], v2, s[8:11], s47 offen offset:3072 sc1
  s_add_u32 s47, s47, 4096
  v_mfma_f32_16x16x32_bf16 v[212:215], a[208:211], v[62:65], v[212:215]
  v_mov_b32 v107, v101
  v_mfma_f32_16x16x32_bf16 v[216:219], a[212:215], v[62:65], v[216:219]
  v_mov_b32 v111, v101
  v_mfma_f32_16x16x32_bf16 v[220:223], a[204:207], v[66:69], v[220:223]
  buffer_load_dwordx4 a[176:179], v2, s[8:11], s47 offen offset:0 sc1
  v_mfma_f32_16x16x32_bf16 v[224:227], a[208:211], v[66:69], v[224:227]
  s_nop 1
  v_permlane16_swap_b32 v104, v108
  v_mfma_f32_16x16x32_bf16 v[228:231], a[212:215], v[66:69], v[228:231]
  v_permlane16_swap_b32 v105, v109
  v_mfma_f32_16x16x32_bf16 v[232:235], a[204:207], v[70:73], v[232:235]
  buffer_load_dwordx4 a[180:183], v2, s[8:11], s47 offen offset:1024 sc1
  v_mfma_f32_16x16x32_bf16 v[236:239], a[208:211], v[70:73], v[236:239]
  v_permlane16_swap_b32 v106, v110
  v_mfma_f32_16x16x32_bf16 v[240:243], a[212:215], v[70:73], v[240:243]
  v_permlane16_swap_b32 v107, v111
  v_mfma_f32_16x16x32_bf16 v[80:83], a[204:207], v[74:77], v[80:83]
  buffer_load_dwordx4 a[184:187], v2, s[8:11], s47 offen offset:2048 sc1
  v_mfma_f32_16x16x32_bf16 v[84:87], a[208:211], v[74:77], v[84:87]
  s_nop 0
  v_mov_b32 v112, v104
  v_mfma_f32_16x16x32_bf16 v[88:91], a[212:215], v[74:77], v[88:91]
  v_mov_b32 v116, v108
  s_waitcnt lgkmcnt(0)
  v_mfma_f32_16x16x32_bf16 v[160:163], a[216:219], v[14:17], v[160:163]
  ds_read_b128 v[46:49], v92 offset:19456
  v_mfma_f32_16x16x32_bf16 v[164:167], a[220:223], v[14:17], v[164:167]
  ds_read_b128 v[50:53], v92 offset:39936
  v_mfma_f32_16x16x32_bf16 v[168:171], a[224:227], v[14:17], v[168:171]
  ds_read_b128 v[54:57], v92 offset:60416
  v_mfma_f32_16x16x32_bf16 v[172:175], a[216:219], v[18:21], v[172:175]
  ds_read_b128 v[58:61], v93 offset:19456
  v_mfma_f32_16x16x32_bf16 v[176:179], a[220:223], v[18:21], v[176:179]
  ds_read_b128 v[62:65], v93 offset:39936
  v_mfma_f32_16x16x32_bf16 v[180:183], a[224:227], v[18:21], v[180:183]
  ds_read_b128 v[66:69], v93 offset:60416
  v_mfma_f32_16x16x32_bf16 v[184:187], a[216:219], v[22:25], v[184:187]
  ds_read_b128 v[70:73], v94 offset:19456
  v_mfma_f32_16x16x32_bf16 v[188:191], a[220:223], v[22:25], v[188:191]
  ds_read_b128 v[74:77], v94 offset:39936
  v_mfma_f32_16x16x32_bf16 v[192:195], a[224:227], v[22:25], v[192:195]
  buffer_load_dwordx4 a[188:191], v2, s[8:11], s47 offen offset:3072 sc1
  s_add_u32 s47, s47, 4096
  v_mfma_f32_16x16x32_bf16 v[196:199], a[216:219], v[26:29], v[196:199]
  v_mov_b32 v113, v105
  v_mfma_f32_16x16x32_bf16 v[200:203], a[220:223], v[26:29], v[200:203]
  v_mov_b32 v117, v109
  v_mfma_f32_16x16x32_bf16 v[204:207], a[224:227], v[26:29], v[204:207]
  v_mov_b32 v114, v106
  v_mfma_f32_16x16x32_bf16 v[208:211], a[216:219], v[30:33], v[208:211]
  buffer_load_dwordx4 a[192:195], v2, s[8:11], s47 offen offset:0 sc1
  v_mfma_f32_16x16x32_bf16 v[212:215], a[220:223], v[30:33], v[212:215]
  v_mov_b32 v118, v110
  v_mfma_f32_16x16x32_bf16 v[216:219], a[224:227], v[30:33], v[216:219]
  v_mov_b32 v115, v107
  v_mfma_f32_16x16x32_bf16 v[220:223], a[216:219], v[34:37], v[220:223]
  buffer_load_dwordx4 a[196:199], v2, s[8:11], s47 offen offset:1024 sc1
  v_mfma_f32_16x16x32_bf16 v[224:227], a[220:223], v[34:37], v[224:227]
  v_mov_b32 v119, v111
  v_mfma_f32_16x16x32_bf16 v[228:231], a[224:227], v[34:37], v[228:231]
  s_nop 1
  v_permlane32_swap_b32 v104, v112
  v_mfma_f32_16x16x32_bf16 v[232:235], a[216:219], v[38:41], v[232:235]
  buffer_load_dwordx4 a[200:203], v2, s[8:11], s47 offen offset:2048 sc1
  v_mfma_f32_16x16x32_bf16 v[236:239], a[220:223], v[38:41], v[236:239]
  v_permlane32_swap_b32 v108, v116
  v_mfma_f32_16x16x32_bf16 v[240:243], a[224:227], v[38:41], v[240:243]
  v_permlane32_swap_b32 v105, v113
  v_mfma_f32_16x16x32_bf16 v[80:83], a[216:219], v[42:45], v[80:83]
  buffer_load_dwordx4 a[204:207], v2, s[8:11], s47 offen offset:3072 sc1
  s_add_u32 s47, s47, 4096
  v_mfma_f32_16x16x32_bf16 v[84:87], a[220:223], v[42:45], v[84:87]
  v_permlane32_swap_b32 v109, v117
  v_mfma_f32_16x16x32_bf16 v[88:91], a[224:227], v[42:45], v[88:91]
  v_permlane32_swap_b32 v106, v114
  s_waitcnt lgkmcnt(0)
  v_mfma_f32_16x16x32_bf16 v[160:163], a[228:231], v[46:49], v[160:163]
  v_permlane32_swap_b32 v110, v118
  v_mfma_f32_16x16x32_bf16 v[164:167], a[232:235], v[46:49], v[164:167]
  v_permlane32_swap_b32 v107, v115
  v_mfma_f32_16x16x32_bf16 v[168:171], a[236:239], v[46:49], v[168:171]
  v_permlane32_swap_b32 v111, v119
  v_mfma_f32_16x16x32_bf16 v[172:175], a[228:231], v[50:53], v[172:175]
  v_mfma_f32_16x16x32_bf16 v[176:179], a[232:235], v[50:53], v[176:179]
  v_mfma_f32_16x16x32_bf16 v[180:183], a[236:239], v[50:53], v[180:183]
  v_mfma_f32_16x16x32_bf16 v[184:187], a[228:231], v[54:57], v[184:187]
  v_mfma_f32_16x16x32_bf16 v[188:191], a[232:235], v[54:57], v[188:191]
  v_mfma_f32_16x16x32_bf16 v[192:195], a[236:239], v[54:57], v[192:195]
  buffer_load_dwordx4 a[208:211], v2, s[8:11], s47 offen offset:0 sc1
  v_mfma_f32_16x16x32_bf16 v[196:199], a[228:231], v[58:61], v[196:199]
  v_mfma_f32_16x16x32_bf16 v[200:203], a[232:235], v[58:61], v[200:203]
  v_mfma_f32_16x16x32_bf16 v[204:207], a[236:239], v[58:61], v[204:207]
  v_mfma_f32_16x16x32_bf16 v[208:211], a[228:231], v[62:65], v[208:211]
  buffer_load_dwordx4 a[212:215], v2, s[8:11], s47 offen offset:1024 sc1
  v_mfma_f32_16x16x32_bf16 v[212:215], a[232:235], v[62:65], v[212:215]
  v_mfma_f32_16x16x32_bf16 v[216:219], a[236:239], v[62:65], v[216:219]
  v_mfma_f32_16x16x32_bf16 v[220:223], a[228:231], v[66:69], v[220:223]
  buffer_load_dwordx4 a[216:219], v2, s[8:11], s47 offen offset:2048 sc1
  v_mfma_f32_16x16x32_bf16 v[224:227], a[232:235], v[66:69], v[224:227]
  v_mfma_f32_16x16x32_bf16 v[228:231], a[236:239], v[66:69], v[228:231]
  v_mfma_f32_16x16x32_bf16 v[232:235], a[228:231], v[70:73], v[232:235]
  buffer_load_dwordx4 a[220:223], v2, s[8:11], s47 offen offset:3072 sc1
  s_add_u32 s47, s47, 4096
  v_mfma_f32_16x16x32_bf16 v[236:239], a[232:235], v[70:73], v[236:239]
  v_mfma_f32_16x16x32_bf16 v[240:243], a[236:239], v[70:73], v[240:243]
  v_mfma_f32_16x16x32_bf16 v[80:83], a[228:231], v[74:77], v[80:83]
  buffer_load_dwordx4 a[224:227], v2, s[8:11], s47 offen offset:0 sc1
  v_mfma_f32_16x16x32_bf16 v[84:87], a[232:235], v[74:77], v[84:87]
  v_mfma_f32_16x16x32_bf16 v[88:91], a[236:239], v[74:77], v[88:91]
  s_mul_i32 s33, s51, 393216
  s_mul_i32 s34, s50, 768
  s_add_u32 s33, s33, s34
  s_mul_i32 s34, s26, 327680
  s_add_u32 s33, s33, s34
  s_add_u32 s33, s33, 327680
  v_pk_fma_f32 v[160:161], v[136:137], v[104:105], v[160:161] op_sel_hi:[1,0,1]
  v_pk_fma_f32 v[162:163], v[138:139], v[104:105], v[162:163] op_sel_hi:[1,0,1]
  v_pk_fma_f32 v[164:165], v[140:141], v[104:105], v[164:165] op_sel_hi:[1,0,1]
  v_pk_fma_f32 v[166:167], v[142:143], v[104:105], v[166:167] op_sel_hi:[1,0,1]
  v_pk_fma_f32 v[168:169], v[152:153], v[104:105], v[168:169] op_sel_hi:[1,0,1]
  v_pk_fma_f32 v[170:171], v[154:155], v[104:105], v[170:171] op_sel_hi:[1,0,1]
  v_pk_mul_f32 v[160:161], v[160:161], v[104:105] op_sel:[0,1]
  v_pk_mul_f32 v[164:165], v[164:165], v[104:105] op_sel:[0,1]
  v_pk_mul_f32 v[168:169], v[168:169], v[104:105] op_sel:[0,1]
  v_pk_mul_f32 v[160:161], v[160:161], v[162:163]
  v_pk_mul_f32 v[164:165], v[164:165], v[166:167]
  v_pk_mul_f32 v[168:169], v[168:169], v[170:171]
  v_cvt_pk_bf16_f32 v48, v160, v161
  v_cvt_pk_bf16_f32 v52, v164, v165
  v_cvt_pk_bf16_f32 v56, v168, v169
  v_pk_fma_f32 v[172:173], v[136:137], v[106:107], v[172:173] op_sel_hi:[1,0,1]
  v_pk_fma_f32 v[174:175], v[138:139], v[106:107], v[174:175] op_sel_hi:[1,0,1]
  v_pk_fma_f32 v[176:177], v[140:141], v[106:107], v[176:177] op_sel_hi:[1,0,1]
  v_pk_fma_f32 v[178:179], v[142:143], v[106:107], v[178:179] op_sel_hi:[1,0,1]
  v_pk_fma_f32 v[180:181], v[152:153], v[106:107], v[180:181] op_sel_hi:[1,0,1]
  v_pk_fma_f32 v[182:183], v[154:155], v[106:107], v[182:183] op_sel_hi:[1,0,1]
  v_pk_mul_f32 v[172:173], v[172:173], v[106:107] op_sel:[0,1]
  v_pk_mul_f32 v[176:177], v[176:177], v[106:107] op_sel:[0,1]
  v_pk_mul_f32 v[180:181], v[180:181], v[106:107] op_sel:[0,1]
  v_pk_mul_f32 v[172:173], v[172:173], v[174:175]
  v_pk_mul_f32 v[176:177], v[176:177], v[178:179]
  v_pk_mul_f32 v[180:181], v[180:181], v[182:183]
  v_cvt_pk_bf16_f32 v49, v172, v173
  v_cvt_pk_bf16_f32 v53, v176, v177
  v_cvt_pk_bf16_f32 v57, v180, v181
  v_pk_fma_f32 v[184:185], v[136:137], v[108:109], v[184:185] op_sel_hi:[1,0,1]
  v_pk_fma_f32 v[186:187], v[138:139], v[108:109], v[186:187] op_sel_hi:[1,0,1]
  v_pk_fma_f32 v[188:189], v[140:141], v[108:109], v[188:189] op_sel_hi:[1,0,1]
  v_pk_fma_f32 v[190:191], v[142:143], v[108:109], v[190:191] op_sel_hi:[1,0,1]
  v_pk_fma_f32 v[192:193], v[152:153], v[108:109], v[192:193] op_sel_hi:[1,0,1]
  v_pk_fma_f32 v[194:195], v[154:155], v[108:109], v[194:195] op_sel_hi:[1,0,1]
  v_pk_mul_f32 v[184:185], v[184:185], v[108:109] op_sel:[0,1]
  v_pk_mul_f32 v[188:189], v[188:189], v[108:109] op_sel:[0,1]
  v_pk_mul_f32 v[192:193], v[192:193], v[108:109] op_sel:[0,1]
  v_pk_mul_f32 v[184:185], v[184:185], v[186:187]
  v_pk_mul_f32 v[188:189], v[188:189], v[190:191]
  v_pk_mul_f32 v[192:193], v[192:193], v[194:195]
  v_cvt_pk_bf16_f32 v50, v184, v185
  v_cvt_pk_bf16_f32 v54, v188, v189
  v_cvt_pk_bf16_f32 v58, v192, v193
  v_pk_fma_f32 v[196:197], v[136:137], v[110:111], v[196:197] op_sel_hi:[1,0,1]
  v_pk_fma_f32 v[198:199], v[138:139], v[110:111], v[198:199] op_sel_hi:[1,0,1]
  v_pk_fma_f32 v[200:201], v[140:141], v[110:111], v[200:201] op_sel_hi:[1,0,1]
  v_pk_fma_f32 v[202:203], v[142:143], v[110:111], v[202:203] op_sel_hi:[1,0,1]
  v_pk_fma_f32 v[204:205], v[152:153], v[110:111], v[204:205] op_sel_hi:[1,0,1]
  v_pk_fma_f32 v[206:207], v[154:155], v[110:111], v[206:207] op_sel_hi:[1,0,1]
  v_pk_mul_f32 v[196:197], v[196:197], v[110:111] op_sel:[0,1]
  v_pk_mul_f32 v[200:201], v[200:201], v[110:111] op_sel:[0,1]
  v_pk_mul_f32 v[204:205], v[204:205], v[110:111] op_sel:[0,1]
  v_pk_mul_f32 v[196:197], v[196:197], v[198:199]
  v_pk_mul_f32 v[200:201], v[200:201], v[202:203]
  v_pk_mul_f32 v[204:205], v[204:205], v[206:207]
  v_cvt_pk_bf16_f32 v51, v196, v197
  v_cvt_pk_bf16_f32 v55, v200, v201
  v_cvt_pk_bf16_f32 v59, v204, v205
  s_nop 1
  v_permlane16_swap_b32 v48, v49
  v_permlane16_swap_b32 v50, v51
  v_permlane16_swap_b32 v52, v53
  v_permlane16_swap_b32 v54, v55
  v_permlane16_swap_b32 v56, v57
  v_permlane16_swap_b32 v58, v59
  s_nop 1
  v_permlane32_swap_b32 v48, v50
  v_permlane32_swap_b32 v49, v51
  v_permlane32_swap_b32 v52, v54
  v_permlane32_swap_b32 v53, v55
  v_permlane32_swap_b32 v56, v58
  v_permlane32_swap_b32 v57, v59
  s_cmp_eq_u32 s30, 0
  s_cbranch_scc1 L_wt_2140
  buffer_store_dwordx4 v[48:51], v95, s[8:11], s33 offen offset:0
  buffer_store_dwordx4 v[52:55], v95, s[8:11], s33 offen offset:256
  buffer_store_dwordx4 v[56:59], v95, s[8:11], s33 offen offset:512
L_wj_2141:
  s_add_u32 s33, s33, 196608
  v_pk_fma_f32 v[208:209], v[136:137], v[112:113], v[208:209] op_sel_hi:[1,0,1]
  v_pk_fma_f32 v[210:211], v[138:139], v[112:113], v[210:211] op_sel_hi:[1,0,1]
  v_pk_fma_f32 v[212:213], v[140:141], v[112:113], v[212:213] op_sel_hi:[1,0,1]
  v_pk_fma_f32 v[214:215], v[142:143], v[112:113], v[214:215] op_sel_hi:[1,0,1]
  v_pk_fma_f32 v[216:217], v[152:153], v[112:113], v[216:217] op_sel_hi:[1,0,1]
  v_pk_fma_f32 v[218:219], v[154:155], v[112:113], v[218:219] op_sel_hi:[1,0,1]
  v_pk_mul_f32 v[208:209], v[208:209], v[112:113] op_sel:[0,1]
  v_pk_mul_f32 v[212:213], v[212:213], v[112:113] op_sel:[0,1]
  v_pk_mul_f32 v[216:217], v[216:217], v[112:113] op_sel:[0,1]
  v_pk_mul_f32 v[208:209], v[208:209], v[210:211]
  v_pk_mul_f32 v[212:213], v[212:213], v[214:215]
  v_pk_mul_f32 v[216:217], v[216:217], v[218:219]
  v_cvt_pk_bf16_f32 v60, v208, v209
  v_cvt_pk_bf16_f32 v64, v212, v213
  v_cvt_pk_bf16_f32 v68, v216, v217
  v_pk_fma_f32 v[220:221], v[136:137], v[114:115], v[220:221] op_sel_hi:[1,0,1]
  v_pk_fma_f32 v[222:223], v[138:139], v[114:115], v[222:223] op_sel_hi:[1,0,1]
  v_pk_fma_f32 v[224:225], v[140:141], v[114:115], v[224:225] op_sel_hi:[1,0,1]
  v_pk_fma_f32 v[226:227], v[142:143], v[114:115], v[226:227] op_sel_hi:[1,0,1]
  v_pk_fma_f32 v[228:229], v[152:153], v[114:115], v[228:229] op_sel_hi:[1,0,1]
  v_pk_fma_f32 v[230:231], v[154:155], v[114:115], v[230:231] op_sel_hi:[1,0,1]
  v_pk_mul_f32 v[220:221], v[220:221], v[114:115] op_sel:[0,1]
  v_pk_mul_f32 v[224:225], v[224:225], v[114:115] op_sel:[0,1]
  v_pk_mul_f32 v[228:229], v[228:229], v[114:115] op_sel:[0,1]
  v_pk_mul_f32 v[220:221], v[220:221], v[222:223]
  v_pk_mul_f32 v[224:225], v[224:225], v[226:227]
  v_pk_mul_f32 v[228:229], v[228:229], v[230:231]
  v_cvt_pk_bf16_f32 v61, v220, v221
  v_cvt_pk_bf16_f32 v65, v224, v225
  v_cvt_pk_bf16_f32 v69, v228, v229
  v_pk_fma_f32 v[232:233], v[136:137], v[116:117], v[232:233] op_sel_hi:[1,0,1]
  v_pk_fma_f32 v[234:235], v[138:139], v[116:117], v[234:235] op_sel_hi:[1,0,1]
  v_pk_fma_f32 v[236:237], v[140:141], v[116:117], v[236:237] op_sel_hi:[1,0,1]
  v_pk_fma_f32 v[238:239], v[142:143], v[116:117], v[238:239] op_sel_hi:[1,0,1]
  v_pk_fma_f32 v[240:241], v[152:153], v[116:117], v[240:241] op_sel_hi:[1,0,1]
  v_pk_fma_f32 v[242:243], v[154:155], v[116:117], v[242:243] op_sel_hi:[1,0,1]
  v_pk_mul_f32 v[232:233], v[232:233], v[116:117] op_sel:[0,1]
  v_pk_mul_f32 v[236:237], v[236:237], v[116:117] op_sel:[0,1]
  v_pk_mul_f32 v[240:241], v[240:241], v[116:117] op_sel:[0,1]
  v_pk_mul_f32 v[232:233], v[232:233], v[234:235]
  v_pk_mul_f32 v[236:237], v[236:237], v[238:239]
  v_pk_mul_f32 v[240:241], v[240:241], v[242:243]
  v_cvt_pk_bf16_f32 v62, v232, v233
  v_cvt_pk_bf16_f32 v66, v236, v237
  v_cvt_pk_bf16_f32 v70, v240, v241
  v_pk_fma_f32 v[80:81], v[136:137], v[118:119], v[80:81] op_sel_hi:[1,0,1]
  v_pk_fma_f32 v[82:83], v[138:139], v[118:119], v[82:83] op_sel_hi:[1,0,1]
  v_pk_fma_f32 v[84:85], v[140:141], v[118:119], v[84:85] op_sel_hi:[1,0,1]
  v_pk_fma_f32 v[86:87], v[142:143], v[118:119], v[86:87] op_sel_hi:[1,0,1]
  v_pk_fma_f32 v[88:89], v[152:153], v[118:119], v[88:89] op_sel_hi:[1,0,1]
  v_pk_fma_f32 v[90:91], v[154:155], v[118:119], v[90:91] op_sel_hi:[1,0,1]
  v_pk_mul_f32 v[80:81], v[80:81], v[118:119] op_sel:[0,1]
  v_pk_mul_f32 v[84:85], v[84:85], v[118:119] op_sel:[0,1]
  v_pk_mul_f32 v[88:89], v[88:89], v[118:119] op_sel:[0,1]
  v_pk_mul_f32 v[80:81], v[80:81], v[82:83]
  v_pk_mul_f32 v[84:85], v[84:85], v[86:87]
  v_pk_mul_f32 v[88:89], v[88:89], v[90:91]
  v_cvt_pk_bf16_f32 v63, v80, v81
  v_cvt_pk_bf16_f32 v67, v84, v85
  v_cvt_pk_bf16_f32 v71, v88, v89
  s_nop 1
  v_permlane16_swap_b32 v60, v61
  v_permlane16_swap_b32 v62, v63
  v_permlane16_swap_b32 v64, v65
  v_permlane16_swap_b32 v66, v67
  v_permlane16_swap_b32 v68, v69
  v_permlane16_swap_b32 v70, v71
  s_nop 1
  v_permlane32_swap_b32 v60, v62
  v_permlane32_swap_b32 v61, v63
  v_permlane32_swap_b32 v64, v66
  v_permlane32_swap_b32 v65, v67
  v_permlane32_swap_b32 v68, v70
  v_permlane32_swap_b32 v69, v71
  s_cmp_eq_u32 s30, 0
  s_cbranch_scc1 L_wt_2142
  buffer_store_dwordx4 v[60:63], v95, s[8:11], s33 offen offset:0
  buffer_store_dwordx4 v[64:67], v95, s[8:11], s33 offen offset:256
  buffer_store_dwordx4 v[68:71], v95, s[8:11], s33 offen offset:512
L_wj_2143:
  s_lshl_b32 s33, s51, 8
  s_add_u32 s33, s33, 32515072
  s_lshl_b32 s34, s50, 2
  s_add_u32 s43, s33, s34
  s_lshl_b32 s34, s28, 6
  s_add_u32 s44, s33, s34
  s_mul_i32 s35, s28, 12288
  s_add_u32 s35, s35, 327680
  s_mul_i32 s33, s26, 327680
  s_add_u32 s35, s35, s33
  s_add_u32 s33, s28, 0
  s_and_b32 s33, s33, 3
  s_add_u32 s33, s33, s42
  s_mul_i32 s33, s33, 49152
  s_add_u32 s60, s33, s35
  s_add_u32 s33, s28, 1
  s_and_b32 s33, s33, 3
  s_add_u32 s33, s33, s42
  s_mul_i32 s33, s33, 49152
  s_add_u32 s61, s33, s35
  s_add_u32 s33, s28, 2
  s_and_b32 s33, s33, 3
  s_add_u32 s33, s33, s42
  s_mul_i32 s33, s33, 49152
  s_add_u32 s62, s33, s35
  s_add_u32 s33, s28, 3
  s_and_b32 s33, s33, 3
  s_add_u32 s33, s33, s42
  s_mul_i32 s33, s33, 49152
  s_add_u32 s63, s33, s35
  v_readfirstlane_b32 s52, v13
  s_mul_i32 s33, s28, 15360
  s_movk_i32 s34, 1120
  v_add_u32 v239, 0, v1
  v_min_u32 v239, 159, v239
  v_mul_u32_u24 v240, 205, v239
  v_lshrrev_b32 v240, 11, v240
  v_lshlrev_b32 v239, 4, v239
  v_mad_u32_u24 v236, v240, s34, v239
  v_add_u32 v239, 64, v1
  v_min_u32 v239, 159, v239
  v_mul_u32_u24 v240, 205, v239
  v_lshrrev_b32 v240, 11, v240
  v_lshlrev_b32 v239, 4, v239
  v_mad_u32_u24 v237, v240, s34, v239
  v_add_u32 v239, 128, v1
  v_min_u32 v239, 159, v239
  v_mul_u32_u24 v240, 205, v239
  v_lshrrev_b32 v240, 11, v240
  v_lshlrev_b32 v239, 4, v239
  v_mad_u32_u24 v238, v240, s34, v239
  v_and_b32 v240, 15, v1
  v_lshrrev_b32 v241, 4, v1
  v_lshl_add_u32 v240, v240, 2, v241
  v_mul_u32_u24 v240, 40, v240
  v_add_u32 v239, s33, v240
  v_mov_b32 v11, s100
  v_mov_b32 v12, 0
  s_mov_b64 exec, 1
  s_waitcnt vmcnt(0)
  s_cmp_eq_u32 s30, 0
  s_cbranch_scc1 L_wt_2144
  buffer_store_dword v11, v12, s[8:11], s43 offen
L_wj_2145:
  s_mov_b64 exec, -1
  s_barrier
  v_and_b32 v12, 15, v1
  s_mov_b32 s31, 200000
  v_lshlrev_b32 v12, 2, v12
L_poll_2146:
  buffer_load_dword v11, v12, s[8:11], s44 offen sc1
  s_sub_u32 s31, s31, 1
  s_waitcnt vmcnt(0)
  v_cmp_ne_u32 vcc, s100, v11
  s_cbranch_scc1 L_pout_2147
  s_cbranch_vccnz L_poll_2146
L_pout_2147:
  buffer_load_dwordx4 v[14:17], v2, s[8:11], s61 offen offset:0 sc1
  buffer_load_dwordx4 v[18:21], v2, s[8:11], s61 offen offset:1024 sc1
  buffer_load_dwordx4 v[22:25], v2, s[8:11], s61 offen offset:2048 sc1
  buffer_load_dwordx4 v[26:29], v2, s[8:11], s61 offen offset:3072 sc1
  s_add_u32 s61, s61, 4096
  buffer_load_dwordx4 v[30:33], v2, s[8:11], s61 offen offset:0 sc1
  buffer_load_dwordx4 v[34:37], v2, s[8:11], s61 offen offset:1024 sc1
  buffer_load_dwordx4 v[38:41], v2, s[8:11], s61 offen offset:2048 sc1
  buffer_load_dwordx4 v[42:45], v2, s[8:11], s61 offen offset:3072 sc1
  s_add_u32 s61, s61, 4096
  s_waitcnt vmcnt(7)
  v_mfma_f32_16x16x32_bf16 v[112:115], a[0:3], v[14:17], 0
  buffer_load_dwordx4 v[46:49], v2, s[8:11], s61 offen offset:0 sc1
  v_mfma_f32_16x16x32_bf16 v[116:119], a[4:7], v[14:17], 0
  v_mfma_f32_16x16x32_bf16 v[120:123], a[8:11], v[14:17], 0
  v_mfma_f32_16x16x32_bf16 v[124:127], a[12:15], v[14:17], 0
  v_mfma_f32_16x16x32_bf16 v[128:131], a[16:19], v[14:17], 0
  s_waitcnt vmcnt(7)
  v_mfma_f32_16x16x32_bf16 v[112:115], a[20:23], v[18:21], v[112:115]
  buffer_load_dwordx4 v[50:53], v2, s[8:11], s61 offen offset:1024 sc1
  v_mfma_f32_16x16x32_bf16 v[116:119], a[24:27], v[18:21], v[116:119]
  v_mfma_f32_16x16x32_bf16 v[120:123], a[28:31], v[18:21], v[120:123]
  v_mfma_f32_16x16x32_bf16 v[124:127], a[32:35], v[18:21], v[124:127]
  v_mfma_f32_16x16x32_bf16 v[128:131], a[36:39], v[18:21], v[128:131]
  s_waitcnt vmcnt(7)
  v_mfma_f32_16x16x32_bf16 v[112:115], a[40:43], v[22:25], v[112:115]
  buffer_load_dwordx4 v[54:57], v2, s[8:11], s61 offen offset:2048 sc1
  v_mfma_f32_16x16x32_bf16 v[116:119], a[44:47], v[22:25], v[116:119]
  v_mfma_f32_16x16x32_bf16 v[120:123], a[48:51], v[22:25], v[120:123]
  v_mfma_f32_16x16x32_bf16 v[124:127], a[52:55], v[22:25], v[124:127]
  v_mfma_f32_16x16x32_bf16 v[128:131], a[56:59], v[22:25], v[128:131]
  s_waitcnt vmcnt(7)
  v_mfma_f32_16x16x32_bf16 v[112:115], a[60:63], v[26:29], v[112:115]
  buffer_load_dwordx4 v[58:61], v2, s[8:11], s61 offen offset:3072 sc1
  v_mfma_f32_16x16x32_bf16 v[116:119], a[64:67], v[26:29], v[116:119]
  v_mfma_f32_16x16x32_bf16 v[120:123], a[68:71], v[26:29], v[120:123]
  v_mfma_f32_16x16x32_bf16 v[124:127], a[72:75], v[26:29], v[124:127]
  v_mfma_f32_16x16x32_bf16 v[128:131], a[76:79], v[26:29], v[128:131]
  s_waitcnt vmcnt(7)
  v_mfma_f32_16x16x32_bf16 v[112:115], a[80:83], v[30:33], v[112:115]
  buffer_load_dwordx4 v[62:65], v2, s[8:11], s62 offen offset:0 sc1
  v_mfma_f32_16x16x32_bf16 v[116:119], a[84:87], v[30:33], v[116:119]
  v_mfma_f32_16x16x32_bf16 v[120:123], a[88:91], v[30:33], v[120:123]
  v_mfma_f32_16x16x32_bf16 v[124:127], a[92:95], v[30:33], v[124:127]
  v_mfma_f32_16x16x32_bf16 v[128:131], a[96:99], v[30:33], v[128:131]
  s_waitcnt vmcnt(7)
  v_mfma_f32_16x16x32_bf16 v[112:115], a[100:103], v[34:37], v[112:115]
  buffer_load_dwordx4 v[66:69], v2, s[8:11], s62 offen offset:1024 sc1
  v_mfma_f32_16x16x32_bf16 v[116:119], a[104:107], v[34:37], v[116:119]
  v_mfma_f32_16x16x32_bf16 v[120:123], a[108:111], v[34:37], v[120:123]
  v_mfma_f32_16x16x32_bf16 v[124:127], a[112:115], v[34:37], v[124:127]
  v_mfma_f32_16x16x32_bf16 v[128:131], a[116:119], v[34:37], v[128:131]
  s_waitcnt vmcnt(7)
  v_mfma_f32_16x16x32_bf16 v[112:115], a[120:123], v[38:41], v[112:115]
  buffer_load_dwordx4 v[70:73], v2, s[8:11], s62 offen offset:2048 sc1
  v_mfma_f32_16x16x32_bf16 v[116:119], a[124:127], v[38:41], v[116:119]
  v_mfma_f32_16x16x32_bf16 v[120:123], a[128:131], v[38:41], v[120:123]
  v_mfma_f32_16x16x32_bf16 v[124:127], a[132:135], v[38:41], v[124:127]
  v_mfma_f32_16x16x32_bf16 v[128:131], a[136:139], v[38:41], v[128:131]
  s_waitcnt vmcnt(7)
  v_mfma_f32_16x16x32_bf16 v[112:115], a[140:143], v[42:45], v[112:115]
  buffer_load_dwordx4 v[74:77], v2, s[8:11], s62 offen offset:3072 sc1
  s_add_u32 s62, s62, 4096
  v_mfma_f32_16x16x32_bf16 v[116:119], a[144:147], v[42:45], v[116:119]
  v_mfma_f32_16x16x32_bf16 v[120:123], a[148:151], v[42:45], v[120:123]
  v_mfma_f32_16x16x32_bf16 v[124:127], a[152:155], v[42:45], v[124:127]
  v_mfma_f32_16x16x32_bf16 v[128:131], a[156:159], v[42:45], v[128:131]
  s_waitcnt vmcnt(7)
  v_mfma_f32_16x16x32_bf16 v[112:115], a[160:163], v[46:49], v[112:115]
  buffer_load_dwordx4 v[78:81], v2, s[8:11], s62 offen offset:0 sc1
  v_mfma_f32_16x16x32_bf16 v[116:119], a[164:167], v[46:49], v[116:119]
  v_mfma_f32_16x16x32_bf16 v[120:123], a[168:171], v[46:49], v[120:123]
  v_mfma_f32_16x16x32_bf16 v[124:127], a[172:175], v[46:49], v[124:127]
  v_mfma_f32_16x16x32_bf16 v[128:131], a[176:179], v[46:49], v[128:131]
  s_waitcnt vmcnt(7)
  v_mfma_f32_16x16x32_bf16 v[112:115], a[180:183], v[50:53], v[112:115]
  buffer_load_dwordx4 v[82:85], v2, s[8:11], s62 offen offset:1024 sc1
  v_mfma_f32_16x16x32_bf16 v[116:119], a[184:187], v[50:53], v[116:119]
  v_mfma_f32_16x16x32_bf16 v[120:123], a[188:191], v[50:53], v[120:123]
  v_mfma_f32_16x16x32_bf16 v[124:127], a[192:195], v[50:53], v[124:127]
  v_mfma_f32_16x16x32_bf16 v[128:131], a[196:199], v[50:53], v[128:131]
  s_waitcnt vmcnt(7)
  v_mfma_f32_16x16x32_bf16 v[112:115], a[200:203], v[54:57], v[112:115]
  buffer_load_dwordx4 v[86:89], v2, s[8:11], s62 offen offset:2048 sc1
  v_mfma_f32_16x16x32_bf16 v[116:119], a[204:207], v[54:57], v[116:119]
  v_mfma_f32_16x16x32_bf16 v[120:123], a[208:211], v[54:57], v[120:123]
  v_mfma_f32_16x16x32_bf16 v[124:127], a[212:215], v[54:57], v[124:127]
  v_mfma_f32_16x16x32_bf16 v[128:131], a[216:219], v[54:57], v[128:131]
  s_waitcnt vmcnt(7)
  v_mfma_f32_16x16x32_bf16 v[112:115], a[220:223], v[58:61], v[112:115]
  buffer_load_dwordx4 v[90:93], v2, s[8:11], s62 offen offset:3072 sc1
  s_add_u32 s62, s62, 4096
  v_mfma_f32_16x16x32_bf16 v[116:119], a[224:227], v[58:61], v[116:119]
  v_mfma_f32_16x16x32_bf16 v[120:123], a[240:243], v[58:61], v[120:123]
  v_mfma_f32_16x16x32_bf16 v[124:127], a[244:247], v[58:61], v[124:127]
  v_mfma_f32_16x16x32_bf16 v[128:131], a[248:251], v[58:61], v[128:131]
  s_waitcnt vmcnt(7)
  v_mfma_f32_16x16x32_bf16 v[132:135], a[0:3], v[62:65], 0
  buffer_load_dwordx4 v[94:97], v2, s[8:11], s62 offen offset:0 sc1
  v_mfma_f32_16x16x32_bf16 v[136:139], a[4:7], v[62:65], 0
  v_mfma_f32_16x16x32_bf16 v[140:143], a[8:11], v[62:65], 0
  v_mfma_f32_16x16x32_bf16 v[144:147], a[12:15], v[62:65], 0
  v_mfma_f32_16x16x32_bf16 v[148:151], a[16:19], v[62:65], 0
  s_waitcnt vmcnt(7)
  v_mfma_f32_16x16x32_bf16 v[132:135], a[20:23], v[66:69], v[132:135]
  buffer_load_dwordx4 v[98:101], v2, s[8:11], s62 offen offset:1024 sc1
  v_mfma_f32_16x16x32_bf16 v[136:139], a[24:27], v[66:69], v[136:139]
  v_mfma_f32_16x16x32_bf16 v[140:143], a[28:31], v[66:69], v[140:143]
  v_mfma_f32_16x16x32_bf16 v[144:147], a[32:35], v[66:69], v[144:147]
  v_mfma_f32_16x16x32_bf16 v[148:151], a[36:39], v[66:69], v[148:151]
  s_waitcnt vmcnt(7)
  v_mfma_f32_16x16x32_bf16 v[132:135], a[40:43], v[70:73], v[132:135]
  buffer_load_dwordx4 v[102:105], v2, s[8:11], s62 offen offset:2048 sc1
  ds_write_b128 v3, v[112:115] offset:0
  v_mfma_f32_16x16x32_bf16 v[136:139], a[44:47], v[70:73], v[136:139]
  ds_write_b128 v3, v[116:119] offset:1024
  v_mfma_f32_16x16x32_bf16 v[140:143], a[48:51], v[70:73], v[140:143]
  ds_write_b128 v3, v[120:123] offset:2048
  v_mfma_f32_16x16x32_bf16 v[144:147], a[52:55], v[70:73], v[144:147]
  ds_write_b128 v3, v[124:127] offset:3072
  v_mfma_f32_16x16x32_bf16 v[148:151], a[56:59], v[70:73], v[148:151]
  ds_write_b128 v3, v[128:131] offset:4096
  s_waitcnt vmcnt(7)
  v_mfma_f32_16x16x32_bf16 v[132:135], a[60:63], v[74:77], v[132:135]
  buffer_load_dwordx4 v[106:109], v2, s[8:11], s62 offen offset:3072 sc1
  v_mfma_f32_16x16x32_bf16 v[136:139], a[64:67], v[74:77], v[136:139]
  v_mfma_f32_16x16x32_bf16 v[140:143], a[68:71], v[74:77], v[140:143]
  v_mfma_f32_16x16x32_bf16 v[144:147], a[72:75], v[74:77], v[144:147]
  v_mfma_f32_16x16x32_bf16 v[148:151], a[76:79], v[74:77], v[148:151]
  s_waitcnt vmcnt(7)
  v_mfma_f32_16x16x32_bf16 v[132:135], a[80:83], v[78:81], v[132:135]
  buffer_load_dwordx4 v[14:17], v2, s[8:11], s63 offen offset:0 sc1
  v_mfma_f32_16x16x32_bf16 v[136:139], a[84:87], v[78:81], v[136:139]
  v_mfma_f32_16x16x32_bf16 v[140:143], a[88:91], v[78:81], v[140:143]
  v_mfma_f32_16x16x32_bf16 v[144:147], a[92:95], v[78:81], v[144:147]
  v_mfma_f32_16x16x32_bf16 v[148:151], a[96:99], v[78:81], v[148:151]
  s_waitcnt vmcnt(7)
  v_mfma_f32_16x16x32_bf16 v[132:135], a[100:103], v[82:85], v[132:135]
  buffer_load_dwordx4 v[18:21], v2, s[8:11], s63 offen offset:1024 sc1
  v_mfma_f32_16x16x32_bf16 v[136:139], a[104:107], v[82:85], v[136:139]
  v_mfma_f32_16x16x32_bf16 v[140:143], a[108:111], v[82:85], v[140:143]
  v_mfma_f32_16x16x32_bf16 v[144:147], a[112:115], v[82:85], v[144:147]
  v_mfma_f32_16x16x32_bf16 v[148:151], a[116:119], v[82:85], v[148:151]
  s_waitcnt vmcnt(7)
  v_mfma_f32_16x16x32_bf16 v[132:135], a[120:123], v[86:89], v[132:135]
  buffer_load_dwordx4 v[22:25], v2, s[8:11], s63 offen offset:2048 sc1
  v_mfma_f32_16x16x32_bf16 v[136:139], a[124:127], v[86:89], v[136:139]
  v_mfma_f32_16x16x32_bf16 v[140:143], a[128:131], v[86:89], v[140:143]
  v_mfma_f32_16x16x32_bf16 v[144:147], a[132:135], v[86:89], v[144:147]
  v_mfma_f32_16x16x32_bf16 v[148:151], a[136:139], v[86:89], v[148:151]
  s_waitcnt vmcnt(7)
  v_mfma_f32_16x16x32_bf16 v[132:135], a[140:143], v[90:93], v[132:135]
  buffer_load_dwordx4 v[26:29], v2, s[8:11], s63 offen offset:3072 sc1
  s_add_u32 s63, s63, 4096
  v_mfma_f32_16x16x32_bf16 v[136:139], a[144:147], v[90:93], v[136:139]
  v_mfma_f32_16x16x32_bf16 v[140:143], a[148:151], v[90:93], v[140:143]
  v_mfma_f32_16x16x32_bf16 v[144:147], a[152:155], v[90:93], v[144:147]
  v_mfma_f32_16x16x32_bf16 v[148:151], a[156:159], v[90:93], v[148:151]
  s_waitcnt vmcnt(7)
  v_mfma_f32_16x16x32_bf16 v[132:135], a[160:163], v[94:97], v[132:135]
  buffer_load_dwordx4 v[30:33], v2, s[8:11], s63 offen offset:0 sc1
  v_mfma_f32_16x16x32_bf16 v[136:139], a[164:167], v[94:97], v[136:139]
  v_mfma_f32_16x16x32_bf16 v[140:143], a[168:171], v[94:97], v[140:143]
  v_mfma_f32_16x16x32_bf16 v[144:147], a[172:175], v[94:97], v[144:147]
  v_mfma_f32_16x16x32_bf16 v[148:151], a[176:179], v[94:97], v[148:151]
  s_waitcnt vmcnt(7)
  v_mfma_f32_16x16x32_bf16 v[132:135], a[180:183], v[98:101], v[132:135]
  buffer_load_dwordx4 v[34:37], v2, s[8:11], s63 offen offset:1024 sc1
  v_mfma_f32_16x16x32_bf16 v[136:139], a[184:187], v[98:101], v[136:139]
  v_mfma_f32_16x16x32_bf16 v[140:143], a[188:191], v[98:101], v[140:143]
  v_mfma_f32_16x16x32_bf16 v[144:147], a[192:195], v[98:101], v[144:147]
  v_mfma_f32_16x16x32_bf16 v[148:151], a[196:199], v[98:101], v[148:151]
  s_waitcnt vmcnt(7)
  v_mfma_f32_16x16x32_bf16 v[132:135], a[200:203], v[102:105], v[132:135]
  buffer_load_dwordx4 v[38:41], v2, s[8:11], s63 offen offset:2048 sc1
  v_mfma_f32_16x16x32_bf16 v[136:139], a[204:207], v[102:105], v[136:139]
  v_mfma_f32_16x16x32_bf16 v[140:143], a[208:211], v[102:105], v[140:143]
  v_mfma_f32_16x16x32_bf16 v[144:147], a[212:215], v[102:105], v[144:147]
  v_mfma_f32_16x16x32_bf16 v[148:151], a[216:219], v[102:105], v[148:151]
  s_waitcnt vmcnt(7)
  v_mfma_f32_16x16x32_bf16 v[132:135], a[220:223], v[106:109], v[132:135]
  buffer_load_dwordx4 v[42:45], v2, s[8:11], s63 offen offset:3072 sc1
  s_add_u32 s63, s63, 4096
  v_mfma_f32_16x16x32_bf16 v[136:139], a[224:227], v[106:109], v[136:139]
  v_mfma_f32_16x16x32_bf16 v[140:143], a[240:243], v[106:109], v[140:143]
  v_mfma_f32_16x16x32_bf16 v[144:147], a[244:247], v[106:109], v[144:147]
  v_mfma_f32_16x16x32_bf16 v[148:151], a[248:251], v[106:109], v[148:151]
  s_waitcnt vmcnt(7)
  v_mfma_f32_16x16x32_bf16 v[152:155], a[0:3], v[14:17], 0
  v_lshlrev_b32 v112, 16, v244
  v_and_b32 v113, 0xffff0000, v244
  buffer_load_dwordx4 v[46:49], v2, s[8:11], s63 offen offset:0 sc1
  v_mfma_f32_16x16x32_bf16 v[156:159], a[4:7], v[14:17], 0
  v_lshlrev_b32 v114, 16, v245
  v_and_b32 v115, 0xffff0000, v245
  v_mfma_f32_16x16x32_bf16 v[160:163], a[8:11], v[14:17], 0
  v_lshlrev_b32 v116, 16, v246
  v_and_b32 v117, 0xffff0000, v246
  v_mfma_f32_16x16x32_bf16 v[164:167], a[12:15], v[14:17], 0
  v_lshlrev_b32 v118, 16, v247
  v_and_b32 v119, 0xffff0000, v247
  v_mfma_f32_16x16x32_bf16 v[168:171], a[16:19], v[14:17], 0
  v_lshlrev_b32 v120, 16, v248
  v_and_b32 v121, 0xffff0000, v248
  s_waitcnt vmcnt(7)
  v_mfma_f32_16x16x32_bf16 v[152:155], a[20:23], v[18:21], v[152:155]
  v_lshlrev_b32 v122, 16, v249
  v_and_b32 v123, 0xffff0000, v249
  buffer_load_dwordx4 v[50:53], v2, s[8:11], s63 offen offset:1024 sc1
  v_mfma_f32_16x16x32_bf16 v[156:159], a[24:27], v[18:21], v[156:159]
  v_lshlrev_b32 v124, 16, v250
  v_and_b32 v125, 0xffff0000, v250
  v_mfma_f32_16x16x32_bf16 v[160:163], a[28:31], v[18:21], v[160:163]
  v_lshlrev_b32 v126, 16, v251
  v_and_b32 v127, 0xffff0000, v251
  v_mfma_f32_16x16x32_bf16 v[164:167], a[32:35], v[18:21], v[164:167]
  v_lshlrev_b32 v128, 16, v252
  v_and_b32 v129, 0xffff0000, v252
  v_mfma_f32_16x16x32_bf16 v[168:171], a[36:39], v[18:21], v[168:171]
  v_lshlrev_b32 v130, 16, v253
  v_and_b32 v131, 0xffff0000, v253
  s_waitcnt vmcnt(7)
  v_mfma_f32_16x16x32_bf16 v[152:155], a[40:43], v[22:25], v[152:155]
  buffer_load_dwordx4 v[54:57], v2, s[8:11], s63 offen offset:2048 sc1
  ds_write_b128 v4, v[132:135] offset:0
  v_mfma_f32_16x16x32_bf16 v[156:159], a[44:47], v[22:25], v[156:159]
  ds_write_b128 v4, v[136:139] offset:1024
  v_mfma_f32_16x16x32_bf16 v[160:163], a[48:51], v[22:25], v[160:163]
  ds_write_b128 v4, v[140:143] offset:2048
  v_mfma_f32_16x16x32_bf16 v[164:167], a[52:55], v[22:25], v[164:167]
  ds_write_b128 v4, v[144:147] offset:3072
  v_mfma_f32_16x16x32_bf16 v[168:171], a[56:59], v[22:25], v[168:171]
  ds_write_b128 v4, v[148:151] offset:4096
  s_waitcnt vmcnt(7)
  v_mfma_f32_16x16x32_bf16 v[152:155], a[60:63], v[26:29], v[152:155]
  buffer_load_dwordx4 v[58:61], v2, s[8:11], s63 offen offset:3072 sc1
  v_mfma_f32_16x16x32_bf16 v[156:159], a[64:67], v[26:29], v[156:159]
  v_mfma_f32_16x16x32_bf16 v[160:163], a[68:71], v[26:29], v[160:163]
  v_mfma_f32_16x16x32_bf16 v[164:167], a[72:75], v[26:29], v[164:167]
  v_mfma_f32_16x16x32_bf16 v[168:171], a[76:79], v[26:29], v[168:171]
  s_waitcnt vmcnt(7)
  v_mfma_f32_16x16x32_bf16 v[152:155], a[80:83], v[30:33], v[152:155]
  buffer_load_dwordx4 v[62:65], v2, s[8:11], s60 offen offset:0 sc1
  v_mfma_f32_16x16x32_bf16 v[156:159], a[84:87], v[30:33], v[156:159]
  v_mfma_f32_16x16x32_bf16 v[160:163], a[88:91], v[30:33], v[160:163]
  v_mfma_f32_16x16x32_bf16 v[164:167], a[92:95], v[30:33], v[164:167]
  v_mfma_f32_16x16x32_bf16 v[168:171], a[96:99], v[30:33], v[168:171]
  s_waitcnt vmcnt(7)
  v_mfma_f32_16x16x32_bf16 v[152:155], a[100:103], v[34:37], v[152:155]
  buffer_load_dwordx4 v[66:69], v2, s[8:11], s60 offen offset:1024 sc1
  v_mfma_f32_16x16x32_bf16 v[156:159], a[104:107], v[34:37], v[156:159]
  v_mfma_f32_16x16x32_bf16 v[160:163], a[108:111], v[34:37], v[160:163]
  v_mfma_f32_16x16x32_bf16 v[164:167], a[112:115], v[34:37], v[164:167]
  v_mfma_f32_16x16x32_bf16 v[168:171], a[116:119], v[34:37], v[168:171]
  s_waitcnt vmcnt(7)
  v_mfma_f32_16x16x32_bf16 v[152:155], a[120:123], v[38:41], v[152:155]
  buffer_load_dwordx4 v[70:73], v2, s[8:11], s60 offen offset:2048 sc1
  v_mfma_f32_16x16x32_bf16 v[156:159], a[124:127], v[38:41], v[156:159]
  v_mfma_f32_16x16x32_bf16 v[160:163], a[128:131], v[38:41], v[160:163]
  v_mfma_f32_16x16x32_bf16 v[164:167], a[132:135], v[38:41], v[164:167]
  v_mfma_f32_16x16x32_bf16 v[168:171], a[136:139], v[38:41], v[168:171]
  s_waitcnt vmcnt(7)
  v_mfma_f32_16x16x32_bf16 v[152:155], a[140:143], v[42:45], v[152:155]
  buffer_load_dwordx4 v[74:77], v2, s[8:11], s60 offen offset:3072 sc1
  s_add_u32 s60, s60, 4096
  v_mfma_f32_16x16x32_bf16 v[156:159], a[144:147], v[42:45], v[156:159]
  v_mfma_f32_16x16x32_bf16 v[160:163], a[148:151], v[42:45], v[160:163]
  v_mfma_f32_16x16x32_bf16 v[164:167], a[152:155], v[42:45], v[164:167]
  v_mfma_f32_16x16x32_bf16 v[168:171], a[156:159], v[42:45], v[168:171]
  s_waitcnt vmcnt(7)
  v_mfma_f32_16x16x32_bf16 v[152:155], a[160:163], v[46:49], v[152:155]
  buffer_load_dwordx4 v[78:81], v2, s[8:11], s60 offen offset:0 sc1
  v_mfma_f32_16x16x32_bf16 v[156:159], a[164:167], v[46:49], v[156:159]
  v_mfma_f32_16x16x32_bf16 v[160:163], a[168:171], v[46:49], v[160:163]
  v_mfma_f32_16x16x32_bf16 v[164:167], a[172:175], v[46:49], v[164:167]
  v_mfma_f32_16x16x32_bf16 v[168:171], a[176:179], v[46:49], v[168:171]
  s_waitcnt vmcnt(7)
  v_mfma_f32_16x16x32_bf16 v[152:155], a[180:183], v[50:53], v[152:155]
  buffer_load_dwordx4 v[82:85], v2, s[8:11], s60 offen offset:1024 sc1
  v_mfma_f32_16x16x32_bf16 v[156:159], a[184:187], v[50:53], v[156:159]
  v_mfma_f32_16x16x32_bf16 v[160:163], a[188:191], v[50:53], v[160:163]
  v_mfma_f32_16x16x32_bf16 v[164:167], a[192:195], v[50:53], v[164:167]
  v_mfma_f32_16x16x32_bf16 v[168:171], a[196:199], v[50:53], v[168:171]
  s_waitcnt vmcnt(7)
  v_mfma_f32_16x16x32_bf16 v[152:155], a[200:203], v[54:57], v[152:155]
  buffer_load_dwordx4 v[86:89], v2, s[8:11], s60 offen offset:2048 sc1
  v_mfma_f32_16x16x32_bf16 v[156:159], a[204:207], v[54:57], v[156:159]
  v_mfma_f32_16x16x32_bf16 v[160:163], a[208:211], v[54:57], v[160:163]
  v_mfma_f32_16x16x32_bf16 v[164:167], a[212:215], v[54:57], v[164:167]
  v_mfma_f32_16x16x32_bf16 v[168:171], a[216:219], v[54:57], v[168:171]
  s_waitcnt vmcnt(7)
  v_mfma_f32_16x16x32_bf16 v[152:155], a[220:223], v[58:61], v[152:155]
  buffer_load_dwordx4 v[90:93], v2, s[8:11], s60 offen offset:3072 sc1
  s_add_u32 s60, s60, 4096
  v_mfma_f32_16x16x32_bf16 v[156:159], a[224:227], v[58:61], v[156:159]
  v_mfma_f32_16x16x32_bf16 v[160:163], a[240:243], v[58:61], v[160:163]
  v_mfma_f32_16x16x32_bf16 v[164:167], a[244:247], v[58:61], v[164:167]
  v_mfma_f32_16x16x32_bf16 v[168:171], a[248:251], v[58:61], v[168:171]
  s_waitcnt vmcnt(7)
  v_mfma_f32_16x16x32_bf16 v[112:115], a[0:3], v[62:65], v[112:115]
  buffer_load_dwordx4 v[94:97], v2, s[8:11], s60 offen offset:0 sc1
  v_mfma_f32_16x16x32_bf16 v[116:119], a[4:7], v[62:65], v[116:119]
  v_mfma_f32_16x16x32_bf16 v[120:123], a[8:11], v[62:65], v[120:123]
  v_mfma_f32_16x16x32_bf16 v[124:127], a[12:15], v[62:65], v[124:127]
  v_mfma_f32_16x16x32_bf16 v[128:131], a[16:19], v[62:65], v[128:131]
  s_waitcnt vmcnt(7)
  v_mfma_f32_16x16x32_bf16 v[112:115], a[20:23], v[66:69], v[112:115]
  buffer_load_dwordx4 v[98:101], v2, s[8:11], s60 offen offset:1024 sc1
  v_mfma_f32_16x16x32_bf16 v[116:119], a[24:27], v[66:69], v[116:119]
  v_mfma_f32_16x16x32_bf16 v[120:123], a[28:31], v[66:69], v[120:123]
  v_mfma_f32_16x16x32_bf16 v[124:127], a[32:35], v[66:69], v[124:127]
  v_mfma_f32_16x16x32_bf16 v[128:131], a[36:39], v[66:69], v[128:131]
  s_waitcnt vmcnt(7)
  v_mfma_f32_16x16x32_bf16 v[112:115], a[40:43], v[70:73], v[112:115]
  buffer_load_dwordx4 v[102:105], v2, s[8:11], s60 offen offset:2048 sc1
  ds_write_b128 v5, v[152:155] offset:0
  v_mfma_f32_16x16x32_bf16 v[116:119], a[44:47], v[70:73], v[116:119]
  ds_write_b128 v5, v[156:159] offset:1024
  v_mfma_f32_16x16x32_bf16 v[120:123], a[48:51], v[70:73], v[120:123]
  ds_write_b128 v5, v[160:163] offset:2048
  v_mfma_f32_16x16x32_bf16 v[124:127], a[52:55], v[70:73], v[124:127]
  ds_write_b128 v5, v[164:167] offset:3072
  v_mfma_f32_16x16x32_bf16 v[128:131], a[56:59], v[70:73], v[128:131]
  ds_write_b128 v5, v[168:171] offset:4096
  s_waitcnt vmcnt(7)
  v_mfma_f32_16x16x32_bf16 v[112:115], a[60:63], v[74:77], v[112:115]
  buffer_load_dwordx4 v[106:109], v2, s[8:11], s60 offen offset:3072 sc1
  v_mfma_f32_16x16x32_bf16 v[116:119], a[64:67], v[74:77], v[116:119]
  v_mfma_f32_16x16x32_bf16 v[120:123], a[68:71], v[74:77], v[120:123]
  v_mfma_f32_16x16x32_bf16 v[124:127], a[72:75], v[74:77], v[124:127]
  v_mfma_f32_16x16x32_bf16 v[128:131], a[76:79], v[74:77], v[128:131]
  s_waitcnt vmcnt(7)
  v_mfma_f32_16x16x32_bf16 v[112:115], a[80:83], v[78:81], v[112:115]
  v_mfma_f32_16x16x32_bf16 v[116:119], a[84:87], v[78:81], v[116:119]
  v_mfma_f32_16x16x32_bf16 v[120:123], a[88:91], v[78:81], v[120:123]
  v_mfma_f32_16x16x32_bf16 v[124:127], a[92:95], v[78:81], v[124:127]
  v_mfma_f32_16x16x32_bf16 v[128:131], a[96:99], v[78:81], v[128:131]
  s_waitcnt vmcnt(6)
  v_mfma_f32_16x16x32_bf16 v[112:115], a[100:103], v[82:85], v[112:115]
  v_mfma_f32_16x16x32_bf16 v[116:119], a[104:107], v[82:85], v[116:119]
  v_mfma_f32_16x16x32_bf16 v[120:123], a[108:111], v[82:85], v[120:123]
  v_mfma_f32_16x16x32_bf16 v[124:127], a[112:115], v[82:85], v[124:127]
  v_mfma_f32_16x16x32_bf16 v[128:131], a[116:119], v[82:85], v[128:131]
  s_waitcnt vmcnt(5)
  v_mfma_f32_16x16x32_bf16 v[112:115], a[120:123], v[86:89], v[112:115]
  v_mfma_f32_16x16x32_bf16 v[116:119], a[124:127], v[86:89], v[116:119]
  v_mfma_f32_16x16x32_bf16 v[120:123], a[128:131], v[86:89], v[120:123]
  v_mfma_f32_16x16x32_bf16 v[124:127], a[132:135], v[86:89], v[124:127]
  v_mfma_f32_16x16x32_bf16 v[128:131], a[136:139], v[86:89], v[128:131]
  s_waitcnt vmcnt(4)
  v_mfma_f32_16x16x32_bf16 v[112:115], a[140:143], v[90:93], v[112:115]
  v_mfma_f32_16x16x32_bf16 v[116:119], a[144:147], v[90:93], v[116:119]
  v_mfma_f32_16x16x32_bf16 v[120:123], a[148:151], v[90:93], v[120:123]
  v_mfma_f32_16x16x32_bf16 v[124:127], a[152:155], v[90:93], v[124:127]
  v_mfma_f32_16x16x32_bf16 v[128:131], a[156:159], v[90:93], v[128:131]
  s_waitcnt vmcnt(3)
  v_mfma_f32_16x16x32_bf16 v[112:115], a[160:163], v[94:97], v[112:115]
  v_mfma_f32_16x16x32_bf16 v[116:119], a[164:167], v[94:97], v[116:119]
  v_mfma_f32_16x16x32_bf16 v[120:123], a[168:171], v[94:97], v[120:123]
  v_mfma_f32_16x16x32_bf16 v[124:127], a[172:175], v[94:97], v[124:127]
  v_mfma_f32_16x16x32_bf16 v[128:131], a[176:179], v[94:97], v[128:131]
  s_waitcnt lgkmcnt(0)
  s_barrier
  s_waitcnt vmcnt(2)
  v_mfma_f32_16x16x32_bf16 v[112:115], a[180:183], v[98:101], v[112:115]
  ds_read_b128 v[176:179], v6 offset:0
  v_mfma_f32_16x16x32_bf16 v[116:119], a[184:187], v[98:101], v[116:119]
  ds_read_b128 v[180:183], v6 offset:1024
  v_mfma_f32_16x16x32_bf16 v[120:123], a[188:191], v[98:101], v[120:123]
  ds_read_b128 v[184:187], v6 offset:2048
  v_mfma_f32_16x16x32_bf16 v[124:127], a[192:195], v[98:101], v[124:127]
  ds_read_b128 v[188:191], v6 offset:3072
  v_mfma_f32_16x16x32_bf16 v[128:131], a[196:199], v[98:101], v[128:131]
  ds_read_b128 v[192:195], v6 offset:4096
  s_waitcnt vmcnt(1)
  v_mfma_f32_16x16x32_bf16 v[112:115], a[200:203], v[102:105], v[112:115]
  ds_read_b128 v[196:199], v6 offset:5120
  v_mfma_f32_16x16x32_bf16 v[116:119], a[204:207], v[102:105], v[116:119]
  ds_read_b128 v[200:203], v6 offset:6144
  v_mfma_f32_16x16x32_bf16 v[120:123], a[208:211], v[102:105], v[120:123]
  ds_read_b128 v[204:207], v6 offset:7168
  v_mfma_f32_16x16x32_bf16 v[124:127], a[212:215], v[102:105], v[124:127]
  ds_read_b128 v[208:211], v6 offset:8192
  v_mfma_f32_16x16x32_bf16 v[128:131], a[216:219], v[102:105], v[128:131]
  ds_read_b128 v[212:215], v6 offset:9216
  s_waitcnt vmcnt(0)
  v_mfma_f32_16x16x32_bf16 v[112:115], a[220:223], v[106:109], v[112:115]
  ds_read_b128 v[216:219], v6 offset:10240
  v_mfma_f32_16x16x32_bf16 v[116:119], a[224:227], v[106:109], v[116:119]
  ds_read_b128 v[220:223], v6 offset:11264
  v_mfma_f32_16x16x32_bf16 v[120:123], a[240:243], v[106:109], v[120:123]
  ds_read_b128 v[224:227], v6 offset:12288
  v_mfma_f32_16x16x32_bf16 v[124:127], a[244:247], v[106:109], v[124:127]
  ds_read_b128 v[228:231], v6 offset:13312
  v_mfma_f32_16x16x32_bf16 v[128:131], a[248:251], v[106:109], v[128:131]
  ds_read_b128 v[232:235], v6 offset:14336
  s_waitcnt lgkmcnt(5)
  v_pk_add_f32 v[176:177], v[176:177], v[196:197]
  v_pk_add_f32 v[178:179], v[178:179], v[198:199]
  v_pk_add_f32 v[180:181], v[180:181], v[200:201]
  v_pk_add_f32 v[182:183], v[182:183], v[202:203]
  v_pk_add_f32 v[184:185], v[184:185], v[204:205]
  v_pk_add_f32 v[186:187], v[186:187], v[206:207]
  v_pk_add_f32 v[188:189], v[188:189], v[208:209]
  v_pk_add_f32 v[190:191], v[190:191], v[210:211]
  v_pk_add_f32 v[192:193], v[192:193], v[212:213]
  v_pk_add_f32 v[194:195], v[194:195], v[214:215]
  s_waitcnt lgkmcnt(0)
  v_pk_add_f32 v[112:113], v[112:113], v[216:217]
  v_pk_add_f32 v[114:115], v[114:115], v[218:219]
  v_pk_add_f32 v[116:117], v[116:117], v[220:221]
  v_pk_add_f32 v[118:119], v[118:119], v[222:223]
  v_pk_add_f32 v[120:121], v[120:121], v[224:225]
  v_pk_add_f32 v[122:123], v[122:123], v[226:227]
  v_pk_add_f32 v[124:125], v[124:125], v[228:229]
  v_pk_add_f32 v[126:127], v[126:127], v[230:231]
  v_pk_add_f32 v[128:129], v[128:129], v[232:233]
  v_pk_add_f32 v[130:131], v[130:131], v[234:235]
  v_pk_add_f32 v[112:113], v[112:113], v[176:177]
  v_pk_add_f32 v[114:115], v[114:115], v[178:179]
  v_pk_add_f32 v[116:117], v[116:117], v[180:181]
  v_pk_add_f32 v[118:119], v[118:119], v[182:183]
  v_pk_add_f32 v[120:121], v[120:121], v[184:185]
  v_pk_add_f32 v[122:123], v[122:123], v[186:187]
  v_pk_add_f32 v[124:125], v[124:125], v[188:189]
  v_pk_add_f32 v[126:127], v[126:127], v[190:191]
  v_pk_add_f32 v[128:129], v[128:129], v[192:193]
  v_pk_add_f32 v[130:131], v[130:131], v[194:195]
  v_cvt_pk_bf16_f32 v244, v112, v113
  v_cvt_pk_bf16_f32 v245, v114, v115
  v_cvt_pk_bf16_f32 v246, v116, v117
  v_cvt_pk_bf16_f32 v247, v118, v119
  v_cvt_pk_bf16_f32 v248, v120, v121
  v_cvt_pk_bf16_f32 v249, v122, v123
  v_cvt_pk_bf16_f32 v250, v124, v125
  v_cvt_pk_bf16_f32 v251, v126, v127
  v_cvt_pk_bf16_f32 v252, v128, v129
  v_cvt_pk_bf16_f32 v253, v130, v131
  ds_write_b64 v239, v[244:245] offset:0
  ds_write_b64 v239, v[246:247] offset:8
  ds_write_b64 v239, v[248:249] offset:16
  ds_write_b64 v239, v[250:251] offset:24
  ds_write_b64 v239, v[252:253] offset:32
  s_waitcnt lgkmcnt(0)
  ds_read_b128 v[14:17], v6 offset:0
  ds_read_b128 v[18:21], v6 offset:1024
  ds_read_b128 v[22:25], v6 offset:2048
  s_cmp_eq_u32 s30, 0
  s_cbranch_scc1 L_wt_2148
  s_waitcnt lgkmcnt(2)
  buffer_store_dwordx4 v[14:17], v236, s[16:19], s52 offen
  s_waitcnt lgkmcnt(1)
  buffer_store_dwordx4 v[18:21], v237, s[16:19], s52 offen
  s_waitcnt lgkmcnt(0)
  s_mov_b32 exec_hi, 0
  buffer_store_dwordx4 v[22:25], v238, s[16:19], s52 offen
  s_mov_b64 exec, -1
L_wj_2149:
  s_or_b32 s33, s2, s28
  s_cbranch_scc1 L_ntag_2150
  s_load_dwordx2 s[48:49], s[0:1], 64
  v_mov_b32 v9, 0
  s_mov_b64 exec, 1
  s_waitcnt lgkmcnt(0)
  global_store_dword v9, v9, s[48:49]
L_ntag_2150:
L_mkdone_1:
  s_endpgm
L_fb_2125:
  s_cmp_lg_u32 s37, 0
  s_cbranch_scc1 L_fin_2126
  s_mov_b32 s37, 1
  v_add_u32 v62, 161280, v3
  v_mov_b32 v9, 0xff800000
  v_mov_b32 v10, 0xff800000
  s_mov_b32 s33, 64
L_fl_2151:
  ds_read_b64 v[26:27], v62 offset:0
  ds_read_b64 v[28:29], v62 offset:256
  ds_read_b64 v[30:31], v62 offset:1024
  s_waitcnt lgkmcnt(0)
  v_mfma_f32_32x32x16_bf16 v[96:111], v[26:29], v[14:17], 0
  v_mfma_f32_32x32x16_bf16 v[112:127], v[26:29], v[20:23], 0
  v_mfma_f32_32x32x8_bf16 v[96:111], v[30:31], v[18:19], v[96:111]
  v_mfma_f32_32x32x8_bf16 v[112:127], v[30:31], v[24:25], v[112:127]
  v_subrev_u32 v62, 2560, v62
  s_sub_u32 s33, s33, 1
  s_nop 7
  s_nop 4
  v_max3_f32 v9, v96, v97, v9
  v_max3_f32 v9, v98, v99, v9
  v_max3_f32 v9, v100, v101, v9
  v_max3_f32 v9, v102, v103, v9
  v_max3_f32 v9, v104, v105, v9
  v_max3_f32 v9, v106, v107, v9
  v_max3_f32 v9, v108, v109, v9
  v_max3_f32 v9, v110, v111, v9
  v_max3_f32 v10, v112, v113, v10
  v_max3_f32 v10, v114, v115, v10
  v_max3_f32 v10, v116, v117, v10
  v_max3_f32 v10, v118, v119, v10
  v_max3_f32 v10, v120, v121, v10
  v_max3_f32 v10, v122, v123, v10
  v_max3_f32 v10, v124, v125, v10
  v_max3_f32 v10, v126, v127, v10
  s_cmp_lg_u32 s33, 0
  s_cbranch_scc1 L_fl_2151
  v_mov_b32 v11, v9
  v_mov_b32 v12, v10
  s_nop 1
  v_permlane32_swap_b32 v11, v9
  v_permlane32_swap_b32 v12, v10
  s_nop 1
  v_max_f32 v9, v9, v11
  v_max_f32 v10, v10, v12
  v_sub_f32 v64, 0, v9
  v_sub_f32 v65, 0, v9
  v_sub_f32 v66, 0, v9
  v_sub_f32 v67, 0, v9
  v_sub_f32 v68, 0, v9
  v_sub_f32 v69, 0, v9
  v_sub_f32 v70, 0, v9
  v_sub_f32 v71, 0, v9
  v_sub_f32 v72, 0, v9
  v_sub_f32 v73, 0, v9
  v_sub_f32 v74, 0, v9
  v_sub_f32 v75, 0, v9
  v_sub_f32 v76, 0, v9
  v_sub_f32 v77, 0, v9
  v_sub_f32 v78, 0, v9
  v_sub_f32 v79, 0, v9
  ds_read_b64 v[32:33], v3 offset:2560
  ds_read_b64 v[34:35], v3 offset:2816
  ds_read_b64 v[36:37], v3 offset:3584
  v_mfma_f32_32x32x16_bf16 v[96:111], v[26:29], v[14:17], v[64:79]
  v_mfma_f32_32x32x8_bf16 v[96:111], v[30:31], v[18:19], v[96:111]
  s_mov_b64 exec, s[38:39]
  ds_read_b128 v[38:41], v6 offset:0
  ds_read_b128 v[42:45], v6 offset:640
  s_mov_b64 exec, -1
  v_sub_f32 v80, 0, v10
  v_sub_f32 v81, 0, v10
  v_sub_f32 v82, 0, v10
  v_sub_f32 v83, 0, v10
  v_sub_f32 v84, 0, v10
  v_sub_f32 v85, 0, v10
  v_sub_f32 v86, 0, v10
  v_sub_f32 v87, 0, v10
  v_sub_f32 v88, 0, v10
  v_sub_f32 v89, 0, v10
  v_sub_f32 v90, 0, v10
  v_sub_f32 v91, 0, v10
  v_sub_f32 v92, 0, v10
  v_sub_f32 v93, 0, v10
  v_sub_f32 v94, 0, v10
  v_sub_f32 v95, 0, v10
  v_mov_b32 v128, 0
  v_mov_b32 v129, 0
  v_mov_b32 v130, 0
  v_mov_b32 v131, 0
  v_mov_b32 v132, 0
  v_mov_b32 v133, 0
  v_mov_b32 v134, 0
  v_mov_b32 v135, 0
  v_mov_b32 v136, 0
  v_mov_b32 v137, 0
  v_mov_b32 v138, 0
  v_mov_b32 v139, 0
  v_mov_b32 v140, 0
  v_mov_b32 v141, 0
  v_mov_b32 v142, 0
  v_mov_b32 v143, 0
  v_mov_b32 v144, 0
  v_mov_b32 v145, 0
  v_mov_b32 v146, 0
  v_mov_b32 v147, 0
  v_mov_b32 v148, 0
  v_mov_b32 v149, 0
  v_mov_b32 v150, 0
  v_mov_b32 v151, 0
  v_mov_b32 v152, 0
  v_mov_b32 v153, 0
  v_mov_b32 v154, 0
  v_mov_b32 v155, 0
  v_mov_b32 v156, 0
  v_mov_b32 v157, 0
  v_mov_b32 v158, 0
  v_mov_b32 v159, 0
  v_mov_b32 v58, 0
  v_mov_b32 v59, 0
  v_mov_b32 v60, 0
  v_mov_b32 v61, 0
  s_waitcnt lgkmcnt(0)
  v_exp_f32 v96, v96
  v_exp_f32 v97, v97
  v_mov_b32 v62, v3
  v_mov_b32 v63, v6
  s_mov_b32 s33, 31
L_fl2_2152:
  v_exp_f32 v98, v98
  v_mfma_f32_32x32x16_bf16 v[144:159], v[50:53], v[58:61], v[144:159]
  v_cvt_pk_bf16_f32 v54, v96, v97
  v_exp_f32 v99, v99
  v_exp_f32 v100, v100
  v_cvt_pk_bf16_f32 v55, v98, v99
  v_exp_f32 v101, v101
  v_mfma_f32_32x32x16_bf16 v[112:127], v[26:29], v[20:23], v[80:95]
  s_mov_b64 exec, s[38:39]
  ds_read_b128 v[46:49], v63 offset:2560
  ds_read_b128 v[50:53], v63 offset:3200
  s_mov_b64 exec, -1
  v_exp_f32 v102, v102
  v_cvt_pk_bf16_f32 v56, v100, v101
  v_exp_f32 v103, v103
  v_exp_f32 v104, v104
  v_mfma_f32_32x32x8_bf16 v[112:127], v[30:31], v[24:25], v[112:127]
  v_cvt_pk_bf16_f32 v57, v102, v103
  v_exp_f32 v105, v105
  v_exp_f32 v106, v106
  v_cvt_pk_bf16_f32 v58, v104, v105
  v_exp_f32 v107, v107
  v_exp_f32 v108, v108
  v_cvt_pk_bf16_f32 v59, v106, v107
  v_exp_f32 v109, v109
  v_mfma_f32_32x32x16_bf16 v[128:143], v[38:41], v[54:57], v[128:143]
  v_exp_f32 v110, v110
  v_cvt_pk_bf16_f32 v60, v108, v109
  v_exp_f32 v111, v111
  v_exp_f32 v112, v112
  v_cvt_pk_bf16_f32 v61, v110, v111
  v_exp_f32 v113, v113
  v_exp_f32 v114, v114
  v_mfma_f32_32x32x16_bf16 v[128:143], v[42:45], v[58:61], v[128:143]
  s_waitcnt lgkmcnt(0)
  v_cvt_pk_bf16_f32 v54, v112, v113
  v_exp_f32 v115, v115
  v_exp_f32 v116, v116
  v_cvt_pk_bf16_f32 v55, v114, v115
  v_exp_f32 v117, v117
  v_mfma_f32_32x32x16_bf16 v[96:111], v[32:35], v[14:17], v[64:79]
  ds_read_b64 v[26:27], v62 offset:5120
  ds_read_b64 v[28:29], v62 offset:5376
  ds_read_b64 v[30:31], v62 offset:6144
  v_exp_f32 v118, v118
  v_cvt_pk_bf16_f32 v56, v116, v117
  v_exp_f32 v119, v119
  v_exp_f32 v120, v120
  v_mfma_f32_32x32x8_bf16 v[96:111], v[36:37], v[18:19], v[96:111]
  v_cvt_pk_bf16_f32 v57, v118, v119
  v_exp_f32 v121, v121
  v_exp_f32 v122, v122
  v_cvt_pk_bf16_f32 v58, v120, v121
  v_exp_f32 v123, v123
  v_exp_f32 v124, v124
  v_cvt_pk_bf16_f32 v59, v122, v123
  v_exp_f32 v125, v125
  v_mfma_f32_32x32x16_bf16 v[144:159], v[38:41], v[54:57], v[144:159]
  v_exp_f32 v126, v126
  v_cvt_pk_bf16_f32 v60, v124, v125
  v_exp_f32 v127, v127
  v_exp_f32 v96, v96
  v_cvt_pk_bf16_f32 v61, v126, v127
  v_exp_f32 v97, v97
  v_exp_f32 v98, v98
  v_mfma_f32_32x32x16_bf16 v[144:159], v[42:45], v[58:61], v[144:159]
  v_cvt_pk_bf16_f32 v54, v96, v97
  v_exp_f32 v99, v99
  v_exp_f32 v100, v100
  v_cvt_pk_bf16_f32 v55, v98, v99
  v_exp_f32 v101, v101
  v_mfma_f32_32x32x16_bf16 v[112:127], v[32:35], v[20:23], v[80:95]
  s_mov_b64 exec, s[38:39]
  ds_read_b128 v[38:41], v63 offset:5120
  ds_read_b128 v[42:45], v63 offset:5760
  s_mov_b64 exec, -1
  v_exp_f32 v102, v102
  v_cvt_pk_bf16_f32 v56, v100, v101
  v_exp_f32 v103, v103
  v_exp_f32 v104, v104
  v_mfma_f32_32x32x8_bf16 v[112:127], v[36:37], v[24:25], v[112:127]
  v_cvt_pk_bf16_f32 v57, v102, v103
  v_exp_f32 v105, v105
  v_exp_f32 v106, v106
  v_cvt_pk_bf16_f32 v58, v104, v105
  v_exp_f32 v107, v107
  v_exp_f32 v108, v108
  v_cvt_pk_bf16_f32 v59, v106, v107
  v_exp_f32 v109, v109
  v_mfma_f32_32x32x16_bf16 v[128:143], v[46:49], v[54:57], v[128:143]
  v_exp_f32 v110, v110
  v_cvt_pk_bf16_f32 v60, v108, v109
  v_exp_f32 v111, v111
  v_exp_f32 v112, v112
  v_cvt_pk_bf16_f32 v61, v110, v111
  v_exp_f32 v113, v113
  v_exp_f32 v114, v114
  v_mfma_f32_32x32x16_bf16 v[128:143], v[50:53], v[58:61], v[128:143]
  s_waitcnt lgkmcnt(0)
  v_cvt_pk_bf16_f32 v54, v112, v113
  v_exp_f32 v115, v115
  v_exp_f32 v116, v116
  v_cvt_pk_bf16_f32 v55, v114, v115
  v_exp_f32 v117, v117
  v_mfma_f32_32x32x16_bf16 v[96:111], v[26:29], v[14:17], v[64:79]
  ds_read_b64 v[32:33], v62 offset:7680
  ds_read_b64 v[34:35], v62 offset:7936
  ds_read_b64 v[36:37], v62 offset:8704
  v_exp_f32 v118, v118
  v_cvt_pk_bf16_f32 v56, v116, v117
  v_exp_f32 v119, v119
  v_exp_f32 v120, v120
  v_mfma_f32_32x32x8_bf16 v[96:111], v[30:31], v[18:19], v[96:111]
  v_cvt_pk_bf16_f32 v57, v118, v119
  v_exp_f32 v121, v121
  v_exp_f32 v122, v122
  v_cvt_pk_bf16_f32 v58, v120, v121
  v_exp_f32 v123, v123
  v_exp_f32 v124, v124
  v_cvt_pk_bf16_f32 v59, v122, v123
  v_exp_f32 v125, v125
  v_mfma_f32_32x32x16_bf16 v[144:159], v[46:49], v[54:57], v[144:159]
  v_exp_f32 v126, v126
  v_cvt_pk_bf16_f32 v60, v124, v125
  v_exp_f32 v127, v127
  v_exp_f32 v96, v96
  v_cvt_pk_bf16_f32 v61, v126, v127
  v_exp_f32 v97, v97
  v_add_u32 v62, 5120, v62
  v_add_u32 v63, 5120, v63
  s_sub_u32 s33, s33, 1
  s_cmp_lg_u32 s33, 0
  s_cbranch_scc1 L_fl2_2152
  v_exp_f32 v98, v98
  v_mfma_f32_32x32x16_bf16 v[144:159], v[50:53], v[58:61], v[144:159]
  v_cvt_pk_bf16_f32 v54, v96, v97
  v_exp_f32 v99, v99
  v_exp_f32 v100, v100
  v_cvt_pk_bf16_f32 v55, v98, v99
  v_exp_f32 v101, v101
  v_mfma_f32_32x32x16_bf16 v[112:127], v[26:29], v[20:23], v[80:95]
  s_mov_b64 exec, s[38:39]
  ds_read_b128 v[46:49], v63 offset:2560
  ds_read_b128 v[50:53], v63 offset:3200
  s_mov_b64 exec, -1
  v_exp_f32 v102, v102
  v_cvt_pk_bf16_f32 v56, v100, v101
  v_exp_f32 v103, v103
  v_exp_f32 v104, v104
  v_mfma_f32_32x32x8_bf16 v[112:127], v[30:31], v[24:25], v[112:127]
  v_cvt_pk_bf16_f32 v57, v102, v103
  v_exp_f32 v105, v105
  v_exp_f32 v106, v106
  v_cvt_pk_bf16_f32 v58, v104, v105
  v_exp_f32 v107, v107
  v_exp_f32 v108, v108
  v_cvt_pk_bf16_f32 v59, v106, v107
  v_exp_f32 v109, v109
  v_mfma_f32_32x32x16_bf16 v[128:143], v[38:41], v[54:57], v[128:143]
  v_exp_f32 v110, v110
  v_cvt_pk_bf16_f32 v60, v108, v109
  v_exp_f32 v111, v111
  v_exp_f32 v112, v112
  v_cvt_pk_bf16_f32 v61, v110, v111
  v_exp_f32 v113, v113
  v_exp_f32 v114, v114
  v_mfma_f32_32x32x16_bf16 v[128:143], v[42:45], v[58:61], v[128:143]
  s_waitcnt lgkmcnt(0)
  v_cvt_pk_bf16_f32 v54, v112, v113
  v_exp_f32 v115, v115
  v_exp_f32 v116, v116
  v_cvt_pk_bf16_f32 v55, v114, v115
  v_exp_f32 v117, v117
  v_mfma_f32_32x32x16_bf16 v[96:111], v[32:35], v[14:17], v[64:79]
  v_exp_f32 v118, v118
  v_cvt_pk_bf16_f32 v56, v116, v117
  v_exp_f32 v119, v119
  v_exp_f32 v120, v120
  v_mfma_f32_32x32x8_bf16 v[96:111], v[36:37], v[18:19], v[96:111]
  v_cvt_pk_bf16_f32 v57, v118, v119
  v_exp_f32 v121, v121
  v_exp_f32 v122, v122
  v_cvt_pk_bf16_f32 v58, v120, v121
  v_exp_f32 v123, v123
  v_exp_f32 v124, v124
  v_cvt_pk_bf16_f32 v59, v122, v123
  v_exp_f32 v125, v125
  v_mfma_f32_32x32x16_bf16 v[144:159], v[38:41], v[54:57], v[144:159]
  v_exp_f32 v126, v126
  v_cvt_pk_bf16_f32 v60, v124, v125
  v_exp_f32 v127, v127
  v_exp_f32 v96, v96
  v_cvt_pk_bf16_f32 v61, v126, v127
  v_exp_f32 v97, v97
  v_exp_f32 v98, v98
  v_mfma_f32_32x32x16_bf16 v[144:159], v[42:45], v[58:61], v[144:159]
  v_cvt_pk_bf16_f32 v54, v96, v97
  v_exp_f32 v99, v99
  v_exp_f32 v100, v100
  v_cvt_pk_bf16_f32 v55, v98, v99
  v_exp_f32 v101, v101
  v_mfma_f32_32x32x16_bf16 v[112:127], v[32:35], v[20:23], v[80:95]
  v_exp_f32 v102, v102
  v_cvt_pk_bf16_f32 v56, v100, v101
  v_exp_f32 v103, v103
  v_exp_f32 v104, v104
  v_mfma_f32_32x32x8_bf16 v[112:127], v[36:37], v[24:25], v[112:127]
  v_cvt_pk_bf16_f32 v57, v102, v103
  v_exp_f32 v105, v105
  v_exp_f32 v106, v106
  v_cvt_pk_bf16_f32 v58, v104, v105
  v_exp_f32 v107, v107
  v_exp_f32 v108, v108
  v_cvt_pk_bf16_f32 v59, v106, v107
  v_exp_f32 v109, v109
  v_mfma_f32_32x32x16_bf16 v[128:143], v[46:49], v[54:57], v[128:143]
  v_exp_f32 v110, v110
  v_cvt_pk_bf16_f32 v60, v108, v109
  v_exp_f32 v111, v111
  v_exp_f32 v112, v112
  v_cvt_pk_bf16_f32 v61, v110, v111
  v_exp_f32 v113, v113
  v_exp_f32 v114, v114
  v_mfma_f32_32x32x16_bf16 v[128:143], v[50:53], v[58:61], v[128:143]
  s_waitcnt lgkmcnt(0)
  v_cvt_pk_bf16_f32 v54, v112, v113
  v_exp_f32 v115, v115
  v_exp_f32 v116, v116
  v_cvt_pk_bf16_f32 v55, v114, v115
  v_exp_f32 v117, v117
  v_exp_f32 v118, v118
  v_cvt_pk_bf16_f32 v56, v116, v117
  v_exp_f32 v119, v119
  v_exp_f32 v120, v120
  v_cvt_pk_bf16_f32 v57, v118, v119
  v_exp_f32 v121, v121
  v_exp_f32 v122, v122
  v_cvt_pk_bf16_f32 v58, v120, v121
  v_exp_f32 v123, v123
  v_exp_f32 v124, v124
  v_cvt_pk_bf16_f32 v59, v122, v123
  v_exp_f32 v125, v125
  v_mfma_f32_32x32x16_bf16 v[144:159], v[46:49], v[54:57], v[144:159]
  v_exp_f32 v126, v126
  v_cvt_pk_bf16_f32 v60, v124, v125
  v_exp_f32 v127, v127
  s_nop 0
  v_cvt_pk_bf16_f32 v61, v126, v127
  s_nop 1
  s_branch L_fin0_2124
L_qhook_19:
  s_mov_b32 s31, 200000
L_qsp_28:
  v_readfirstlane_b32 s100, v135
  s_cmp_lg_u32 s100, 0
  s_cbranch_scc1 L_qok_29
  global_load_dword v135, v139, s[48:49] sc1
  s_sub_u32 s31, s31, 1
  s_waitcnt vmcnt(0)
  s_cbranch_scc0 L_qsp_28
L_qok_29:
  s_or_b32 s32, s32, s100
  s_lshl_b32 s34, s26, 7
  s_add_u32 s34, s34, 32505856
  s_cmp_lg_u32 s28, 0
  s_cbranch_scc1 L_qloop_17
  s_lshl_b32 s33, s27, 2
  s_add_u32 s33, s33, s34
  v_mov_b32 v135, s32
  s_mov_b64 exec, 1
  buffer_store_dword v135, v139, s[8:11], s33 offen sc0 sc1
  s_mov_b64 exec, -1
  s_branch L_qloop_17
L_wt_33:
  buffer_store_dwordx2 v[64:65], v24, s[8:11], s58 offen sc0 sc1
  buffer_store_dwordx2 v[66:67], v25, s[8:11], s58 offen sc0 sc1
  buffer_store_dwordx2 v[68:69], v26, s[8:11], s58 offen sc0 sc1
  buffer_store_dwordx2 v[70:71], v27, s[8:11], s58 offen sc0 sc1
  s_branch L_wj_34
L_wt_35:
  buffer_store_dwordx2 v[80:81], v28, s[8:11], s58 offen sc0 sc1
  buffer_store_dwordx2 v[82:83], v29, s[8:11], s58 offen sc0 sc1
  buffer_store_dwordx2 v[84:85], v30, s[8:11], s58 offen sc0 sc1
  buffer_store_dwordx2 v[86:87], v31, s[8:11], s58 offen sc0 sc1
  s_branch L_wj_36
L_wt_37:
  buffer_store_dwordx2 v[96:97], v24, s[8:11], s59 offen sc0 sc1
  buffer_store_dwordx2 v[98:99], v25, s[8:11], s59 offen sc0 sc1
  buffer_store_dwordx2 v[100:101], v26, s[8:11], s59 offen sc0 sc1
  buffer_store_dwordx2 v[102:103], v27, s[8:11], s59 offen sc0 sc1
  s_branch L_wj_38
L_wt_39:
  buffer_store_dwordx2 v[112:113], v28, s[8:11], s59 offen sc0 sc1
  buffer_store_dwordx2 v[114:115], v29, s[8:11], s59 offen sc0 sc1
  buffer_store_dwordx2 v[116:117], v30, s[8:11], s59 offen sc0 sc1
  buffer_store_dwordx2 v[118:119], v31, s[8:11], s59 offen sc0 sc1
  s_branch L_wj_40
L_qhook_43:
  s_mov_b32 s31, 200000
L_qsp_52:
  v_readfirstlane_b32 s100, v135
  s_cmp_lg_u32 s100, 0
  s_cbranch_scc1 L_qok_53
  global_load_dword v135, v139, s[48:49] sc1
  s_sub_u32 s31, s31, 1
  s_waitcnt vmcnt(0)
  s_cbranch_scc0 L_qsp_52
L_qok_53:
  s_or_b32 s32, s32, s100
  s_lshl_b32 s34, s26, 7
  s_add_u32 s34, s34, 32505856
  s_cmp_lg_u32 s28, 0
  s_cbranch_scc1 L_qloop_41
  s_lshl_b32 s33, s27, 2
  s_add_u32 s33, s33, s34
  v_mov_b32 v135, s32
  s_mov_b64 exec, 1
  buffer_store_dword v135, v139, s[8:11], s33 offen sc0 sc1
  s_mov_b64 exec, -1
  s_branch L_qloop_41
L_wt_57:
  buffer_store_dwordx2 v[64:65], v24, s[8:11], s58 offen sc0 sc1
  buffer_store_dwordx2 v[66:67], v25, s[8:11], s58 offen sc0 sc1
  buffer_store_dwordx2 v[68:69], v26, s[8:11], s58 offen sc0 sc1
  buffer_store_dwordx2 v[70:71], v27, s[8:11], s58 offen sc0 sc1
  s_branch L_wj_58
L_wt_59:
  buffer_store_dwordx4 v[80:83], v28, s[8:11], s58 offen offset:0 sc0 sc1
  buffer_store_dwordx4 v[84:87], v28, s[8:11], s58 offen offset:640 sc0 sc1
  s_branch L_wj_60
L_wt_61:
  buffer_store_dwordx2 v[96:97], v24, s[8:11], s59 offen sc0 sc1
  buffer_store_dwordx2 v[98:99], v25, s[8:11], s59 offen sc0 sc1
  buffer_store_dwordx2 v[100:101], v26, s[8:11], s59 offen sc0 sc1
  buffer_store_dwordx2 v[102:103], v27, s[8:11], s59 offen sc0 sc1
  s_branch L_wj_62
L_wt_63:
  buffer_store_dwordx4 v[112:115], v28, s[8:11], s59 offen offset:0 sc0 sc1
  buffer_store_dwordx4 v[116:119], v28, s[8:11], s59 offen offset:640 sc0 sc1
  s_branch L_wj_64
L_qhook_67:
  s_mov_b32 s31, 200000
L_qsp_76:
  v_readfirstlane_b32 s100, v135
  s_cmp_lg_u32 s100, 0
  s_cbranch_scc1 L_qok_77
  global_load_dword v135, v139, s[48:49] sc1
  s_sub_u32 s31, s31, 1
  s_waitcnt vmcnt(0)
  s_cbranch_scc0 L_qsp_76
L_qok_77:
  s_or_b32 s32, s32, s100
  s_lshl_b32 s34, s26, 7
  s_add_u32 s34, s34, 32505856
  s_cmp_lg_u32 s28, 0
  s_cbranch_scc1 L_qloop_65
  s_lshl_b32 s33, s27, 2
  s_add_u32 s33, s33, s34
  v_mov_b32 v135, s32
  s_mov_b64 exec, 1
  buffer_store_dword v135, v139, s[8:11], s33 offen sc0 sc1
  s_mov_b64 exec, -1
  s_branch L_qloop_65
L_wt_81:
  buffer_store_dwordx4 v[64:67], v24, s[8:11], s58 offen offset:0 sc0 sc1
  buffer_store_dwordx4 v[68:71], v24, s[8:11], s58 offen offset:640 sc0 sc1
  s_branch L_wj_82
L_wt_83:
  buffer_store_dwordx2 v[80:81], v28, s[8:11], s58 offen sc0 sc1
  buffer_store_dwordx2 v[82:83], v29, s[8:11], s58 offen sc0 sc1
  buffer_store_dwordx2 v[84:85], v30, s[8:11], s58 offen sc0 sc1
  buffer_store_dwordx2 v[86:87], v31, s[8:11], s58 offen sc0 sc1
  s_branch L_wj_84
L_wt_85:
  buffer_store_dwordx4 v[96:99], v24, s[8:11], s59 offen offset:0 sc0 sc1
  buffer_store_dwordx4 v[100:103], v24, s[8:11], s59 offen offset:640 sc0 sc1
  s_branch L_wj_86
L_wt_87:
  buffer_store_dwordx2 v[112:113], v28, s[8:11], s59 offen sc0 sc1
  buffer_store_dwordx2 v[114:115], v29, s[8:11], s59 offen sc0 sc1
  buffer_store_dwordx2 v[116:117], v30, s[8:11], s59 offen sc0 sc1
  buffer_store_dwordx2 v[118:119], v31, s[8:11], s59 offen sc0 sc1
  s_branch L_wj_88
L_qhook_91:
  s_mov_b32 s31, 200000
L_qsp_100:
  v_readfirstlane_b32 s100, v135
  s_cmp_lg_u32 s100, 0
  s_cbranch_scc1 L_qok_101
  global_load_dword v135, v139, s[48:49] sc1
  s_sub_u32 s31, s31, 1
  s_waitcnt vmcnt(0)
  s_cbranch_scc0 L_qsp_100
L_qok_101:
  s_or_b32 s32, s32, s100
  s_lshl_b32 s34, s26, 7
  s_add_u32 s34, s34, 32505856
  s_cmp_lg_u32 s28, 0
  s_cbranch_scc1 L_qloop_89
  s_lshl_b32 s33, s27, 2
  s_add_u32 s33, s33, s34
  v_mov_b32 v135, s32
  s_mov_b64 exec, 1
  buffer_store_dword v135, v139, s[8:11], s33 offen sc0 sc1
  s_mov_b64 exec, -1
  s_branch L_qloop_89
L_wt_105:
  buffer_store_dwordx4 v[64:67], v24, s[8:11], s58 offen offset:0 sc0 sc1
  buffer_store_dwordx4 v[68:71], v24, s[8:11], s58 offen offset:640 sc0 sc1
  s_branch L_wj_106
L_wt_107:
  buffer_store_dwordx4 v[80:83], v28, s[8:11], s58 offen offset:0 sc0 sc1
  buffer_store_dwordx4 v[84:87], v28, s[8:11], s58 offen offset:640 sc0 sc1
  s_branch L_wj_108
L_wt_109:
  buffer_store_dwordx4 v[96:99], v24, s[8:11], s59 offen offset:0 sc0 sc1
  buffer_store_dwordx4 v[100:103], v24, s[8:11], s59 offen offset:640 sc0 sc1
  s_branch L_wj_110
L_wt_111:
  buffer_store_dwordx4 v[112:115], v28, s[8:11], s59 offen offset:0 sc0 sc1
  buffer_store_dwordx4 v[116:119], v28, s[8:11], s59 offen offset:640 sc0 sc1
  s_branch L_wj_112
L_wt_115:
  buffer_store_dword v132, v133, s[8:11], s34 offen sc0 sc1
  s_branch L_wj_116
L_pck_123:
  s_mov_b32 s31, 200000
L_poll_121:
  buffer_load_dwordx4 v[196:199], v2, s[8:11], s41 offen sc1
  s_sub_u32 s31, s31, 1
  s_waitcnt vmcnt(0)
  v_xor_b32 v196, s100, v196
  v_xor_b32 v197, s100, v197
  v_xor_b32 v198, s100, v198
  v_xor_b32 v199, s100, v199
  v_or3_b32 v196, v196, v197, v198
  v_or_b32 v196, v196, v199
  v_cmp_ne_u32 vcc, 0, v196
  s_cbranch_scc1 L_pout_122
  s_cbranch_vccnz L_poll_121
  s_branch L_pout_122
L_wt_2129:
  buffer_store_dwordx4 v[244:247], v124, s[16:19], s45 offen sc0 sc1
  buffer_store_dwordx4 v[248:251], v124, s[16:19], s45 offen offset:256 sc0 sc1
  buffer_store_dwordx2 v[252:253], v125, s[16:19], s45 offen offset:1024 sc0 sc1
  s_branch L_wj_2130
L_wt_2131:
  buffer_store_dwordx2 v[14:15], v126, s[8:11], s46 offen sc0 sc1
  s_branch L_wj_2132
L_wt_2133:
  buffer_store_dword v11, v12, s[8:11], s43 offen sc0 sc1
  s_branch L_wj_2134
L_pck_2139:
  s_mov_b32 s31, 200000
L_poll_2137:
  buffer_load_dwordx4 v[128:131], v9, s[8:11], s36 offen sc1
  s_sub_u32 s31, s31, 1
  s_waitcnt vmcnt(0)
  v_xor_b32 v128, s100, v128
  v_xor_b32 v129, s100, v129
  v_xor_b32 v130, s100, v130
  v_xor_b32 v131, s100, v131
  v_or3_b32 v128, v128, v129, v130
  v_or_b32 v128, v128, v131
  v_cmp_ne_u32 vcc, 0, v128
  s_cbranch_scc1 L_pout_2138
  s_cbranch_vccnz L_poll_2137
  s_branch L_pout_2138
L_wt_2140:
  buffer_store_dwordx4 v[48:51], v95, s[8:11], s33 offen offset:0 sc0 sc1
  buffer_store_dwordx4 v[52:55], v95, s[8:11], s33 offen offset:256 sc0 sc1
  buffer_store_dwordx4 v[56:59], v95, s[8:11], s33 offen offset:512 sc0 sc1
  s_branch L_wj_2141
L_wt_2142:
  buffer_store_dwordx4 v[60:63], v95, s[8:11], s33 offen offset:0 sc0 sc1
  buffer_store_dwordx4 v[64:67], v95, s[8:11], s33 offen offset:256 sc0 sc1
  buffer_store_dwordx4 v[68:71], v95, s[8:11], s33 offen offset:512 sc0 sc1
  s_branch L_wj_2143
L_wt_2144:
  buffer_store_dword v11, v12, s[8:11], s43 offen sc0 sc1
  s_branch L_wj_2145
L_wt_2148:
  s_waitcnt lgkmcnt(2)
  buffer_store_dwordx4 v[14:17], v236, s[16:19], s52 offen sc0 sc1
  s_waitcnt lgkmcnt(1)
  buffer_store_dwordx4 v[18:21], v237, s[16:19], s52 offen sc0 sc1
  s_waitcnt lgkmcnt(0)
  s_mov_b32 exec_hi, 0
  buffer_store_dwordx4 v[22:25], v238, s[16:19], s52 offen sc0 sc1
  s_mov_b64 exec, -1
  s_branch L_wj_2149
L_mk_end:
.section .rodata,"a"
.p2align 6
.amdhsa_kernel mk_attn_ffn_kernel
.amdhsa_next_free_vgpr 512
.amdhsa_next_free_sgpr 102
.amdhsa_accum_offset 256
.amdhsa_group_segment_fixed_size 0
.amdhsa_kernarg_size 80
.amdhsa_user_sgpr_count 2
.amdhsa_user_sgpr_kernarg_segment_ptr 1
.amdhsa_system_sgpr_workgroup_id_x 1
.end_amdhsa_kernel
```
